```python
import torch

def _softmax(x, axis=-1):
    return torch.softmax(x, dim=axis)
def _gelu(x):
    return torch.nn.functional.gelu(x, approximate="tanh")
def _silu(x):
    return torch.nn.functional.silu(x)
def _sigmoid(x):
    return torch.sigmoid(x)
def _layernorm(x, axis=-1, eps=1e-5):
    m = x.mean(dim=axis, keepdim=True)
    v = x.var(dim=axis, keepdim=True, unbiased=False)
    return (x - m) / torch.sqrt(v + eps)
def _scatter_add(tgt, idx, src, axis=0):
    return tgt.clone().index_add_(axis, idx, src)
def _segment_sum(src, seg, n):
    out = torch.zeros((n,) + src.shape[1:], dtype=src.dtype)
    return out.index_add_(0, seg, src)
def _pad(x, pw):
    flat = tuple(v for pair in reversed(pw) for v in pair)
    return torch.nn.functional.pad(x, flat)

kernel_name = 'parallel_sum__softmax_full_mha__swiglu_ffn__prompt'

def setup_inputs():

    _w = (lambda a: (lambda t: t.to(torch.bfloat16) if t.is_floating_point() else t)(torch.as_tensor(a)))
    def _A_setup():
        B, S, D = 1, 2048, 640
        return {
            "x": _w((lambda *s: torch.randn(*s, dtype=torch.bfloat16) * 0.05)(B, S, D)),
            "wqkv": _w((lambda *s: torch.randn(*s, dtype=torch.bfloat16) * 0.2)(D, 3 * D)),
            "wo": _w((lambda *s: torch.randn(*s, dtype=torch.bfloat16) * 0.1)(D, D)),
        }
    _A_in = _A_setup()

    def _B_setup():
        B, S, D, F = 1, 2048, 640, 1536
        return {
            "x": _w((lambda *s: torch.randn(*s, dtype=torch.bfloat16) * 0.05)(B, S, D)),
            "w_gate": _w((lambda *s: torch.randn(*s, dtype=torch.bfloat16) * 0.1)(D, F)),
            "w_up": _w((lambda *s: torch.randn(*s, dtype=torch.bfloat16) * 0.1)(D, F)),
            "w_down": _w((lambda *s: torch.randn(*s, dtype=torch.bfloat16) * 0.1)(F, D)),
        }
    _B_in = _B_setup()

    return {
        "A_x": _A_in["x"],
        "A_wqkv": _A_in["wqkv"],
        "A_wo": _A_in["wo"],
        "B_x": _B_in["x"],
        "B_w_gate": _B_in["w_gate"],
        "B_w_up": _B_in["w_up"],
        "B_w_down": _B_in["w_down"],
    }

def reference(A_x, A_wqkv, A_wo, B_x, B_w_gate, B_w_up, B_w_down):
    def _A_ref(x, wqkv, wo):
        B, S, D = x.shape
        H = 32; Dh = D // H
        qkv = (lambda x, *d: x.permute(*d))((x @ wqkv).reshape(B, S, 3, H, Dh), 2, 0, 3, 1, 4)
        q, k, v = qkv[0], qkv[1], qkv[2]
        scale = Dh ** -0.5
        scores = torch.einsum("bhqd,bhkd->bhqk", q, k) * scale
        p = _softmax(scores, axis=-1)
        o = torch.einsum("bhqk,bhkd->bhqd", p, v)
        return (lambda x, *d: x.permute(*d))(o, 0, 2, 1, 3).reshape(B, S, D) @ wo

    def _B_ref(x, w_gate, w_up, w_down):
        g = _silu(x @ w_gate)
        u = x @ w_up
        return (g * u) @ w_down

    x = A_x
    xn = _layernorm(x, axis=-1)
    return x + _A_ref(xn, A_wqkv, A_wo) + _B_ref(xn, B_w_gate, B_w_up, B_w_down)
```

```asm
; @launch kernel=parallel_sum__softmax_full_mha__swiglu_ffn__prompt_kernel grid=(512,1,1) block=(512,1,1) lds=81920
.amdgcn_target "amdgcn-amd-amdhsa--gfx950"
.text
.globl parallel_sum__softmax_full_mha__swiglu_ffn__prompt_kernel
.p2align 8
.type parallel_sum__softmax_full_mha__swiglu_ffn__prompt_kernel,@function
parallel_sum__softmax_full_mha__swiglu_ffn__prompt_kernel:
L_code_begin:
    s_load_dwordx4 s[36:39], s[0:1], 64
    s_load_dwordx4 s[32:35], s[0:1], 0
    s_getpc_b64 s[12:13]
L_pc:
    s_sub_u32 s12, s12, L_pc-L_code_begin
    s_subb_u32 s13, s13, 0
    s_mov_b32 s14, L_code_end-L_code_begin
    s_mov_b32 s15, 0x00020000
    s_lshr_b32 s30, s2, 3
    s_lshl_b32 s30, s30, 13
    v_lshlrev_b32 v1, 4, v0
    s_cmp_ge_u32 s2, 512
    s_cbranch_scc1 L_end
    buffer_load_dwordx4 v[124:127], v1, s[12:15], s30 offen
    v_lshrrev_b32 v1, 6, v0
    v_and_b32 v103, 63, v0
    v_readfirstlane_b32 s20, v1
    s_cmp_ge_u32 s2, 256
    s_cbranch_scc1 L_B
    s_setprio 2
    v_mov_b32 v117, v103
    s_and_b32 s31, s2, 3
    s_lshl_b32 s31, s31, 2
    s_bfe_u32 s30, s2, 0x20003
    s_add_u32 s31, s31, s30
    s_bfe_u32 s28, s2, 0x10002
    s_lshl_b32 s28, s28, 3
    s_lshr_b32 s30, s2, 5
    s_add_u32 s28, s28, s30
    s_cmp_ge_u32 s20, 4
    s_cbranch_scc0 L_q_cons
    s_cmp_eq_u32 s28, 15
    s_cbranch_scc1 L_q_skip
    s_and_b32 s21, s20, 3
    s_lshl_b32 s29, s21, 10
    v_and_b32 v1, 3, v1
    v_lshrrev_b32 v2, 3, v117
    v_lshl_add_u32 v2, v1, 3, v2
    v_lshrrev_b32 v3, 4, v117
    v_and_b32 v4, 1, v1
    v_lshl_add_u32 v4, v4, 2, v3
    v_and_b32 v5, 7, v117
    v_xor_b32 v4, v4, v5
    v_lshlrev_b32 v4, 4, v4
    v_mul_u32_u24 v101, 1280, v2
    v_add_u32 v101, v101, v4
    v_and_b32 v3, 1, v3
    v_lshlrev_b32 v3, 2, v3
    v_xor_b32 v3, v3, v5
    v_lshlrev_b32 v3, 4, v3
    v_mul_u32_u24 v102, 3840, v2
    v_add_u32 v102, v102, v3
    s_lshr_b32 s40, s2, 3
    s_mul_i32 s40, s40, 3
    s_mul_i32 s30, s40, 205
    s_lshr_b32 s30, s30, 11
    s_mul_i32 s30, s30, 10
    s_sub_u32 s40, s40, s30
    s_mul_i32 s27, s31, 163840
    s_add_u32 s26, s27, 1280
    s_lshl_b32 s23, s28, 8
    s_add_u32 s22, s23, 2457600
    s_lshl_b32 s24, s40, 7
    s_add_u32 s24, s24, s27
    s_mul_i32 s25, s40, 245760
    s_add_u32 s25, s25, s23
    s_waitcnt lgkmcnt(0)
    s_mov_b32 s4, s32
    s_mov_b32 s5, s33
    s_mov_b32 s6, 2621440
    s_mov_b32 s7, 0x00020000
    s_mov_b32 s8, s34
    s_mov_b32 s9, s35
    s_mov_b32 s10, 2457600
    s_mov_b32 s11, 0x00020000
    s_add_u32 m0, s29, 0
    s_add_u32 s30, s24, 0
    buffer_load_dwordx4 v101, s[4:7], s30 offen lds
    s_add_u32 m0, s29, 4096
    s_add_u32 s30, s24, 40960
    buffer_load_dwordx4 v101, s[4:7], s30 offen lds
    s_add_u32 m0, s29, 8192
    s_add_u32 s30, s24, 81920
    buffer_load_dwordx4 v101, s[4:7], s30 offen lds
    s_add_u32 m0, s29, 12288
    s_add_u32 s30, s24, 122880
    buffer_load_dwordx4 v101, s[4:7], s30 offen lds
    s_add_u32 s24, s24, 128
    s_cmp_eq_u32 s24, s26
    s_cselect_b32 s24, s27, s24
    s_add_u32 m0, s29, 49152
    s_add_u32 s30, s25, 0
    buffer_load_dwordx4 v102, s[8:11], s30 offen lds
    s_add_u32 m0, s29, 53248
    s_add_u32 s30, s25, 128
    buffer_load_dwordx4 v102, s[8:11], s30 offen lds
    s_add_u32 s25, s25, 122880
    s_cmp_eq_u32 s25, s22
    s_cselect_b32 s25, s23, s25
    s_add_u32 m0, s29, 57344
    s_add_u32 s30, s25, 0
    buffer_load_dwordx4 v102, s[8:11], s30 offen lds
    s_add_u32 m0, s29, 61440
    s_add_u32 s30, s25, 128
    buffer_load_dwordx4 v102, s[8:11], s30 offen lds
    s_add_u32 s25, s25, 122880
    s_cmp_eq_u32 s25, s22
    s_cselect_b32 s25, s23, s25
    s_add_u32 m0, s29, 16384
    s_add_u32 s30, s24, 0
    buffer_load_dwordx4 v101, s[4:7], s30 offen lds
    s_add_u32 m0, s29, 20480
    s_add_u32 s30, s24, 40960
    buffer_load_dwordx4 v101, s[4:7], s30 offen lds
    s_add_u32 m0, s29, 24576
    s_add_u32 s30, s24, 81920
    buffer_load_dwordx4 v101, s[4:7], s30 offen lds
    s_add_u32 m0, s29, 28672
    s_add_u32 s30, s24, 122880
    buffer_load_dwordx4 v101, s[4:7], s30 offen lds
    s_add_u32 s24, s24, 128
    s_cmp_eq_u32 s24, s26
    s_cselect_b32 s24, s27, s24
    s_add_u32 m0, s29, 65536
    s_add_u32 s30, s25, 0
    buffer_load_dwordx4 v102, s[8:11], s30 offen lds
    s_add_u32 m0, s29, 69632
    s_add_u32 s30, s25, 128
    buffer_load_dwordx4 v102, s[8:11], s30 offen lds
    s_add_u32 s25, s25, 122880
    s_cmp_eq_u32 s25, s22
    s_cselect_b32 s25, s23, s25
    s_add_u32 m0, s29, 73728
    s_add_u32 s30, s25, 0
    buffer_load_dwordx4 v102, s[8:11], s30 offen lds
    s_add_u32 m0, s29, 77824
    s_add_u32 s30, s25, 128
    buffer_load_dwordx4 v102, s[8:11], s30 offen lds
    s_add_u32 s25, s25, 122880
    s_cmp_eq_u32 s25, s22
    s_cselect_b32 s25, s23, s25
    s_add_u32 m0, s29, 32768
    s_add_u32 s30, s24, 0
    buffer_load_dwordx4 v101, s[4:7], s30 offen lds
    s_add_u32 m0, s29, 36864
    s_add_u32 s30, s24, 40960
    buffer_load_dwordx4 v101, s[4:7], s30 offen lds
    s_add_u32 m0, s29, 40960
    s_add_u32 s30, s24, 81920
    buffer_load_dwordx4 v101, s[4:7], s30 offen lds
    s_add_u32 m0, s29, 45056
    s_add_u32 s30, s24, 122880
    buffer_load_dwordx4 v101, s[4:7], s30 offen lds
    s_add_u32 s24, s24, 128
    s_cmp_eq_u32 s24, s26
    s_cselect_b32 s24, s27, s24
    s_add_u32 s44, s38, 19988480
    s_addc_u32 s45, s39, 0
    s_mov_b32 s46, 20480
    s_mov_b32 s47, 0x00020000
    s_mov_b32 s60, s36
    s_mov_b32 s61, s37
    s_mov_b32 s62, 256
    s_mov_b32 s63, 0x00020000
    s_add_u32 s48, s38, 19922944
    s_addc_u32 s49, s39, 0
    s_mov_b32 s50, 16384
    s_mov_b32 s51, 0x00020000
    v_mov_b32 v2, 0
    s_add_u32 s30, s31, 64
    s_lshl_b32 s30, s30, 7
    v_mov_b32 v3, s30
    v_mov_b32 v8, 1
    v_lshlrev_b32 v9, 3, v117
    s_lshl_b32 s41, s31, 9
    s_add_u32 s42, s41, 8192
    s_waitcnt vmcnt(14)
    s_barrier
    s_waitcnt vmcnt(12)
    s_barrier
    s_add_u32 m0, s29, 49152
    s_add_u32 s30, s25, 0
    buffer_load_dwordx4 v102, s[8:11], s30 offen lds
    s_add_u32 m0, s29, 53248
    s_add_u32 s30, s25, 128
    buffer_load_dwordx4 v102, s[8:11], s30 offen lds
    s_add_u32 s25, s25, 122880
    s_cmp_eq_u32 s25, s22
    s_cselect_b32 s25, s23, s25
    s_waitcnt vmcnt(8)
    s_barrier
    s_add_u32 m0, s29, 57344
    s_add_u32 s30, s25, 0
    buffer_load_dwordx4 v102, s[8:11], s30 offen lds
    s_add_u32 m0, s29, 61440
    s_add_u32 s30, s25, 128
    buffer_load_dwordx4 v102, s[8:11], s30 offen lds
    s_add_u32 s25, s25, 122880
    s_cmp_eq_u32 s25, s22
    s_cselect_b32 s25, s23, s25
    s_add_u32 m0, s29, 0
    s_add_u32 s30, s24, 0
    buffer_load_dwordx4 v101, s[4:7], s30 offen lds
    s_add_u32 m0, s29, 4096
    s_add_u32 s30, s24, 40960
    buffer_load_dwordx4 v101, s[4:7], s30 offen lds
    s_add_u32 m0, s29, 8192
    s_add_u32 s30, s24, 81920
    buffer_load_dwordx4 v101, s[4:7], s30 offen lds
    s_add_u32 m0, s29, 12288
    s_add_u32 s30, s24, 122880
    buffer_load_dwordx4 v101, s[4:7], s30 offen lds
    s_add_u32 s24, s24, 128
    s_cmp_eq_u32 s24, s26
    s_cselect_b32 s24, s27, s24
    s_waitcnt vmcnt(12)
    s_barrier
    s_add_u32 m0, s29, 65536
    s_add_u32 s30, s25, 0
    buffer_load_dwordx4 v102, s[8:11], s30 offen lds
    s_add_u32 m0, s29, 69632
    s_add_u32 s30, s25, 128
    buffer_load_dwordx4 v102, s[8:11], s30 offen lds
    s_add_u32 s25, s25, 122880
    s_cmp_eq_u32 s25, s22
    s_cselect_b32 s25, s23, s25
    s_waitcnt vmcnt(8)
    s_barrier
    s_add_u32 m0, s29, 73728
    s_add_u32 s30, s25, 0
    buffer_load_dwordx4 v102, s[8:11], s30 offen lds
    s_add_u32 m0, s29, 77824
    s_add_u32 s30, s25, 128
    buffer_load_dwordx4 v102, s[8:11], s30 offen lds
    s_add_u32 s25, s25, 122880
    s_cmp_eq_u32 s25, s22
    s_cselect_b32 s25, s23, s25
    s_add_u32 m0, s29, 16384
    s_add_u32 s30, s24, 0
    buffer_load_dwordx4 v101, s[4:7], s30 offen lds
    s_add_u32 m0, s29, 20480
    s_add_u32 s30, s24, 40960
    buffer_load_dwordx4 v101, s[4:7], s30 offen lds
    s_add_u32 m0, s29, 24576
    s_add_u32 s30, s24, 81920
    buffer_load_dwordx4 v101, s[4:7], s30 offen lds
    s_add_u32 m0, s29, 28672
    s_add_u32 s30, s24, 122880
    buffer_load_dwordx4 v101, s[4:7], s30 offen lds
    s_add_u32 s24, s24, 128
    s_cmp_eq_u32 s24, s26
    s_cselect_b32 s24, s27, s24
    s_waitcnt vmcnt(12)
    s_barrier
    s_add_u32 m0, s29, 49152
    s_add_u32 s30, s25, 0
    buffer_load_dwordx4 v102, s[8:11], s30 offen lds
    s_add_u32 m0, s29, 53248
    s_add_u32 s30, s25, 128
    buffer_load_dwordx4 v102, s[8:11], s30 offen lds
    s_add_u32 s25, s25, 122880
    s_cmp_eq_u32 s25, s22
    s_cselect_b32 s25, s23, s25
    s_waitcnt vmcnt(8)
    s_barrier
    s_add_u32 m0, s29, 57344
    s_add_u32 s30, s25, 0
    buffer_load_dwordx4 v102, s[8:11], s30 offen lds
    s_add_u32 m0, s29, 61440
    s_add_u32 s30, s25, 128
    buffer_load_dwordx4 v102, s[8:11], s30 offen lds
    s_add_u32 s25, s25, 122880
    s_cmp_eq_u32 s25, s22
    s_cselect_b32 s25, s23, s25
    s_add_u32 m0, s29, 32768
    s_add_u32 s30, s24, 0
    buffer_load_dwordx4 v101, s[4:7], s30 offen lds
    s_add_u32 m0, s29, 36864
    s_add_u32 s30, s24, 40960
    buffer_load_dwordx4 v101, s[4:7], s30 offen lds
    s_add_u32 m0, s29, 40960
    s_add_u32 s30, s24, 81920
    buffer_load_dwordx4 v101, s[4:7], s30 offen lds
    s_add_u32 m0, s29, 45056
    s_add_u32 s30, s24, 122880
    buffer_load_dwordx4 v101, s[4:7], s30 offen lds
    s_add_u32 s24, s24, 128
    s_cmp_eq_u32 s24, s26
    s_cselect_b32 s24, s27, s24
    s_waitcnt vmcnt(12)
    s_barrier
    s_add_u32 m0, s29, 65536
    s_add_u32 s30, s25, 0
    buffer_load_dwordx4 v102, s[8:11], s30 offen lds
    s_add_u32 m0, s29, 69632
    s_add_u32 s30, s25, 128
    buffer_load_dwordx4 v102, s[8:11], s30 offen lds
    s_add_u32 s25, s25, 122880
    s_cmp_eq_u32 s25, s22
    s_cselect_b32 s25, s23, s25
    s_waitcnt vmcnt(8)
    s_barrier
    s_add_u32 m0, s29, 73728
    s_add_u32 s30, s25, 0
    buffer_load_dwordx4 v102, s[8:11], s30 offen lds
    s_add_u32 m0, s29, 77824
    s_add_u32 s30, s25, 128
    buffer_load_dwordx4 v102, s[8:11], s30 offen lds
    s_add_u32 s25, s25, 122880
    s_cmp_eq_u32 s25, s22
    s_cselect_b32 s25, s23, s25
    s_add_u32 m0, s29, 0
    s_add_u32 s30, s24, 0
    buffer_load_dwordx4 v101, s[4:7], s30 offen lds
    s_add_u32 m0, s29, 4096
    s_add_u32 s30, s24, 40960
    buffer_load_dwordx4 v101, s[4:7], s30 offen lds
    s_add_u32 m0, s29, 8192
    s_add_u32 s30, s24, 81920
    buffer_load_dwordx4 v101, s[4:7], s30 offen lds
    s_add_u32 m0, s29, 12288
    s_add_u32 s30, s24, 122880
    buffer_load_dwordx4 v101, s[4:7], s30 offen lds
    s_add_u32 s24, s24, 128
    s_cmp_eq_u32 s24, s26
    s_cselect_b32 s24, s27, s24
    s_waitcnt vmcnt(12)
    s_barrier
    s_add_u32 m0, s29, 49152
    s_add_u32 s30, s25, 0
    buffer_load_dwordx4 v102, s[8:11], s30 offen lds
    s_add_u32 m0, s29, 53248
    s_add_u32 s30, s25, 128
    buffer_load_dwordx4 v102, s[8:11], s30 offen lds
    s_add_u32 s25, s25, 122880
    s_cmp_eq_u32 s25, s22
    s_cselect_b32 s25, s23, s25
    s_waitcnt vmcnt(8)
    s_barrier
    s_add_u32 m0, s29, 57344
    s_add_u32 s30, s25, 0
    buffer_load_dwordx4 v102, s[8:11], s30 offen lds
    s_add_u32 m0, s29, 61440
    s_add_u32 s30, s25, 128
    buffer_load_dwordx4 v102, s[8:11], s30 offen lds
    s_add_u32 s25, s25, 122880
    s_cmp_eq_u32 s25, s22
    s_cselect_b32 s25, s23, s25
    s_add_u32 m0, s29, 16384
    s_add_u32 s30, s24, 0
    buffer_load_dwordx4 v101, s[4:7], s30 offen lds
    s_add_u32 m0, s29, 20480
    s_add_u32 s30, s24, 40960
    buffer_load_dwordx4 v101, s[4:7], s30 offen lds
    s_add_u32 m0, s29, 24576
    s_add_u32 s30, s24, 81920
    buffer_load_dwordx4 v101, s[4:7], s30 offen lds
    s_add_u32 m0, s29, 28672
    s_add_u32 s30, s24, 122880
    buffer_load_dwordx4 v101, s[4:7], s30 offen lds
    s_add_u32 s24, s24, 128
    s_cmp_eq_u32 s24, s26
    s_cselect_b32 s24, s27, s24
    s_waitcnt vmcnt(12)
    s_barrier
    s_add_u32 m0, s29, 65536
    s_add_u32 s30, s25, 0
    buffer_load_dwordx4 v102, s[8:11], s30 offen lds
    s_add_u32 m0, s29, 69632
    s_add_u32 s30, s25, 128
    buffer_load_dwordx4 v102, s[8:11], s30 offen lds
    s_add_u32 s25, s25, 122880
    s_cmp_eq_u32 s25, s22
    s_cselect_b32 s25, s23, s25
    s_mov_b64 exec, 1
    buffer_load_dword v10, v2, s[60:63], 0 offen sc1
    s_mov_b64 exec, -1
    s_waitcnt vmcnt(9)
    s_barrier
    s_add_u32 m0, s29, 73728
    s_add_u32 s30, s25, 0
    buffer_load_dwordx4 v102, s[8:11], s30 offen lds
    s_add_u32 m0, s29, 77824
    s_add_u32 s30, s25, 128
    buffer_load_dwordx4 v102, s[8:11], s30 offen lds
    s_add_u32 s25, s25, 122880
    s_cmp_eq_u32 s25, s22
    s_cselect_b32 s25, s23, s25
    s_add_u32 m0, s29, 32768
    s_add_u32 s30, s24, 0
    buffer_load_dwordx4 v101, s[4:7], s30 offen lds
    s_add_u32 m0, s29, 36864
    s_add_u32 s30, s24, 40960
    buffer_load_dwordx4 v101, s[4:7], s30 offen lds
    s_add_u32 m0, s29, 40960
    s_add_u32 s30, s24, 81920
    buffer_load_dwordx4 v101, s[4:7], s30 offen lds
    s_add_u32 m0, s29, 45056
    s_add_u32 s30, s24, 122880
    buffer_load_dwordx4 v101, s[4:7], s30 offen lds
    s_add_u32 s24, s24, 128
    s_cmp_eq_u32 s24, s26
    s_cselect_b32 s24, s27, s24
    s_waitcnt vmcnt(6)
    s_barrier
    v_readfirstlane_b32 s54, v10
    s_cmp_eq_u32 s54, 1
    s_cbranch_scc1 L_q_zok
    s_mov_b32 s55, 262144
    s_mov_b64 exec, 1
L_poll_zq:
    buffer_load_dword v10, v2, s[60:63], 0 offen sc1
    s_waitcnt vmcnt(0)
    v_cmp_ne_u32 vcc, 1, v10
    s_cbranch_vccz L_got_zq
    s_sleep 4
    s_sub_u32 s55, s55, 1
    s_cbranch_scc0 L_poll_zq
L_got_zq:
    s_mov_b64 exec, -1
L_q_zok:
    s_add_u32 m0, s29, 49152
    s_add_u32 s30, s25, 0
    buffer_load_dwordx4 v102, s[8:11], s30 offen lds
    s_add_u32 m0, s29, 53248
    s_add_u32 s30, s25, 128
    buffer_load_dwordx4 v102, s[8:11], s30 offen lds
    s_add_u32 s25, s25, 122880
    s_cmp_eq_u32 s25, s22
    s_cselect_b32 s25, s23, s25
    s_waitcnt vmcnt(9)
    s_barrier
    s_add_u32 m0, s29, 57344
    s_add_u32 s30, s25, 0
    buffer_load_dwordx4 v102, s[8:11], s30 offen lds
    s_add_u32 m0, s29, 61440
    s_add_u32 s30, s25, 128
    buffer_load_dwordx4 v102, s[8:11], s30 offen lds
    s_add_u32 s25, s25, 122880
    s_cmp_eq_u32 s25, s22
    s_cselect_b32 s25, s23, s25
    s_add_u32 m0, s29, 0
    s_add_u32 s30, s24, 0
    buffer_load_dwordx4 v101, s[4:7], s30 offen lds
    s_add_u32 m0, s29, 4096
    s_add_u32 s30, s24, 40960
    buffer_load_dwordx4 v101, s[4:7], s30 offen lds
    s_add_u32 m0, s29, 8192
    s_add_u32 s30, s24, 81920
    buffer_load_dwordx4 v101, s[4:7], s30 offen lds
    s_add_u32 m0, s29, 12288
    s_add_u32 s30, s24, 122880
    buffer_load_dwordx4 v101, s[4:7], s30 offen lds
    s_add_u32 s24, s24, 128
    s_cmp_eq_u32 s24, s26
    s_cselect_b32 s24, s27, s24
    s_waitcnt vmcnt(12)
    s_barrier
    s_add_u32 m0, s29, 65536
    s_add_u32 s30, s25, 0
    buffer_load_dwordx4 v102, s[8:11], s30 offen lds
    s_add_u32 m0, s29, 69632
    s_add_u32 s30, s25, 128
    buffer_load_dwordx4 v102, s[8:11], s30 offen lds
    s_add_u32 s25, s25, 122880
    s_cmp_eq_u32 s25, s22
    s_cselect_b32 s25, s23, s25
    s_mov_b64 exec, 1
    buffer_load_dword v11, v3, s[44:47], 0 offen sc1
    s_mov_b64 exec, -1
    s_waitcnt vmcnt(9)
    s_barrier
    s_add_u32 m0, s29, 73728
    s_add_u32 s30, s25, 0
    buffer_load_dwordx4 v102, s[8:11], s30 offen lds
    s_add_u32 m0, s29, 77824
    s_add_u32 s30, s25, 128
    buffer_load_dwordx4 v102, s[8:11], s30 offen lds
    s_add_u32 s25, s25, 122880
    s_cmp_eq_u32 s25, s22
    s_cselect_b32 s25, s23, s25
    s_waitcnt vmcnt(2)
    s_barrier
    v_readfirstlane_b32 s54, v11
    s_cmp_eq_u32 s54, 1
    s_cbranch_scc1 L_q_cok
    s_mov_b32 s55, 262144
    s_mov_b64 exec, 1
L_poll_cq:
    buffer_load_dword v11, v3, s[44:47], 0 offen sc1
    s_waitcnt vmcnt(0)
    v_cmp_ne_u32 vcc, 1, v11
    s_cbranch_vccz L_got_cq
    s_sleep 8
    s_sub_u32 s55, s55, 1
    s_cbranch_scc0 L_poll_cq
L_got_cq:
    s_mov_b64 exec, -1
L_q_cok:
    buffer_load_dwordx2 v[4:5], v9, s[48:51], s41 offen sc1
    buffer_load_dwordx2 v[6:7], v9, s[48:51], s42 offen sc1
    s_waitcnt vmcnt(5)
    s_barrier
    s_waitcnt vmcnt(0)
    ds_write_b64 v9, v[4:5] offset:16896
    ds_write_b64 v9, v[6:7] offset:17408
    s_barrier
    s_waitcnt lgkmcnt(0)
    s_barrier
    s_branch L_q_done
L_q_cons:
    s_lshr_b32 s21, s20, 1
    s_and_b32 s22, s20, 1
    v_and_b32 v112, 31, v117
    v_lshrrev_b32 v113, 5, v117
    s_cmp_eq_u32 s28, 15
    s_cbranch_scc1 L_q_skip
    s_lshl_b32 s30, s21, 13
    v_lshl_add_u32 v2, v112, 7, s30
    v_bfe_u32 v3, v117, 1, 3
    v_xor_b32 v3, v3, v113
    v_xor_b32 v1, 0, v3
    v_lshl_add_u32 v96, v1, 4, v2
    v_xor_b32 v1, 2, v3
    v_lshl_add_u32 v97, v1, 4, v2
    v_xor_b32 v1, 4, v3
    v_lshl_add_u32 v98, v1, 4, v2
    v_xor_b32 v1, 6, v3
    v_lshl_add_u32 v99, v1, 4, v2
    v_bfe_u32 v2, v117, 2, 2
    v_lshl_add_u32 v2, v113, 3, v2
    v_lshlrev_b32 v2, 7, v2
    v_bfe_u32 v3, v117, 4, 1
    v_lshlrev_b32 v3, 5, v3
    v_and_b32 v1, 3, v117
    v_lshl_add_u32 v3, v1, 3, v3
    v_bfe_u32 v1, v117, 3, 1
    v_xor_b32 v1, s22, v1
    v_lshl_add_u32 v3, v1, 6, v3
    v_add_u32 v2, v2, v3
    s_lshl_b32 s30, s21, 12
    s_add_u32 s41, s30, 49152
    v_add_u32 v100, s41, v2
    s_xor_b32 s41, s41, 4096
    v_add_u32 v101, s41, v2
    v_lshlrev_b32 v110, 2, v112
    v_lshlrev_b32 v111, 4, v113
    s_lshl_b32 s42, s31, 2
    s_lshl_b32 s43, s21, 1
    s_add_u32 s42, s42, s43
    s_mov_b32 s56, 0x00020001
    s_mov_b32 s57, 0x00020001
    v_mov_b32 v1, 0x3f803f80
    v_cndmask_b32 v102, 0, v1, s[56:57]
    v_cndmask_b32 v103, 0, v1, s[56:57]
    v_cndmask_b32 v104, 0, v1, s[56:57]
    v_cndmask_b32 v105, 0, v1, s[56:57]
    s_lshl_b32 s54, s21, 8
    s_lshl_b32 s55, s22, 7
    s_add_u32 s54, s54, s55
    s_add_u32 s54, s54, 16384
    s_xor_b32 s55, s54, 256
    v_add_u32 v114, s54, v110
    s_lshl_b32 s53, s21, 8
    s_waitcnt lgkmcnt(0)
    s_add_u32 s44, s38, 19988480
    s_addc_u32 s45, s39, 0
    s_mov_b32 s46, 20480
    s_mov_b32 s47, 0x00020000
    s_mov_b32 s60, s36
    s_mov_b32 s61, s37
    s_mov_b32 s62, 256
    s_mov_b32 s63, 0x00020000
    s_cmp_ge_u32 s28, 10
    s_cselect_b64 vcc, -1, 0
    v_cndmask_b32 v1, v111, v110, vcc
    v_add_u32 v115, s54, v1
    v_add_u32 v116, s55, v1
    v_cndmask_b32 v1, v110, v111, vcc
    v_add_u32 v118, s53, v1
    s_cbranch_scc1 L_q_V
    s_cmp_ge_u32 s28, 5
    s_mov_b32 s40, 2621440
    s_cmov_b32 s40, 5242880
    s_mov_b32 s41, 81920
    s_cmov_b32 s41, 163840
    s_mov_b32 s43, 1280
    s_cmov_b32 s43, 2560
    s_cselect_b32 s52, 1.0, 0x3ea52b5c
    s_cselect_b32 s48, 160, 0
    s_mov_b32 s18, 2621440
    s_cmov_b32 s18, 5242880
    s_add_u32 s16, s38, s40
    s_addc_u32 s17, s39, 0
    s_mov_b32 s19, 0x00020000
    s_lshl_b32 s49, s28, 5
    s_sub_u32 s49, s49, s48
    s_lshl_b32 s50, s22, 3
    s_add_u32 s49, s49, s50
    s_lshl_b32 s50, s21, 4
    s_add_u32 s54, s49, s50
    s_xor_b32 s50, s50, 16
    s_add_u32 s55, s49, s50
    s_mul_i32 s50, s42, s43
    s_add_u32 s51, s50, s43
    v_lshlrev_b32 v1, 4, v112
    s_waitcnt vmcnt(0)
    s_add_u32 s30, s54, 0
    v_add_u32 v2, s30, v113
    v_mul_u32_u24 v3, 205, v2
    v_lshrrev_b32 v3, 10, v3
    v_mul_u32_u24 v4, 5, v3
    v_sub_u32 v2, v2, v4
    v_and_b32 v4, 1, v3
    v_sub_u32 v2, v2, v4
    v_min_u32 v2, 4, v2
    v_lshrrev_b32 v4, 2, v2
    v_lshrrev_b32 v4, v4, v1
    v_mad_u32_u24 v4, v3, s41, v4
    v_lshrrev_b32 v3, 1, v2
    v_lshl_add_u32 v4, v3, 9, v4
    v_and_b32 v3, 1, v2
    v_lshl_add_u32 v110, v3, 3, v4
    s_add_u32 s30, s54, 2
    v_add_u32 v2, s30, v113
    v_mul_u32_u24 v3, 205, v2
    v_lshrrev_b32 v3, 10, v3
    v_mul_u32_u24 v4, 5, v3
    v_sub_u32 v2, v2, v4
    v_and_b32 v4, 1, v3
    v_sub_u32 v2, v2, v4
    v_min_u32 v2, 4, v2
    v_lshrrev_b32 v4, 2, v2
    v_lshrrev_b32 v4, v4, v1
    v_mad_u32_u24 v4, v3, s41, v4
    v_lshrrev_b32 v3, 1, v2
    v_lshl_add_u32 v4, v3, 9, v4
    v_and_b32 v3, 1, v2
    v_lshl_add_u32 v111, v3, 3, v4
    s_add_u32 s30, s54, 4
    v_add_u32 v2, s30, v113
    v_mul_u32_u24 v3, 205, v2
    v_lshrrev_b32 v3, 10, v3
    v_mul_u32_u24 v4, 5, v3
    v_sub_u32 v2, v2, v4
    v_and_b32 v4, 1, v3
    v_sub_u32 v2, v2, v4
    v_min_u32 v2, 4, v2
    v_lshrrev_b32 v4, 2, v2
    v_lshrrev_b32 v4, v4, v1
    v_mad_u32_u24 v4, v3, s41, v4
    v_lshrrev_b32 v3, 1, v2
    v_lshl_add_u32 v4, v3, 9, v4
    v_and_b32 v3, 1, v2
    v_lshl_add_u32 v119, v3, 3, v4
    s_add_u32 s30, s54, 6
    v_add_u32 v2, s30, v113
    v_mul_u32_u24 v3, 205, v2
    v_lshrrev_b32 v3, 10, v3
    v_mul_u32_u24 v4, 5, v3
    v_sub_u32 v2, v2, v4
    v_and_b32 v4, 1, v3
    v_sub_u32 v2, v2, v4
    v_min_u32 v2, 4, v2
    v_lshrrev_b32 v4, 2, v2
    v_lshrrev_b32 v4, v4, v1
    v_mad_u32_u24 v4, v3, s41, v4
    v_lshrrev_b32 v3, 1, v2
    v_lshl_add_u32 v4, v3, 9, v4
    v_and_b32 v3, 1, v2
    v_lshl_add_u32 v124, v3, 3, v4
    s_add_u32 s30, s55, 0
    v_add_u32 v2, s30, v113
    v_mul_u32_u24 v3, 205, v2
    v_lshrrev_b32 v3, 10, v3
    v_mul_u32_u24 v4, 5, v3
    v_sub_u32 v2, v2, v4
    v_and_b32 v4, 1, v3
    v_sub_u32 v2, v2, v4
    v_min_u32 v2, 4, v2
    v_lshrrev_b32 v4, 2, v2
    v_lshrrev_b32 v4, v4, v1
    v_mad_u32_u24 v4, v3, s41, v4
    v_lshrrev_b32 v3, 1, v2
    v_lshl_add_u32 v4, v3, 9, v4
    v_and_b32 v3, 1, v2
    v_lshl_add_u32 v125, v3, 3, v4
    s_add_u32 s30, s55, 2
    v_add_u32 v2, s30, v113
    v_mul_u32_u24 v3, 205, v2
    v_lshrrev_b32 v3, 10, v3
    v_mul_u32_u24 v4, 5, v3
    v_sub_u32 v2, v2, v4
    v_and_b32 v4, 1, v3
    v_sub_u32 v2, v2, v4
    v_min_u32 v2, 4, v2
    v_lshrrev_b32 v4, 2, v2
    v_lshrrev_b32 v4, v4, v1
    v_mad_u32_u24 v4, v3, s41, v4
    v_lshrrev_b32 v3, 1, v2
    v_lshl_add_u32 v4, v3, 9, v4
    v_and_b32 v3, 1, v2
    v_lshl_add_u32 v126, v3, 3, v4
    s_add_u32 s30, s55, 4
    v_add_u32 v2, s30, v113
    v_mul_u32_u24 v3, 205, v2
    v_lshrrev_b32 v3, 10, v3
    v_mul_u32_u24 v4, 5, v3
    v_sub_u32 v2, v2, v4
    v_and_b32 v4, 1, v3
    v_sub_u32 v2, v2, v4
    v_min_u32 v2, 4, v2
    v_lshrrev_b32 v4, 2, v2
    v_lshrrev_b32 v4, v4, v1
    v_mad_u32_u24 v4, v3, s41, v4
    v_lshrrev_b32 v3, 1, v2
    v_lshl_add_u32 v4, v3, 9, v4
    v_and_b32 v3, 1, v2
    v_lshl_add_u32 v127, v3, 3, v4
    s_add_u32 s30, s55, 6
    v_add_u32 v2, s30, v113
    v_mul_u32_u24 v3, 205, v2
    v_lshrrev_b32 v3, 10, v3
    v_mul_u32_u24 v4, 5, v3
    v_sub_u32 v2, v2, v4
    v_and_b32 v4, 1, v3
    v_sub_u32 v2, v2, v4
    v_min_u32 v2, 4, v2
    v_lshrrev_b32 v4, 2, v2
    v_lshrrev_b32 v4, v4, v1
    v_mad_u32_u24 v4, v3, s41, v4
    v_lshrrev_b32 v3, 1, v2
    v_lshl_add_u32 v4, v3, 9, v4
    v_and_b32 v3, 1, v2
    v_lshl_add_u32 v117, v3, 3, v4
    s_barrier
    ds_read_b128 v[64:67], v96 offset:0
    ds_read_b128 v[68:71], v96 offset:4096
    ds_read_b64_tr_b16 v[72:73], v100 offset:0
    ds_read_b64_tr_b16 v[74:75], v100 offset:512
    ds_read_b64_tr_b16 v[76:77], v101 offset:0
    ds_read_b64_tr_b16 v[78:79], v101 offset:512
    s_waitcnt lgkmcnt(0)
    ds_read_b128 v[80:83], v97 offset:0
    ds_read_b128 v[84:87], v97 offset:4096
    ds_read_b64_tr_b16 v[88:89], v100 offset:2048
    ds_read_b64_tr_b16 v[90:91], v100 offset:2560
    ds_read_b64_tr_b16 v[92:93], v101 offset:2048
    ds_read_b64_tr_b16 v[94:95], v101 offset:2560
    v_mfma_f32_32x32x16_bf16 v[0:15], v[72:75], v[64:67], 0
    v_mfma_f32_32x32x16_bf16 v[16:31], v[76:79], v[64:67], 0
    v_mfma_f32_32x32x16_bf16 v[32:47], v[72:75], v[68:71], 0
    v_mfma_f32_32x32x16_bf16 v[48:63], v[76:79], v[68:71], 0
    v_mfma_f32_16x16x32_bf16 v[106:109], v[102:105], v[72:75], 0
    s_waitcnt lgkmcnt(0)
    s_barrier
    ds_read_b128 v[64:67], v98 offset:0
    ds_read_b128 v[68:71], v98 offset:4096
    ds_read_b64_tr_b16 v[72:73], v100 offset:8192
    ds_read_b64_tr_b16 v[74:75], v100 offset:8704
    ds_read_b64_tr_b16 v[76:77], v101 offset:8192
    ds_read_b64_tr_b16 v[78:79], v101 offset:8704
    v_mfma_f32_32x32x16_bf16 v[0:15], v[88:91], v[80:83], v[0:15]
    v_mfma_f32_32x32x16_bf16 v[16:31], v[92:95], v[80:83], v[16:31]
    v_mfma_f32_32x32x16_bf16 v[32:47], v[88:91], v[84:87], v[32:47]
    v_mfma_f32_32x32x16_bf16 v[48:63], v[92:95], v[84:87], v[48:63]
    v_mfma_f32_16x16x32_bf16 v[106:109], v[102:105], v[88:91], v[106:109]
    s_waitcnt lgkmcnt(0)
    ds_read_b128 v[80:83], v99 offset:0
    ds_read_b128 v[84:87], v99 offset:4096
    ds_read_b64_tr_b16 v[88:89], v100 offset:10240
    ds_read_b64_tr_b16 v[90:91], v100 offset:10752
    ds_read_b64_tr_b16 v[92:93], v101 offset:10240
    ds_read_b64_tr_b16 v[94:95], v101 offset:10752
    v_mfma_f32_32x32x16_bf16 v[0:15], v[72:75], v[64:67], v[0:15]
    v_mfma_f32_32x32x16_bf16 v[16:31], v[76:79], v[64:67], v[16:31]
    v_mfma_f32_32x32x16_bf16 v[32:47], v[72:75], v[68:71], v[32:47]
    v_mfma_f32_32x32x16_bf16 v[48:63], v[76:79], v[68:71], v[48:63]
    v_mfma_f32_16x16x32_bf16 v[106:109], v[102:105], v[72:75], v[106:109]
    s_waitcnt lgkmcnt(0)
    s_barrier
    ds_read_b128 v[64:67], v96 offset:16384
    ds_read_b128 v[68:71], v96 offset:20480
    ds_read_b64_tr_b16 v[72:73], v100 offset:16384
    ds_read_b64_tr_b16 v[74:75], v100 offset:16896
    ds_read_b64_tr_b16 v[76:77], v101 offset:16384
    ds_read_b64_tr_b16 v[78:79], v101 offset:16896
    v_mfma_f32_32x32x16_bf16 v[0:15], v[88:91], v[80:83], v[0:15]
    v_mfma_f32_32x32x16_bf16 v[16:31], v[92:95], v[80:83], v[16:31]
    v_mfma_f32_32x32x16_bf16 v[32:47], v[88:91], v[84:87], v[32:47]
    v_mfma_f32_32x32x16_bf16 v[48:63], v[92:95], v[84:87], v[48:63]
    v_mfma_f32_16x16x32_bf16 v[106:109], v[102:105], v[88:91], v[106:109]
    s_waitcnt lgkmcnt(0)
    ds_read_b128 v[80:83], v97 offset:16384
    ds_read_b128 v[84:87], v97 offset:20480
    ds_read_b64_tr_b16 v[88:89], v100 offset:18432
    ds_read_b64_tr_b16 v[90:91], v100 offset:18944
    ds_read_b64_tr_b16 v[92:93], v101 offset:18432
    ds_read_b64_tr_b16 v[94:95], v101 offset:18944
    v_mfma_f32_32x32x16_bf16 v[0:15], v[72:75], v[64:67], v[0:15]
    v_mfma_f32_32x32x16_bf16 v[16:31], v[76:79], v[64:67], v[16:31]
    v_mfma_f32_32x32x16_bf16 v[32:47], v[72:75], v[68:71], v[32:47]
    v_mfma_f32_32x32x16_bf16 v[48:63], v[76:79], v[68:71], v[48:63]
    v_mfma_f32_16x16x32_bf16 v[106:109], v[102:105], v[72:75], v[106:109]
    s_waitcnt lgkmcnt(0)
    s_barrier
    ds_read_b128 v[64:67], v98 offset:16384
    ds_read_b128 v[68:71], v98 offset:20480
    ds_read_b64_tr_b16 v[72:73], v100 offset:24576
    ds_read_b64_tr_b16 v[74:75], v100 offset:25088
    ds_read_b64_tr_b16 v[76:77], v101 offset:24576
    ds_read_b64_tr_b16 v[78:79], v101 offset:25088
    v_mfma_f32_32x32x16_bf16 v[0:15], v[88:91], v[80:83], v[0:15]
    v_mfma_f32_32x32x16_bf16 v[16:31], v[92:95], v[80:83], v[16:31]
    v_mfma_f32_32x32x16_bf16 v[32:47], v[88:91], v[84:87], v[32:47]
    v_mfma_f32_32x32x16_bf16 v[48:63], v[92:95], v[84:87], v[48:63]
    v_mfma_f32_16x16x32_bf16 v[106:109], v[102:105], v[88:91], v[106:109]
    s_waitcnt lgkmcnt(0)
    ds_read_b128 v[80:83], v99 offset:16384
    ds_read_b128 v[84:87], v99 offset:20480
    ds_read_b64_tr_b16 v[88:89], v100 offset:26624
    ds_read_b64_tr_b16 v[90:91], v100 offset:27136
    ds_read_b64_tr_b16 v[92:93], v101 offset:26624
    ds_read_b64_tr_b16 v[94:95], v101 offset:27136
    v_mfma_f32_32x32x16_bf16 v[0:15], v[72:75], v[64:67], v[0:15]
    v_mfma_f32_32x32x16_bf16 v[16:31], v[76:79], v[64:67], v[16:31]
    v_mfma_f32_32x32x16_bf16 v[32:47], v[72:75], v[68:71], v[32:47]
    v_mfma_f32_32x32x16_bf16 v[48:63], v[76:79], v[68:71], v[48:63]
    v_mfma_f32_16x16x32_bf16 v[106:109], v[102:105], v[72:75], v[106:109]
    s_waitcnt lgkmcnt(0)
    s_barrier
    ds_read_b128 v[64:67], v96 offset:32768
    ds_read_b128 v[68:71], v96 offset:36864
    ds_read_b64_tr_b16 v[72:73], v100 offset:0
    ds_read_b64_tr_b16 v[74:75], v100 offset:512
    ds_read_b64_tr_b16 v[76:77], v101 offset:0
    ds_read_b64_tr_b16 v[78:79], v101 offset:512
    v_mfma_f32_32x32x16_bf16 v[0:15], v[88:91], v[80:83], v[0:15]
    v_mfma_f32_32x32x16_bf16 v[16:31], v[92:95], v[80:83], v[16:31]
    v_mfma_f32_32x32x16_bf16 v[32:47], v[88:91], v[84:87], v[32:47]
    v_mfma_f32_32x32x16_bf16 v[48:63], v[92:95], v[84:87], v[48:63]
    v_mfma_f32_16x16x32_bf16 v[106:109], v[102:105], v[88:91], v[106:109]
    s_waitcnt lgkmcnt(0)
    ds_read_b128 v[80:83], v97 offset:32768
    ds_read_b128 v[84:87], v97 offset:36864
    ds_read_b64_tr_b16 v[88:89], v100 offset:2048
    ds_read_b64_tr_b16 v[90:91], v100 offset:2560
    ds_read_b64_tr_b16 v[92:93], v101 offset:2048
    ds_read_b64_tr_b16 v[94:95], v101 offset:2560
    v_mfma_f32_32x32x16_bf16 v[0:15], v[72:75], v[64:67], v[0:15]
    v_mfma_f32_32x32x16_bf16 v[16:31], v[76:79], v[64:67], v[16:31]
    v_mfma_f32_32x32x16_bf16 v[32:47], v[72:75], v[68:71], v[32:47]
    v_mfma_f32_32x32x16_bf16 v[48:63], v[76:79], v[68:71], v[48:63]
    v_mfma_f32_16x16x32_bf16 v[106:109], v[102:105], v[72:75], v[106:109]
    s_waitcnt lgkmcnt(0)
    s_barrier
    ds_read_b128 v[64:67], v98 offset:32768
    ds_read_b128 v[68:71], v98 offset:36864
    ds_read_b64_tr_b16 v[72:73], v100 offset:8192
    ds_read_b64_tr_b16 v[74:75], v100 offset:8704
    ds_read_b64_tr_b16 v[76:77], v101 offset:8192
    ds_read_b64_tr_b16 v[78:79], v101 offset:8704
    v_mfma_f32_32x32x16_bf16 v[0:15], v[88:91], v[80:83], v[0:15]
    v_mfma_f32_32x32x16_bf16 v[16:31], v[92:95], v[80:83], v[16:31]
    v_mfma_f32_32x32x16_bf16 v[32:47], v[88:91], v[84:87], v[32:47]
    v_mfma_f32_32x32x16_bf16 v[48:63], v[92:95], v[84:87], v[48:63]
    v_mfma_f32_16x16x32_bf16 v[106:109], v[102:105], v[88:91], v[106:109]
    s_waitcnt lgkmcnt(0)
    ds_read_b128 v[80:83], v99 offset:32768
    ds_read_b128 v[84:87], v99 offset:36864
    ds_read_b64_tr_b16 v[88:89], v100 offset:10240
    ds_read_b64_tr_b16 v[90:91], v100 offset:10752
    ds_read_b64_tr_b16 v[92:93], v101 offset:10240
    ds_read_b64_tr_b16 v[94:95], v101 offset:10752
    v_mfma_f32_32x32x16_bf16 v[0:15], v[72:75], v[64:67], v[0:15]
    v_mfma_f32_32x32x16_bf16 v[16:31], v[76:79], v[64:67], v[16:31]
    v_mfma_f32_32x32x16_bf16 v[32:47], v[72:75], v[68:71], v[32:47]
    v_mfma_f32_32x32x16_bf16 v[48:63], v[76:79], v[68:71], v[48:63]
    v_mfma_f32_16x16x32_bf16 v[106:109], v[102:105], v[72:75], v[106:109]
    s_waitcnt lgkmcnt(0)
    s_barrier
    ds_read_b128 v[64:67], v96 offset:0
    ds_read_b128 v[68:71], v96 offset:4096
    ds_read_b64_tr_b16 v[72:73], v100 offset:16384
    ds_read_b64_tr_b16 v[74:75], v100 offset:16896
    ds_read_b64_tr_b16 v[76:77], v101 offset:16384
    ds_read_b64_tr_b16 v[78:79], v101 offset:16896
    v_mfma_f32_32x32x16_bf16 v[0:15], v[88:91], v[80:83], v[0:15]
    v_mfma_f32_32x32x16_bf16 v[16:31], v[92:95], v[80:83], v[16:31]
    v_mfma_f32_32x32x16_bf16 v[32:47], v[88:91], v[84:87], v[32:47]
    v_mfma_f32_32x32x16_bf16 v[48:63], v[92:95], v[84:87], v[48:63]
    v_mfma_f32_16x16x32_bf16 v[106:109], v[102:105], v[88:91], v[106:109]
    s_waitcnt lgkmcnt(0)
    ds_read_b128 v[80:83], v97 offset:0
    ds_read_b128 v[84:87], v97 offset:4096
    ds_read_b64_tr_b16 v[88:89], v100 offset:18432
    ds_read_b64_tr_b16 v[90:91], v100 offset:18944
    ds_read_b64_tr_b16 v[92:93], v101 offset:18432
    ds_read_b64_tr_b16 v[94:95], v101 offset:18944
    v_mfma_f32_32x32x16_bf16 v[0:15], v[72:75], v[64:67], v[0:15]
    v_mfma_f32_32x32x16_bf16 v[16:31], v[76:79], v[64:67], v[16:31]
    v_mfma_f32_32x32x16_bf16 v[32:47], v[72:75], v[68:71], v[32:47]
    v_mfma_f32_32x32x16_bf16 v[48:63], v[76:79], v[68:71], v[48:63]
    v_mfma_f32_16x16x32_bf16 v[106:109], v[102:105], v[72:75], v[106:109]
    s_waitcnt lgkmcnt(0)
    s_barrier
    ds_read_b128 v[64:67], v98 offset:0
    ds_read_b128 v[68:71], v98 offset:4096
    ds_read_b64_tr_b16 v[72:73], v100 offset:24576
    ds_read_b64_tr_b16 v[74:75], v100 offset:25088
    ds_read_b64_tr_b16 v[76:77], v101 offset:24576
    ds_read_b64_tr_b16 v[78:79], v101 offset:25088
    v_mfma_f32_32x32x16_bf16 v[0:15], v[88:91], v[80:83], v[0:15]
    v_mfma_f32_32x32x16_bf16 v[16:31], v[92:95], v[80:83], v[16:31]
    v_mfma_f32_32x32x16_bf16 v[32:47], v[88:91], v[84:87], v[32:47]
    v_mfma_f32_32x32x16_bf16 v[48:63], v[92:95], v[84:87], v[48:63]
    v_mfma_f32_16x16x32_bf16 v[106:109], v[102:105], v[88:91], v[106:109]
    s_waitcnt lgkmcnt(0)
    ds_read_b128 v[80:83], v99 offset:0
    ds_read_b128 v[84:87], v99 offset:4096
    ds_read_b64_tr_b16 v[88:89], v100 offset:26624
    ds_read_b64_tr_b16 v[90:91], v100 offset:27136
    ds_read_b64_tr_b16 v[92:93], v101 offset:26624
    ds_read_b64_tr_b16 v[94:95], v101 offset:27136
    v_mfma_f32_32x32x16_bf16 v[0:15], v[72:75], v[64:67], v[0:15]
    v_mfma_f32_32x32x16_bf16 v[16:31], v[76:79], v[64:67], v[16:31]
    v_mfma_f32_32x32x16_bf16 v[32:47], v[72:75], v[68:71], v[32:47]
    v_mfma_f32_32x32x16_bf16 v[48:63], v[76:79], v[68:71], v[48:63]
    v_mfma_f32_16x16x32_bf16 v[106:109], v[102:105], v[72:75], v[106:109]
    s_waitcnt lgkmcnt(0)
    s_barrier
    ds_read_b128 v[64:67], v96 offset:16384
    ds_read_b128 v[68:71], v96 offset:20480
    ds_read_b64_tr_b16 v[72:73], v100 offset:0
    ds_read_b64_tr_b16 v[74:75], v100 offset:512
    ds_read_b64_tr_b16 v[76:77], v101 offset:0
    ds_read_b64_tr_b16 v[78:79], v101 offset:512
    v_mfma_f32_32x32x16_bf16 v[0:15], v[88:91], v[80:83], v[0:15]
    v_mfma_f32_32x32x16_bf16 v[16:31], v[92:95], v[80:83], v[16:31]
    v_mfma_f32_32x32x16_bf16 v[32:47], v[88:91], v[84:87], v[32:47]
    v_mfma_f32_32x32x16_bf16 v[48:63], v[92:95], v[84:87], v[48:63]
    v_mfma_f32_16x16x32_bf16 v[106:109], v[102:105], v[88:91], v[106:109]
    s_waitcnt lgkmcnt(0)
    ds_read_b128 v[80:83], v97 offset:16384
    ds_read_b128 v[84:87], v97 offset:20480
    ds_read_b64_tr_b16 v[88:89], v100 offset:2048
    ds_read_b64_tr_b16 v[90:91], v100 offset:2560
    ds_read_b64_tr_b16 v[92:93], v101 offset:2048
    ds_read_b64_tr_b16 v[94:95], v101 offset:2560
    v_mfma_f32_32x32x16_bf16 v[0:15], v[72:75], v[64:67], v[0:15]
    v_mfma_f32_32x32x16_bf16 v[16:31], v[76:79], v[64:67], v[16:31]
    v_mfma_f32_32x32x16_bf16 v[32:47], v[72:75], v[68:71], v[32:47]
    v_mfma_f32_32x32x16_bf16 v[48:63], v[76:79], v[68:71], v[48:63]
    v_mfma_f32_16x16x32_bf16 v[106:109], v[102:105], v[72:75], v[106:109]
    s_waitcnt lgkmcnt(0)
    s_barrier
    ds_read_b128 v[64:67], v98 offset:16384
    ds_read_b128 v[68:71], v98 offset:20480
    ds_read_b64_tr_b16 v[72:73], v100 offset:8192
    ds_read_b64_tr_b16 v[74:75], v100 offset:8704
    ds_read_b64_tr_b16 v[76:77], v101 offset:8192
    ds_read_b64_tr_b16 v[78:79], v101 offset:8704
    v_mfma_f32_32x32x16_bf16 v[0:15], v[88:91], v[80:83], v[0:15]
    v_mfma_f32_32x32x16_bf16 v[16:31], v[92:95], v[80:83], v[16:31]
    v_mfma_f32_32x32x16_bf16 v[32:47], v[88:91], v[84:87], v[32:47]
    v_mfma_f32_32x32x16_bf16 v[48:63], v[92:95], v[84:87], v[48:63]
    v_mfma_f32_16x16x32_bf16 v[106:109], v[102:105], v[88:91], v[106:109]
    s_waitcnt lgkmcnt(0)
    ds_read_b128 v[80:83], v99 offset:16384
    ds_read_b128 v[84:87], v99 offset:20480
    ds_read_b64_tr_b16 v[88:89], v100 offset:10240
    ds_read_b64_tr_b16 v[90:91], v100 offset:10752
    ds_read_b64_tr_b16 v[92:93], v101 offset:10240
    ds_read_b64_tr_b16 v[94:95], v101 offset:10752
    v_mfma_f32_32x32x16_bf16 v[0:15], v[72:75], v[64:67], v[0:15]
    v_mfma_f32_32x32x16_bf16 v[16:31], v[76:79], v[64:67], v[16:31]
    v_mfma_f32_32x32x16_bf16 v[32:47], v[72:75], v[68:71], v[32:47]
    v_mfma_f32_32x32x16_bf16 v[48:63], v[76:79], v[68:71], v[48:63]
    v_mfma_f32_16x16x32_bf16 v[106:109], v[102:105], v[72:75], v[106:109]
    s_waitcnt lgkmcnt(0)
    s_barrier
    ds_read_b128 v[64:67], v96 offset:32768
    ds_read_b128 v[68:71], v96 offset:36864
    ds_read_b64_tr_b16 v[72:73], v100 offset:16384
    ds_read_b64_tr_b16 v[74:75], v100 offset:16896
    ds_read_b64_tr_b16 v[76:77], v101 offset:16384
    ds_read_b64_tr_b16 v[78:79], v101 offset:16896
    v_mfma_f32_32x32x16_bf16 v[0:15], v[88:91], v[80:83], v[0:15]
    v_mfma_f32_32x32x16_bf16 v[16:31], v[92:95], v[80:83], v[16:31]
    v_mfma_f32_32x32x16_bf16 v[32:47], v[88:91], v[84:87], v[32:47]
    v_mfma_f32_32x32x16_bf16 v[48:63], v[92:95], v[84:87], v[48:63]
    v_mfma_f32_16x16x32_bf16 v[106:109], v[102:105], v[88:91], v[106:109]
    s_waitcnt lgkmcnt(0)
    ds_read_b128 v[80:83], v97 offset:32768
    ds_read_b128 v[84:87], v97 offset:36864
    ds_read_b64_tr_b16 v[88:89], v100 offset:18432
    ds_read_b64_tr_b16 v[90:91], v100 offset:18944
    ds_read_b64_tr_b16 v[92:93], v101 offset:18432
    ds_read_b64_tr_b16 v[94:95], v101 offset:18944
    v_mfma_f32_32x32x16_bf16 v[0:15], v[72:75], v[64:67], v[0:15]
    v_mfma_f32_32x32x16_bf16 v[16:31], v[76:79], v[64:67], v[16:31]
    v_mfma_f32_32x32x16_bf16 v[32:47], v[72:75], v[68:71], v[32:47]
    v_mfma_f32_32x32x16_bf16 v[48:63], v[76:79], v[68:71], v[48:63]
    v_mfma_f32_16x16x32_bf16 v[106:109], v[102:105], v[72:75], v[106:109]
    s_waitcnt lgkmcnt(0)
    s_barrier
    ds_read_b128 v[64:67], v98 offset:32768
    ds_read_b128 v[68:71], v98 offset:36864
    ds_read_b64_tr_b16 v[72:73], v100 offset:24576
    ds_read_b64_tr_b16 v[74:75], v100 offset:25088
    ds_read_b64_tr_b16 v[76:77], v101 offset:24576
    ds_read_b64_tr_b16 v[78:79], v101 offset:25088
    v_mfma_f32_32x32x16_bf16 v[0:15], v[88:91], v[80:83], v[0:15]
    v_mfma_f32_32x32x16_bf16 v[16:31], v[92:95], v[80:83], v[16:31]
    v_mfma_f32_32x32x16_bf16 v[32:47], v[88:91], v[84:87], v[32:47]
    v_mfma_f32_32x32x16_bf16 v[48:63], v[92:95], v[84:87], v[48:63]
    v_mfma_f32_16x16x32_bf16 v[106:109], v[102:105], v[88:91], v[106:109]
    s_waitcnt lgkmcnt(0)
    ds_read_b128 v[80:83], v99 offset:32768
    ds_read_b128 v[84:87], v99 offset:36864
    ds_read_b64_tr_b16 v[88:89], v100 offset:26624
    ds_read_b64_tr_b16 v[90:91], v100 offset:27136
    ds_read_b64_tr_b16 v[92:93], v101 offset:26624
    ds_read_b64_tr_b16 v[94:95], v101 offset:27136
    v_mfma_f32_32x32x16_bf16 v[0:15], v[72:75], v[64:67], v[0:15]
    v_mfma_f32_32x32x16_bf16 v[16:31], v[76:79], v[64:67], v[16:31]
    v_mfma_f32_32x32x16_bf16 v[32:47], v[72:75], v[68:71], v[32:47]
    v_mfma_f32_32x32x16_bf16 v[48:63], v[76:79], v[68:71], v[48:63]
    v_mfma_f32_16x16x32_bf16 v[106:109], v[102:105], v[72:75], v[106:109]
    s_waitcnt lgkmcnt(0)
    s_barrier
    ds_read_b128 v[64:67], v96 offset:0
    ds_read_b128 v[68:71], v96 offset:4096
    ds_read_b64_tr_b16 v[72:73], v100 offset:0
    ds_read_b64_tr_b16 v[74:75], v100 offset:512
    ds_read_b64_tr_b16 v[76:77], v101 offset:0
    ds_read_b64_tr_b16 v[78:79], v101 offset:512
    v_mfma_f32_32x32x16_bf16 v[0:15], v[88:91], v[80:83], v[0:15]
    v_mfma_f32_32x32x16_bf16 v[16:31], v[92:95], v[80:83], v[16:31]
    v_mfma_f32_32x32x16_bf16 v[32:47], v[88:91], v[84:87], v[32:47]
    v_mfma_f32_32x32x16_bf16 v[48:63], v[92:95], v[84:87], v[48:63]
    v_mfma_f32_16x16x32_bf16 v[106:109], v[102:105], v[88:91], v[106:109]
    s_waitcnt lgkmcnt(0)
    ds_read_b128 v[80:83], v97 offset:0
    ds_read_b128 v[84:87], v97 offset:4096
    ds_read_b64_tr_b16 v[88:89], v100 offset:2048
    ds_read_b64_tr_b16 v[90:91], v100 offset:2560
    ds_read_b64_tr_b16 v[92:93], v101 offset:2048
    ds_read_b64_tr_b16 v[94:95], v101 offset:2560
    v_mfma_f32_32x32x16_bf16 v[0:15], v[72:75], v[64:67], v[0:15]
    v_mfma_f32_32x32x16_bf16 v[16:31], v[76:79], v[64:67], v[16:31]
    v_mfma_f32_32x32x16_bf16 v[32:47], v[72:75], v[68:71], v[32:47]
    v_mfma_f32_32x32x16_bf16 v[48:63], v[76:79], v[68:71], v[48:63]
    v_mfma_f32_16x16x32_bf16 v[106:109], v[102:105], v[72:75], v[106:109]
    s_waitcnt lgkmcnt(0)
    s_barrier
    ds_read_b128 v[64:67], v98 offset:0
    ds_read_b128 v[68:71], v98 offset:4096
    ds_read_b64_tr_b16 v[72:73], v100 offset:8192
    ds_read_b64_tr_b16 v[74:75], v100 offset:8704
    ds_read_b64_tr_b16 v[76:77], v101 offset:8192
    ds_read_b64_tr_b16 v[78:79], v101 offset:8704
    v_mfma_f32_32x32x16_bf16 v[0:15], v[88:91], v[80:83], v[0:15]
    v_mfma_f32_32x32x16_bf16 v[16:31], v[92:95], v[80:83], v[16:31]
    v_mfma_f32_32x32x16_bf16 v[32:47], v[88:91], v[84:87], v[32:47]
    v_mfma_f32_32x32x16_bf16 v[48:63], v[92:95], v[84:87], v[48:63]
    v_mfma_f32_16x16x32_bf16 v[106:109], v[102:105], v[88:91], v[106:109]
    s_waitcnt lgkmcnt(0)
    ds_read_b128 v[80:83], v99 offset:0
    ds_read_b128 v[84:87], v99 offset:4096
    ds_read_b64_tr_b16 v[88:89], v100 offset:10240
    ds_read_b64_tr_b16 v[90:91], v100 offset:10752
    ds_read_b64_tr_b16 v[92:93], v101 offset:10240
    ds_read_b64_tr_b16 v[94:95], v101 offset:10752
    v_mfma_f32_32x32x16_bf16 v[0:15], v[72:75], v[64:67], v[0:15]
    v_mfma_f32_32x32x16_bf16 v[16:31], v[76:79], v[64:67], v[16:31]
    v_mfma_f32_32x32x16_bf16 v[32:47], v[72:75], v[68:71], v[32:47]
    v_mfma_f32_32x32x16_bf16 v[48:63], v[76:79], v[68:71], v[48:63]
    v_mfma_f32_16x16x32_bf16 v[106:109], v[102:105], v[72:75], v[106:109]
    s_waitcnt lgkmcnt(0)
    s_barrier
    ds_read_b128 v[64:67], v96 offset:16384
    ds_read_b128 v[68:71], v96 offset:20480
    ds_read_b64_tr_b16 v[72:73], v100 offset:16384
    ds_read_b64_tr_b16 v[74:75], v100 offset:16896
    ds_read_b64_tr_b16 v[76:77], v101 offset:16384
    ds_read_b64_tr_b16 v[78:79], v101 offset:16896
    v_mfma_f32_32x32x16_bf16 v[0:15], v[88:91], v[80:83], v[0:15]
    v_mfma_f32_32x32x16_bf16 v[16:31], v[92:95], v[80:83], v[16:31]
    v_mfma_f32_32x32x16_bf16 v[32:47], v[88:91], v[84:87], v[32:47]
    v_mfma_f32_32x32x16_bf16 v[48:63], v[92:95], v[84:87], v[48:63]
    v_mfma_f32_16x16x32_bf16 v[106:109], v[102:105], v[88:91], v[106:109]
    s_waitcnt lgkmcnt(0)
    ds_read_b128 v[80:83], v97 offset:16384
    ds_read_b128 v[84:87], v97 offset:20480
    ds_read_b64_tr_b16 v[88:89], v100 offset:18432
    ds_read_b64_tr_b16 v[90:91], v100 offset:18944
    ds_read_b64_tr_b16 v[92:93], v101 offset:18432
    ds_read_b64_tr_b16 v[94:95], v101 offset:18944
    v_mfma_f32_32x32x16_bf16 v[0:15], v[72:75], v[64:67], v[0:15]
    v_mfma_f32_32x32x16_bf16 v[16:31], v[76:79], v[64:67], v[16:31]
    v_mfma_f32_32x32x16_bf16 v[32:47], v[72:75], v[68:71], v[32:47]
    v_mfma_f32_32x32x16_bf16 v[48:63], v[76:79], v[68:71], v[48:63]
    v_mfma_f32_16x16x32_bf16 v[106:109], v[102:105], v[72:75], v[106:109]
    s_waitcnt lgkmcnt(0)
    s_barrier
    ds_read_b128 v[64:67], v98 offset:16384
    ds_read_b128 v[68:71], v98 offset:20480
    ds_read_b64_tr_b16 v[72:73], v100 offset:24576
    ds_read_b64_tr_b16 v[74:75], v100 offset:25088
    ds_read_b64_tr_b16 v[76:77], v101 offset:24576
    ds_read_b64_tr_b16 v[78:79], v101 offset:25088
    v_mfma_f32_32x32x16_bf16 v[0:15], v[88:91], v[80:83], v[0:15]
    v_mfma_f32_32x32x16_bf16 v[16:31], v[92:95], v[80:83], v[16:31]
    v_mfma_f32_32x32x16_bf16 v[32:47], v[88:91], v[84:87], v[32:47]
    v_mfma_f32_32x32x16_bf16 v[48:63], v[92:95], v[84:87], v[48:63]
    v_mfma_f32_16x16x32_bf16 v[106:109], v[102:105], v[88:91], v[106:109]
    s_waitcnt lgkmcnt(0)
    ds_read_b128 v[80:83], v99 offset:16384
    ds_read_b128 v[84:87], v99 offset:20480
    ds_read_b64_tr_b16 v[88:89], v100 offset:26624
    ds_read_b64_tr_b16 v[90:91], v100 offset:27136
    ds_read_b64_tr_b16 v[92:93], v101 offset:26624
    ds_read_b64_tr_b16 v[94:95], v101 offset:27136
    v_mfma_f32_32x32x16_bf16 v[0:15], v[72:75], v[64:67], v[0:15]
    v_mfma_f32_32x32x16_bf16 v[16:31], v[76:79], v[64:67], v[16:31]
    v_mfma_f32_32x32x16_bf16 v[32:47], v[72:75], v[68:71], v[32:47]
    v_mfma_f32_32x32x16_bf16 v[48:63], v[76:79], v[68:71], v[48:63]
    v_mfma_f32_16x16x32_bf16 v[106:109], v[102:105], v[72:75], v[106:109]
    s_waitcnt lgkmcnt(0)
    s_barrier
    ds_read_b128 v[64:67], v96 offset:32768
    ds_read_b128 v[68:71], v96 offset:36864
    ds_read_b64_tr_b16 v[72:73], v100 offset:0
    ds_read_b64_tr_b16 v[74:75], v100 offset:512
    ds_read_b64_tr_b16 v[76:77], v101 offset:0
    ds_read_b64_tr_b16 v[78:79], v101 offset:512
    v_mfma_f32_32x32x16_bf16 v[0:15], v[88:91], v[80:83], v[0:15]
    v_mfma_f32_32x32x16_bf16 v[16:31], v[92:95], v[80:83], v[16:31]
    v_mfma_f32_32x32x16_bf16 v[32:47], v[88:91], v[84:87], v[32:47]
    v_mfma_f32_32x32x16_bf16 v[48:63], v[92:95], v[84:87], v[48:63]
    v_mfma_f32_16x16x32_bf16 v[106:109], v[102:105], v[88:91], v[106:109]
    s_waitcnt lgkmcnt(0)
    ds_read_b128 v[80:83], v97 offset:32768
    ds_read_b128 v[84:87], v97 offset:36864
    ds_read_b64_tr_b16 v[88:89], v100 offset:2048
    ds_read_b64_tr_b16 v[90:91], v100 offset:2560
    ds_read_b64_tr_b16 v[92:93], v101 offset:2048
    ds_read_b64_tr_b16 v[94:95], v101 offset:2560
    v_mfma_f32_32x32x16_bf16 v[0:15], v[72:75], v[64:67], v[0:15]
    v_mfma_f32_32x32x16_bf16 v[16:31], v[76:79], v[64:67], v[16:31]
    v_mfma_f32_32x32x16_bf16 v[32:47], v[72:75], v[68:71], v[32:47]
    v_mfma_f32_32x32x16_bf16 v[48:63], v[76:79], v[68:71], v[48:63]
    v_mfma_f32_16x16x32_bf16 v[106:109], v[102:105], v[72:75], v[106:109]
    s_waitcnt lgkmcnt(0)
    s_barrier
    ds_read_b128 v[64:67], v98 offset:32768
    ds_read_b128 v[68:71], v98 offset:36864
    ds_read_b64_tr_b16 v[72:73], v100 offset:8192
    ds_read_b64_tr_b16 v[74:75], v100 offset:8704
    ds_read_b64_tr_b16 v[76:77], v101 offset:8192
    ds_read_b64_tr_b16 v[78:79], v101 offset:8704
    v_mfma_f32_32x32x16_bf16 v[0:15], v[88:91], v[80:83], v[0:15]
    v_mfma_f32_32x32x16_bf16 v[16:31], v[92:95], v[80:83], v[16:31]
    v_mfma_f32_32x32x16_bf16 v[32:47], v[88:91], v[84:87], v[32:47]
    v_mfma_f32_32x32x16_bf16 v[48:63], v[92:95], v[84:87], v[48:63]
    v_mfma_f32_16x16x32_bf16 v[106:109], v[102:105], v[88:91], v[106:109]
    s_waitcnt lgkmcnt(0)
    ds_read_b128 v[80:83], v99 offset:32768
    ds_read_b128 v[84:87], v99 offset:36864
    ds_read_b64_tr_b16 v[88:89], v100 offset:10240
    ds_read_b64_tr_b16 v[90:91], v100 offset:10752
    ds_read_b64_tr_b16 v[92:93], v101 offset:10240
    ds_read_b64_tr_b16 v[94:95], v101 offset:10752
    v_mfma_f32_32x32x16_bf16 v[0:15], v[72:75], v[64:67], v[0:15]
    v_mfma_f32_32x32x16_bf16 v[16:31], v[76:79], v[64:67], v[16:31]
    v_mfma_f32_32x32x16_bf16 v[32:47], v[72:75], v[68:71], v[32:47]
    v_mfma_f32_32x32x16_bf16 v[48:63], v[76:79], v[68:71], v[48:63]
    v_mfma_f32_16x16x32_bf16 v[106:109], v[102:105], v[72:75], v[106:109]
    s_waitcnt lgkmcnt(0)
    s_barrier
    ds_read_b128 v[64:67], v96 offset:0
    ds_read_b128 v[68:71], v96 offset:4096
    ds_read_b64_tr_b16 v[72:73], v100 offset:16384
    ds_read_b64_tr_b16 v[74:75], v100 offset:16896
    ds_read_b64_tr_b16 v[76:77], v101 offset:16384
    ds_read_b64_tr_b16 v[78:79], v101 offset:16896
    v_mfma_f32_32x32x16_bf16 v[0:15], v[88:91], v[80:83], v[0:15]
    v_mfma_f32_32x32x16_bf16 v[16:31], v[92:95], v[80:83], v[16:31]
    v_mfma_f32_32x32x16_bf16 v[32:47], v[88:91], v[84:87], v[32:47]
    v_mfma_f32_32x32x16_bf16 v[48:63], v[92:95], v[84:87], v[48:63]
    v_mfma_f32_16x16x32_bf16 v[106:109], v[102:105], v[88:91], v[106:109]
    s_waitcnt lgkmcnt(0)
    ds_read_b128 v[80:83], v97 offset:0
    ds_read_b128 v[84:87], v97 offset:4096
    ds_read_b64_tr_b16 v[88:89], v100 offset:18432
    ds_read_b64_tr_b16 v[90:91], v100 offset:18944
    ds_read_b64_tr_b16 v[92:93], v101 offset:18432
    ds_read_b64_tr_b16 v[94:95], v101 offset:18944
    v_mfma_f32_32x32x16_bf16 v[0:15], v[72:75], v[64:67], v[0:15]
    v_mfma_f32_32x32x16_bf16 v[16:31], v[76:79], v[64:67], v[16:31]
    v_mfma_f32_32x32x16_bf16 v[32:47], v[72:75], v[68:71], v[32:47]
    v_mfma_f32_32x32x16_bf16 v[48:63], v[76:79], v[68:71], v[48:63]
    v_mfma_f32_16x16x32_bf16 v[106:109], v[102:105], v[72:75], v[106:109]
    s_waitcnt lgkmcnt(0)
    s_barrier
    ds_read_b128 v[64:67], v98 offset:0
    ds_read_b128 v[68:71], v98 offset:4096
    ds_read_b64_tr_b16 v[72:73], v100 offset:24576
    ds_read_b64_tr_b16 v[74:75], v100 offset:25088
    ds_read_b64_tr_b16 v[76:77], v101 offset:24576
    ds_read_b64_tr_b16 v[78:79], v101 offset:25088
    v_mfma_f32_32x32x16_bf16 v[0:15], v[88:91], v[80:83], v[0:15]
    v_mfma_f32_32x32x16_bf16 v[16:31], v[92:95], v[80:83], v[16:31]
    v_mfma_f32_32x32x16_bf16 v[32:47], v[88:91], v[84:87], v[32:47]
    v_mfma_f32_32x32x16_bf16 v[48:63], v[92:95], v[84:87], v[48:63]
    v_mfma_f32_16x16x32_bf16 v[106:109], v[102:105], v[88:91], v[106:109]
    s_waitcnt lgkmcnt(0)
    ds_read_b128 v[80:83], v99 offset:0
    ds_read_b128 v[84:87], v99 offset:4096
    ds_read_b64_tr_b16 v[88:89], v100 offset:26624
    ds_read_b64_tr_b16 v[90:91], v100 offset:27136
    ds_read_b64_tr_b16 v[92:93], v101 offset:26624
    ds_read_b64_tr_b16 v[94:95], v101 offset:27136
    v_mfma_f32_32x32x16_bf16 v[0:15], v[72:75], v[64:67], v[0:15]
    v_mfma_f32_32x32x16_bf16 v[16:31], v[76:79], v[64:67], v[16:31]
    v_mfma_f32_32x32x16_bf16 v[32:47], v[72:75], v[68:71], v[32:47]
    v_mfma_f32_32x32x16_bf16 v[48:63], v[76:79], v[68:71], v[48:63]
    v_mfma_f32_16x16x32_bf16 v[106:109], v[102:105], v[72:75], v[106:109]
    s_waitcnt lgkmcnt(0)
    v_mfma_f32_32x32x16_bf16 v[0:15], v[88:91], v[80:83], v[0:15]
    v_mfma_f32_32x32x16_bf16 v[16:31], v[92:95], v[80:83], v[16:31]
    v_mfma_f32_32x32x16_bf16 v[32:47], v[88:91], v[84:87], v[32:47]
    v_mfma_f32_32x32x16_bf16 v[48:63], v[92:95], v[84:87], v[48:63]
    v_mfma_f32_16x16x32_bf16 v[106:109], v[102:105], v[88:91], v[106:109]
    s_nop 7
    s_mov_b64 exec, 0xffff
    ds_write2_b32 v114, v106, v107 offset0:0 offset1:16
    s_mov_b64 exec, -1
    s_waitcnt lgkmcnt(0)
    s_barrier
    ds_read_b32 v120, v118 offset:16896
    ds_read_b32 v96, v118 offset:17408
    ds_read_b32 v122, v118 offset:17024
    ds_read_b32 v98, v118 offset:17536
    ds_read_b128 v[64:67], v115 offset:0
    ds_read_b128 v[68:71], v115 offset:32
    ds_read_b128 v[72:75], v115 offset:64
    ds_read_b128 v[76:79], v115 offset:96
    ds_read_b128 v[80:83], v116 offset:0
    ds_read_b128 v[84:87], v116 offset:32
    ds_read_b128 v[88:91], v116 offset:64
    ds_read_b128 v[92:95], v116 offset:96
    s_waitcnt lgkmcnt(8)
    v_mul_f32 v96, s52, v96
    v_mul_f32 v98, s52, v98
    s_waitcnt lgkmcnt(7)
    v_pk_fma_f32 v[0:1], v[120:121], v[64:65], v[0:1] op_sel_hi:[0,1,1] neg_lo:[1,0,0] neg_hi:[1,0,0]
    v_pk_fma_f32 v[2:3], v[120:121], v[66:67], v[2:3] op_sel_hi:[0,1,1] neg_lo:[1,0,0] neg_hi:[1,0,0]
    v_pk_mul_f32 v[0:1], v[96:97], v[0:1] op_sel_hi:[0,1]
    v_pk_mul_f32 v[2:3], v[96:97], v[2:3] op_sel_hi:[0,1]
    v_cvt_pk_bf16_f32 v102, v0, v1
    v_cvt_pk_bf16_f32 v103, v2, v3
    buffer_store_dwordx2 v[102:103], v110, s[16:19], s50 offen sc1
    v_pk_fma_f32 v[32:33], v[122:123], v[64:65], v[32:33] op_sel_hi:[0,1,1] neg_lo:[1,0,0] neg_hi:[1,0,0]
    v_pk_fma_f32 v[34:35], v[122:123], v[66:67], v[34:35] op_sel_hi:[0,1,1] neg_lo:[1,0,0] neg_hi:[1,0,0]
    v_pk_mul_f32 v[32:33], v[98:99], v[32:33] op_sel_hi:[0,1]
    v_pk_mul_f32 v[34:35], v[98:99], v[34:35] op_sel_hi:[0,1]
    v_cvt_pk_bf16_f32 v104, v32, v33
    v_cvt_pk_bf16_f32 v105, v34, v35
    buffer_store_dwordx2 v[104:105], v110, s[16:19], s51 offen sc1
    s_waitcnt lgkmcnt(6)
    v_pk_fma_f32 v[4:5], v[120:121], v[68:69], v[4:5] op_sel_hi:[0,1,1] neg_lo:[1,0,0] neg_hi:[1,0,0]
    v_pk_fma_f32 v[6:7], v[120:121], v[70:71], v[6:7] op_sel_hi:[0,1,1] neg_lo:[1,0,0] neg_hi:[1,0,0]
    v_pk_mul_f32 v[4:5], v[96:97], v[4:5] op_sel_hi:[0,1]
    v_pk_mul_f32 v[6:7], v[96:97], v[6:7] op_sel_hi:[0,1]
    v_cvt_pk_bf16_f32 v102, v4, v5
    v_cvt_pk_bf16_f32 v103, v6, v7
    buffer_store_dwordx2 v[102:103], v111, s[16:19], s50 offen sc1
    v_pk_fma_f32 v[36:37], v[122:123], v[68:69], v[36:37] op_sel_hi:[0,1,1] neg_lo:[1,0,0] neg_hi:[1,0,0]
    v_pk_fma_f32 v[38:39], v[122:123], v[70:71], v[38:39] op_sel_hi:[0,1,1] neg_lo:[1,0,0] neg_hi:[1,0,0]
    v_pk_mul_f32 v[36:37], v[98:99], v[36:37] op_sel_hi:[0,1]
    v_pk_mul_f32 v[38:39], v[98:99], v[38:39] op_sel_hi:[0,1]
    v_cvt_pk_bf16_f32 v104, v36, v37
    v_cvt_pk_bf16_f32 v105, v38, v39
    buffer_store_dwordx2 v[104:105], v111, s[16:19], s51 offen sc1
    s_waitcnt lgkmcnt(5)
    v_pk_fma_f32 v[8:9], v[120:121], v[72:73], v[8:9] op_sel_hi:[0,1,1] neg_lo:[1,0,0] neg_hi:[1,0,0]
    v_pk_fma_f32 v[10:11], v[120:121], v[74:75], v[10:11] op_sel_hi:[0,1,1] neg_lo:[1,0,0] neg_hi:[1,0,0]
    v_pk_mul_f32 v[8:9], v[96:97], v[8:9] op_sel_hi:[0,1]
    v_pk_mul_f32 v[10:11], v[96:97], v[10:11] op_sel_hi:[0,1]
    v_cvt_pk_bf16_f32 v102, v8, v9
    v_cvt_pk_bf16_f32 v103, v10, v11
    buffer_store_dwordx2 v[102:103], v119, s[16:19], s50 offen sc1
    v_pk_fma_f32 v[40:41], v[122:123], v[72:73], v[40:41] op_sel_hi:[0,1,1] neg_lo:[1,0,0] neg_hi:[1,0,0]
    v_pk_fma_f32 v[42:43], v[122:123], v[74:75], v[42:43] op_sel_hi:[0,1,1] neg_lo:[1,0,0] neg_hi:[1,0,0]
    v_pk_mul_f32 v[40:41], v[98:99], v[40:41] op_sel_hi:[0,1]
    v_pk_mul_f32 v[42:43], v[98:99], v[42:43] op_sel_hi:[0,1]
    v_cvt_pk_bf16_f32 v104, v40, v41
    v_cvt_pk_bf16_f32 v105, v42, v43
    buffer_store_dwordx2 v[104:105], v119, s[16:19], s51 offen sc1
    s_waitcnt lgkmcnt(4)
    v_pk_fma_f32 v[12:13], v[120:121], v[76:77], v[12:13] op_sel_hi:[0,1,1] neg_lo:[1,0,0] neg_hi:[1,0,0]
    v_pk_fma_f32 v[14:15], v[120:121], v[78:79], v[14:15] op_sel_hi:[0,1,1] neg_lo:[1,0,0] neg_hi:[1,0,0]
    v_pk_mul_f32 v[12:13], v[96:97], v[12:13] op_sel_hi:[0,1]
    v_pk_mul_f32 v[14:15], v[96:97], v[14:15] op_sel_hi:[0,1]
    v_cvt_pk_bf16_f32 v102, v12, v13
    v_cvt_pk_bf16_f32 v103, v14, v15
    buffer_store_dwordx2 v[102:103], v124, s[16:19], s50 offen sc1
    v_pk_fma_f32 v[44:45], v[122:123], v[76:77], v[44:45] op_sel_hi:[0,1,1] neg_lo:[1,0,0] neg_hi:[1,0,0]
    v_pk_fma_f32 v[46:47], v[122:123], v[78:79], v[46:47] op_sel_hi:[0,1,1] neg_lo:[1,0,0] neg_hi:[1,0,0]
    v_pk_mul_f32 v[44:45], v[98:99], v[44:45] op_sel_hi:[0,1]
    v_pk_mul_f32 v[46:47], v[98:99], v[46:47] op_sel_hi:[0,1]
    v_cvt_pk_bf16_f32 v104, v44, v45
    v_cvt_pk_bf16_f32 v105, v46, v47
    buffer_store_dwordx2 v[104:105], v124, s[16:19], s51 offen sc1
    s_waitcnt lgkmcnt(3)
    v_pk_fma_f32 v[16:17], v[120:121], v[80:81], v[16:17] op_sel_hi:[0,1,1] neg_lo:[1,0,0] neg_hi:[1,0,0]
    v_pk_fma_f32 v[18:19], v[120:121], v[82:83], v[18:19] op_sel_hi:[0,1,1] neg_lo:[1,0,0] neg_hi:[1,0,0]
    v_pk_mul_f32 v[16:17], v[96:97], v[16:17] op_sel_hi:[0,1]
    v_pk_mul_f32 v[18:19], v[96:97], v[18:19] op_sel_hi:[0,1]
    v_cvt_pk_bf16_f32 v102, v16, v17
    v_cvt_pk_bf16_f32 v103, v18, v19
    buffer_store_dwordx2 v[102:103], v125, s[16:19], s50 offen sc1
    v_pk_fma_f32 v[48:49], v[122:123], v[80:81], v[48:49] op_sel_hi:[0,1,1] neg_lo:[1,0,0] neg_hi:[1,0,0]
    v_pk_fma_f32 v[50:51], v[122:123], v[82:83], v[50:51] op_sel_hi:[0,1,1] neg_lo:[1,0,0] neg_hi:[1,0,0]
    v_pk_mul_f32 v[48:49], v[98:99], v[48:49] op_sel_hi:[0,1]
    v_pk_mul_f32 v[50:51], v[98:99], v[50:51] op_sel_hi:[0,1]
    v_cvt_pk_bf16_f32 v104, v48, v49
    v_cvt_pk_bf16_f32 v105, v50, v51
    buffer_store_dwordx2 v[104:105], v125, s[16:19], s51 offen sc1
    s_waitcnt lgkmcnt(2)
    v_pk_fma_f32 v[20:21], v[120:121], v[84:85], v[20:21] op_sel_hi:[0,1,1] neg_lo:[1,0,0] neg_hi:[1,0,0]
    v_pk_fma_f32 v[22:23], v[120:121], v[86:87], v[22:23] op_sel_hi:[0,1,1] neg_lo:[1,0,0] neg_hi:[1,0,0]
    v_pk_mul_f32 v[20:21], v[96:97], v[20:21] op_sel_hi:[0,1]
    v_pk_mul_f32 v[22:23], v[96:97], v[22:23] op_sel_hi:[0,1]
    v_cvt_pk_bf16_f32 v102, v20, v21
    v_cvt_pk_bf16_f32 v103, v22, v23
    buffer_store_dwordx2 v[102:103], v126, s[16:19], s50 offen sc1
    v_pk_fma_f32 v[52:53], v[122:123], v[84:85], v[52:53] op_sel_hi:[0,1,1] neg_lo:[1,0,0] neg_hi:[1,0,0]
    v_pk_fma_f32 v[54:55], v[122:123], v[86:87], v[54:55] op_sel_hi:[0,1,1] neg_lo:[1,0,0] neg_hi:[1,0,0]
    v_pk_mul_f32 v[52:53], v[98:99], v[52:53] op_sel_hi:[0,1]
    v_pk_mul_f32 v[54:55], v[98:99], v[54:55] op_sel_hi:[0,1]
    v_cvt_pk_bf16_f32 v104, v52, v53
    v_cvt_pk_bf16_f32 v105, v54, v55
    buffer_store_dwordx2 v[104:105], v126, s[16:19], s51 offen sc1
    s_waitcnt lgkmcnt(1)
    v_pk_fma_f32 v[24:25], v[120:121], v[88:89], v[24:25] op_sel_hi:[0,1,1] neg_lo:[1,0,0] neg_hi:[1,0,0]
    v_pk_fma_f32 v[26:27], v[120:121], v[90:91], v[26:27] op_sel_hi:[0,1,1] neg_lo:[1,0,0] neg_hi:[1,0,0]
    v_pk_mul_f32 v[24:25], v[96:97], v[24:25] op_sel_hi:[0,1]
    v_pk_mul_f32 v[26:27], v[96:97], v[26:27] op_sel_hi:[0,1]
    v_cvt_pk_bf16_f32 v102, v24, v25
    v_cvt_pk_bf16_f32 v103, v26, v27
    buffer_store_dwordx2 v[102:103], v127, s[16:19], s50 offen sc1
    v_pk_fma_f32 v[56:57], v[122:123], v[88:89], v[56:57] op_sel_hi:[0,1,1] neg_lo:[1,0,0] neg_hi:[1,0,0]
    v_pk_fma_f32 v[58:59], v[122:123], v[90:91], v[58:59] op_sel_hi:[0,1,1] neg_lo:[1,0,0] neg_hi:[1,0,0]
    v_pk_mul_f32 v[56:57], v[98:99], v[56:57] op_sel_hi:[0,1]
    v_pk_mul_f32 v[58:59], v[98:99], v[58:59] op_sel_hi:[0,1]
    v_cvt_pk_bf16_f32 v104, v56, v57
    v_cvt_pk_bf16_f32 v105, v58, v59
    buffer_store_dwordx2 v[104:105], v127, s[16:19], s51 offen sc1
    s_waitcnt lgkmcnt(0)
    v_pk_fma_f32 v[28:29], v[120:121], v[92:93], v[28:29] op_sel_hi:[0,1,1] neg_lo:[1,0,0] neg_hi:[1,0,0]
    v_pk_fma_f32 v[30:31], v[120:121], v[94:95], v[30:31] op_sel_hi:[0,1,1] neg_lo:[1,0,0] neg_hi:[1,0,0]
    v_pk_mul_f32 v[28:29], v[96:97], v[28:29] op_sel_hi:[0,1]
    v_pk_mul_f32 v[30:31], v[96:97], v[30:31] op_sel_hi:[0,1]
    v_cvt_pk_bf16_f32 v102, v28, v29
    v_cvt_pk_bf16_f32 v103, v30, v31
    buffer_store_dwordx2 v[102:103], v117, s[16:19], s50 offen sc1
    v_pk_fma_f32 v[60:61], v[122:123], v[92:93], v[60:61] op_sel_hi:[0,1,1] neg_lo:[1,0,0] neg_hi:[1,0,0]
    v_pk_fma_f32 v[62:63], v[122:123], v[94:95], v[62:63] op_sel_hi:[0,1,1] neg_lo:[1,0,0] neg_hi:[1,0,0]
    v_pk_mul_f32 v[60:61], v[98:99], v[60:61] op_sel_hi:[0,1]
    v_pk_mul_f32 v[62:63], v[98:99], v[62:63] op_sel_hi:[0,1]
    v_cvt_pk_bf16_f32 v104, v60, v61
    v_cvt_pk_bf16_f32 v105, v62, v63
    buffer_store_dwordx2 v[104:105], v117, s[16:19], s51 offen sc1
    s_branch L_q_done
L_q_V:
    s_add_u32 s16, s38, 5242880
    s_addc_u32 s17, s39, 0
    s_mov_b32 s18, 5242880
    s_mov_b32 s19, 0x00020000
    s_lshl_b32 s49, s28, 7
    s_sub_u32 s49, s49, 1280
    s_lshl_b32 s50, s22, 5
    s_add_u32 s49, s49, s50
    s_lshl_b32 s50, s21, 6
    s_add_u32 s54, s49, s50
    s_xor_b32 s50, s50, 64
    s_add_u32 s55, s49, s50
    s_mul_i32 s50, s42, 2560
    s_add_u32 s51, s50, 2560
    s_mov_b32 s41, 163840
    v_mul_u32_u24 v1, 320, v113
    v_add_u32 v2, s54, v112
    v_mul_u32_u24 v3, 3277, v2
    v_lshrrev_b32 v3, 16, v3
    v_mul_u32_u24 v4, 20, v3
    v_sub_u32 v2, v2, v4
    v_lshl_add_u32 v4, v2, 4, v1
    v_mad_u32_u24 v110, v3, s41, v4
    v_add_u32 v2, s55, v112
    v_mul_u32_u24 v3, 3277, v2
    v_lshrrev_b32 v3, 16, v3
    v_mul_u32_u24 v4, 20, v3
    v_sub_u32 v2, v2, v4
    v_lshl_add_u32 v4, v2, 4, v1
    v_mad_u32_u24 v111, v3, s41, v4
    s_barrier
    ds_read_b128 v[64:67], v96 offset:0
    ds_read_b128 v[68:71], v96 offset:4096
    ds_read_b64_tr_b16 v[72:73], v100 offset:0
    ds_read_b64_tr_b16 v[74:75], v100 offset:512
    ds_read_b64_tr_b16 v[76:77], v101 offset:0
    ds_read_b64_tr_b16 v[78:79], v101 offset:512
    s_waitcnt lgkmcnt(0)
    ds_read_b128 v[80:83], v97 offset:0
    ds_read_b128 v[84:87], v97 offset:4096
    ds_read_b64_tr_b16 v[88:89], v100 offset:2048
    ds_read_b64_tr_b16 v[90:91], v100 offset:2560
    ds_read_b64_tr_b16 v[92:93], v101 offset:2048
    ds_read_b64_tr_b16 v[94:95], v101 offset:2560
    v_mfma_f32_32x32x16_bf16 v[0:15], v[64:67], v[72:75], 0
    v_mfma_f32_32x32x16_bf16 v[16:31], v[64:67], v[76:79], 0
    v_mfma_f32_32x32x16_bf16 v[32:47], v[68:71], v[72:75], 0
    v_mfma_f32_32x32x16_bf16 v[48:63], v[68:71], v[76:79], 0
    v_mfma_f32_16x16x32_bf16 v[106:109], v[102:105], v[72:75], 0
    s_waitcnt lgkmcnt(0)
    s_barrier
    ds_read_b128 v[64:67], v98 offset:0
    ds_read_b128 v[68:71], v98 offset:4096
    ds_read_b64_tr_b16 v[72:73], v100 offset:8192
    ds_read_b64_tr_b16 v[74:75], v100 offset:8704
    ds_read_b64_tr_b16 v[76:77], v101 offset:8192
    ds_read_b64_tr_b16 v[78:79], v101 offset:8704
    v_mfma_f32_32x32x16_bf16 v[0:15], v[80:83], v[88:91], v[0:15]
    v_mfma_f32_32x32x16_bf16 v[16:31], v[80:83], v[92:95], v[16:31]
    v_mfma_f32_32x32x16_bf16 v[32:47], v[84:87], v[88:91], v[32:47]
    v_mfma_f32_32x32x16_bf16 v[48:63], v[84:87], v[92:95], v[48:63]
    v_mfma_f32_16x16x32_bf16 v[106:109], v[102:105], v[88:91], v[106:109]
    s_waitcnt lgkmcnt(0)
    ds_read_b128 v[80:83], v99 offset:0
    ds_read_b128 v[84:87], v99 offset:4096
    ds_read_b64_tr_b16 v[88:89], v100 offset:10240
    ds_read_b64_tr_b16 v[90:91], v100 offset:10752
    ds_read_b64_tr_b16 v[92:93], v101 offset:10240
    ds_read_b64_tr_b16 v[94:95], v101 offset:10752
    v_mfma_f32_32x32x16_bf16 v[0:15], v[64:67], v[72:75], v[0:15]
    v_mfma_f32_32x32x16_bf16 v[16:31], v[64:67], v[76:79], v[16:31]
    v_mfma_f32_32x32x16_bf16 v[32:47], v[68:71], v[72:75], v[32:47]
    v_mfma_f32_32x32x16_bf16 v[48:63], v[68:71], v[76:79], v[48:63]
    v_mfma_f32_16x16x32_bf16 v[106:109], v[102:105], v[72:75], v[106:109]
    s_waitcnt lgkmcnt(0)
    s_barrier
    ds_read_b128 v[64:67], v96 offset:16384
    ds_read_b128 v[68:71], v96 offset:20480
    ds_read_b64_tr_b16 v[72:73], v100 offset:16384
    ds_read_b64_tr_b16 v[74:75], v100 offset:16896
    ds_read_b64_tr_b16 v[76:77], v101 offset:16384
    ds_read_b64_tr_b16 v[78:79], v101 offset:16896
    v_mfma_f32_32x32x16_bf16 v[0:15], v[80:83], v[88:91], v[0:15]
    v_mfma_f32_32x32x16_bf16 v[16:31], v[80:83], v[92:95], v[16:31]
    v_mfma_f32_32x32x16_bf16 v[32:47], v[84:87], v[88:91], v[32:47]
    v_mfma_f32_32x32x16_bf16 v[48:63], v[84:87], v[92:95], v[48:63]
    v_mfma_f32_16x16x32_bf16 v[106:109], v[102:105], v[88:91], v[106:109]
    s_waitcnt lgkmcnt(0)
    ds_read_b128 v[80:83], v97 offset:16384
    ds_read_b128 v[84:87], v97 offset:20480
    ds_read_b64_tr_b16 v[88:89], v100 offset:18432
    ds_read_b64_tr_b16 v[90:91], v100 offset:18944
    ds_read_b64_tr_b16 v[92:93], v101 offset:18432
    ds_read_b64_tr_b16 v[94:95], v101 offset:18944
    v_mfma_f32_32x32x16_bf16 v[0:15], v[64:67], v[72:75], v[0:15]
    v_mfma_f32_32x32x16_bf16 v[16:31], v[64:67], v[76:79], v[16:31]
    v_mfma_f32_32x32x16_bf16 v[32:47], v[68:71], v[72:75], v[32:47]
    v_mfma_f32_32x32x16_bf16 v[48:63], v[68:71], v[76:79], v[48:63]
    v_mfma_f32_16x16x32_bf16 v[106:109], v[102:105], v[72:75], v[106:109]
    s_waitcnt lgkmcnt(0)
    s_barrier
    ds_read_b128 v[64:67], v98 offset:16384
    ds_read_b128 v[68:71], v98 offset:20480
    ds_read_b64_tr_b16 v[72:73], v100 offset:24576
    ds_read_b64_tr_b16 v[74:75], v100 offset:25088
    ds_read_b64_tr_b16 v[76:77], v101 offset:24576
    ds_read_b64_tr_b16 v[78:79], v101 offset:25088
    v_mfma_f32_32x32x16_bf16 v[0:15], v[80:83], v[88:91], v[0:15]
    v_mfma_f32_32x32x16_bf16 v[16:31], v[80:83], v[92:95], v[16:31]
    v_mfma_f32_32x32x16_bf16 v[32:47], v[84:87], v[88:91], v[32:47]
    v_mfma_f32_32x32x16_bf16 v[48:63], v[84:87], v[92:95], v[48:63]
    v_mfma_f32_16x16x32_bf16 v[106:109], v[102:105], v[88:91], v[106:109]
    s_waitcnt lgkmcnt(0)
    ds_read_b128 v[80:83], v99 offset:16384
    ds_read_b128 v[84:87], v99 offset:20480
    ds_read_b64_tr_b16 v[88:89], v100 offset:26624
    ds_read_b64_tr_b16 v[90:91], v100 offset:27136
    ds_read_b64_tr_b16 v[92:93], v101 offset:26624
    ds_read_b64_tr_b16 v[94:95], v101 offset:27136
    v_mfma_f32_32x32x16_bf16 v[0:15], v[64:67], v[72:75], v[0:15]
    v_mfma_f32_32x32x16_bf16 v[16:31], v[64:67], v[76:79], v[16:31]
    v_mfma_f32_32x32x16_bf16 v[32:47], v[68:71], v[72:75], v[32:47]
    v_mfma_f32_32x32x16_bf16 v[48:63], v[68:71], v[76:79], v[48:63]
    v_mfma_f32_16x16x32_bf16 v[106:109], v[102:105], v[72:75], v[106:109]
    s_waitcnt lgkmcnt(0)
    s_barrier
    ds_read_b128 v[64:67], v96 offset:32768
    ds_read_b128 v[68:71], v96 offset:36864
    ds_read_b64_tr_b16 v[72:73], v100 offset:0
    ds_read_b64_tr_b16 v[74:75], v100 offset:512
    ds_read_b64_tr_b16 v[76:77], v101 offset:0
    ds_read_b64_tr_b16 v[78:79], v101 offset:512
    v_mfma_f32_32x32x16_bf16 v[0:15], v[80:83], v[88:91], v[0:15]
    v_mfma_f32_32x32x16_bf16 v[16:31], v[80:83], v[92:95], v[16:31]
    v_mfma_f32_32x32x16_bf16 v[32:47], v[84:87], v[88:91], v[32:47]
    v_mfma_f32_32x32x16_bf16 v[48:63], v[84:87], v[92:95], v[48:63]
    v_mfma_f32_16x16x32_bf16 v[106:109], v[102:105], v[88:91], v[106:109]
    s_waitcnt lgkmcnt(0)
    ds_read_b128 v[80:83], v97 offset:32768
    ds_read_b128 v[84:87], v97 offset:36864
    ds_read_b64_tr_b16 v[88:89], v100 offset:2048
    ds_read_b64_tr_b16 v[90:91], v100 offset:2560
    ds_read_b64_tr_b16 v[92:93], v101 offset:2048
    ds_read_b64_tr_b16 v[94:95], v101 offset:2560
    v_mfma_f32_32x32x16_bf16 v[0:15], v[64:67], v[72:75], v[0:15]
    v_mfma_f32_32x32x16_bf16 v[16:31], v[64:67], v[76:79], v[16:31]
    v_mfma_f32_32x32x16_bf16 v[32:47], v[68:71], v[72:75], v[32:47]
    v_mfma_f32_32x32x16_bf16 v[48:63], v[68:71], v[76:79], v[48:63]
    v_mfma_f32_16x16x32_bf16 v[106:109], v[102:105], v[72:75], v[106:109]
    s_waitcnt lgkmcnt(0)
    s_barrier
    ds_read_b128 v[64:67], v98 offset:32768
    ds_read_b128 v[68:71], v98 offset:36864
    ds_read_b64_tr_b16 v[72:73], v100 offset:8192
    ds_read_b64_tr_b16 v[74:75], v100 offset:8704
    ds_read_b64_tr_b16 v[76:77], v101 offset:8192
    ds_read_b64_tr_b16 v[78:79], v101 offset:8704
    v_mfma_f32_32x32x16_bf16 v[0:15], v[80:83], v[88:91], v[0:15]
    v_mfma_f32_32x32x16_bf16 v[16:31], v[80:83], v[92:95], v[16:31]
    v_mfma_f32_32x32x16_bf16 v[32:47], v[84:87], v[88:91], v[32:47]
    v_mfma_f32_32x32x16_bf16 v[48:63], v[84:87], v[92:95], v[48:63]
    v_mfma_f32_16x16x32_bf16 v[106:109], v[102:105], v[88:91], v[106:109]
    s_waitcnt lgkmcnt(0)
    ds_read_b128 v[80:83], v99 offset:32768
    ds_read_b128 v[84:87], v99 offset:36864
    ds_read_b64_tr_b16 v[88:89], v100 offset:10240
    ds_read_b64_tr_b16 v[90:91], v100 offset:10752
    ds_read_b64_tr_b16 v[92:93], v101 offset:10240
    ds_read_b64_tr_b16 v[94:95], v101 offset:10752
    v_mfma_f32_32x32x16_bf16 v[0:15], v[64:67], v[72:75], v[0:15]
    v_mfma_f32_32x32x16_bf16 v[16:31], v[64:67], v[76:79], v[16:31]
    v_mfma_f32_32x32x16_bf16 v[32:47], v[68:71], v[72:75], v[32:47]
    v_mfma_f32_32x32x16_bf16 v[48:63], v[68:71], v[76:79], v[48:63]
    v_mfma_f32_16x16x32_bf16 v[106:109], v[102:105], v[72:75], v[106:109]
    s_waitcnt lgkmcnt(0)
    s_barrier
    ds_read_b128 v[64:67], v96 offset:0
    ds_read_b128 v[68:71], v96 offset:4096
    ds_read_b64_tr_b16 v[72:73], v100 offset:16384
    ds_read_b64_tr_b16 v[74:75], v100 offset:16896
    ds_read_b64_tr_b16 v[76:77], v101 offset:16384
    ds_read_b64_tr_b16 v[78:79], v101 offset:16896
    v_mfma_f32_32x32x16_bf16 v[0:15], v[80:83], v[88:91], v[0:15]
    v_mfma_f32_32x32x16_bf16 v[16:31], v[80:83], v[92:95], v[16:31]
    v_mfma_f32_32x32x16_bf16 v[32:47], v[84:87], v[88:91], v[32:47]
    v_mfma_f32_32x32x16_bf16 v[48:63], v[84:87], v[92:95], v[48:63]
    v_mfma_f32_16x16x32_bf16 v[106:109], v[102:105], v[88:91], v[106:109]
    s_waitcnt lgkmcnt(0)
    ds_read_b128 v[80:83], v97 offset:0
    ds_read_b128 v[84:87], v97 offset:4096
    ds_read_b64_tr_b16 v[88:89], v100 offset:18432
    ds_read_b64_tr_b16 v[90:91], v100 offset:18944
    ds_read_b64_tr_b16 v[92:93], v101 offset:18432
    ds_read_b64_tr_b16 v[94:95], v101 offset:18944
    v_mfma_f32_32x32x16_bf16 v[0:15], v[64:67], v[72:75], v[0:15]
    v_mfma_f32_32x32x16_bf16 v[16:31], v[64:67], v[76:79], v[16:31]
    v_mfma_f32_32x32x16_bf16 v[32:47], v[68:71], v[72:75], v[32:47]
    v_mfma_f32_32x32x16_bf16 v[48:63], v[68:71], v[76:79], v[48:63]
    v_mfma_f32_16x16x32_bf16 v[106:109], v[102:105], v[72:75], v[106:109]
    s_waitcnt lgkmcnt(0)
    s_barrier
    ds_read_b128 v[64:67], v98 offset:0
    ds_read_b128 v[68:71], v98 offset:4096
    ds_read_b64_tr_b16 v[72:73], v100 offset:24576
    ds_read_b64_tr_b16 v[74:75], v100 offset:25088
    ds_read_b64_tr_b16 v[76:77], v101 offset:24576
    ds_read_b64_tr_b16 v[78:79], v101 offset:25088
    v_mfma_f32_32x32x16_bf16 v[0:15], v[80:83], v[88:91], v[0:15]
    v_mfma_f32_32x32x16_bf16 v[16:31], v[80:83], v[92:95], v[16:31]
    v_mfma_f32_32x32x16_bf16 v[32:47], v[84:87], v[88:91], v[32:47]
    v_mfma_f32_32x32x16_bf16 v[48:63], v[84:87], v[92:95], v[48:63]
    v_mfma_f32_16x16x32_bf16 v[106:109], v[102:105], v[88:91], v[106:109]
    s_waitcnt lgkmcnt(0)
    ds_read_b128 v[80:83], v99 offset:0
    ds_read_b128 v[84:87], v99 offset:4096
    ds_read_b64_tr_b16 v[88:89], v100 offset:26624
    ds_read_b64_tr_b16 v[90:91], v100 offset:27136
    ds_read_b64_tr_b16 v[92:93], v101 offset:26624
    ds_read_b64_tr_b16 v[94:95], v101 offset:27136
    v_mfma_f32_32x32x16_bf16 v[0:15], v[64:67], v[72:75], v[0:15]
    v_mfma_f32_32x32x16_bf16 v[16:31], v[64:67], v[76:79], v[16:31]
    v_mfma_f32_32x32x16_bf16 v[32:47], v[68:71], v[72:75], v[32:47]
    v_mfma_f32_32x32x16_bf16 v[48:63], v[68:71], v[76:79], v[48:63]
    v_mfma_f32_16x16x32_bf16 v[106:109], v[102:105], v[72:75], v[106:109]
    s_waitcnt lgkmcnt(0)
    s_barrier
    ds_read_b128 v[64:67], v96 offset:16384
    ds_read_b128 v[68:71], v96 offset:20480
    ds_read_b64_tr_b16 v[72:73], v100 offset:0
    ds_read_b64_tr_b16 v[74:75], v100 offset:512
    ds_read_b64_tr_b16 v[76:77], v101 offset:0
    ds_read_b64_tr_b16 v[78:79], v101 offset:512
    v_mfma_f32_32x32x16_bf16 v[0:15], v[80:83], v[88:91], v[0:15]
    v_mfma_f32_32x32x16_bf16 v[16:31], v[80:83], v[92:95], v[16:31]
    v_mfma_f32_32x32x16_bf16 v[32:47], v[84:87], v[88:91], v[32:47]
    v_mfma_f32_32x32x16_bf16 v[48:63], v[84:87], v[92:95], v[48:63]
    v_mfma_f32_16x16x32_bf16 v[106:109], v[102:105], v[88:91], v[106:109]
    s_waitcnt lgkmcnt(0)
    ds_read_b128 v[80:83], v97 offset:16384
    ds_read_b128 v[84:87], v97 offset:20480
    ds_read_b64_tr_b16 v[88:89], v100 offset:2048
    ds_read_b64_tr_b16 v[90:91], v100 offset:2560
    ds_read_b64_tr_b16 v[92:93], v101 offset:2048
    ds_read_b64_tr_b16 v[94:95], v101 offset:2560
    v_mfma_f32_32x32x16_bf16 v[0:15], v[64:67], v[72:75], v[0:15]
    v_mfma_f32_32x32x16_bf16 v[16:31], v[64:67], v[76:79], v[16:31]
    v_mfma_f32_32x32x16_bf16 v[32:47], v[68:71], v[72:75], v[32:47]
    v_mfma_f32_32x32x16_bf16 v[48:63], v[68:71], v[76:79], v[48:63]
    v_mfma_f32_16x16x32_bf16 v[106:109], v[102:105], v[72:75], v[106:109]
    s_waitcnt lgkmcnt(0)
    s_barrier
    ds_read_b128 v[64:67], v98 offset:16384
    ds_read_b128 v[68:71], v98 offset:20480
    ds_read_b64_tr_b16 v[72:73], v100 offset:8192
    ds_read_b64_tr_b16 v[74:75], v100 offset:8704
    ds_read_b64_tr_b16 v[76:77], v101 offset:8192
    ds_read_b64_tr_b16 v[78:79], v101 offset:8704
    v_mfma_f32_32x32x16_bf16 v[0:15], v[80:83], v[88:91], v[0:15]
    v_mfma_f32_32x32x16_bf16 v[16:31], v[80:83], v[92:95], v[16:31]
    v_mfma_f32_32x32x16_bf16 v[32:47], v[84:87], v[88:91], v[32:47]
    v_mfma_f32_32x32x16_bf16 v[48:63], v[84:87], v[92:95], v[48:63]
    v_mfma_f32_16x16x32_bf16 v[106:109], v[102:105], v[88:91], v[106:109]
    s_waitcnt lgkmcnt(0)
    ds_read_b128 v[80:83], v99 offset:16384
    ds_read_b128 v[84:87], v99 offset:20480
    ds_read_b64_tr_b16 v[88:89], v100 offset:10240
    ds_read_b64_tr_b16 v[90:91], v100 offset:10752
    ds_read_b64_tr_b16 v[92:93], v101 offset:10240
    ds_read_b64_tr_b16 v[94:95], v101 offset:10752
    v_mfma_f32_32x32x16_bf16 v[0:15], v[64:67], v[72:75], v[0:15]
    v_mfma_f32_32x32x16_bf16 v[16:31], v[64:67], v[76:79], v[16:31]
    v_mfma_f32_32x32x16_bf16 v[32:47], v[68:71], v[72:75], v[32:47]
    v_mfma_f32_32x32x16_bf16 v[48:63], v[68:71], v[76:79], v[48:63]
    v_mfma_f32_16x16x32_bf16 v[106:109], v[102:105], v[72:75], v[106:109]
    s_waitcnt lgkmcnt(0)
    s_barrier
    ds_read_b128 v[64:67], v96 offset:32768
    ds_read_b128 v[68:71], v96 offset:36864
    ds_read_b64_tr_b16 v[72:73], v100 offset:16384
    ds_read_b64_tr_b16 v[74:75], v100 offset:16896
    ds_read_b64_tr_b16 v[76:77], v101 offset:16384
    ds_read_b64_tr_b16 v[78:79], v101 offset:16896
    v_mfma_f32_32x32x16_bf16 v[0:15], v[80:83], v[88:91], v[0:15]
    v_mfma_f32_32x32x16_bf16 v[16:31], v[80:83], v[92:95], v[16:31]
    v_mfma_f32_32x32x16_bf16 v[32:47], v[84:87], v[88:91], v[32:47]
    v_mfma_f32_32x32x16_bf16 v[48:63], v[84:87], v[92:95], v[48:63]
    v_mfma_f32_16x16x32_bf16 v[106:109], v[102:105], v[88:91], v[106:109]
    s_waitcnt lgkmcnt(0)
    ds_read_b128 v[80:83], v97 offset:32768
    ds_read_b128 v[84:87], v97 offset:36864
    ds_read_b64_tr_b16 v[88:89], v100 offset:18432
    ds_read_b64_tr_b16 v[90:91], v100 offset:18944
    ds_read_b64_tr_b16 v[92:93], v101 offset:18432
    ds_read_b64_tr_b16 v[94:95], v101 offset:18944
    v_mfma_f32_32x32x16_bf16 v[0:15], v[64:67], v[72:75], v[0:15]
    v_mfma_f32_32x32x16_bf16 v[16:31], v[64:67], v[76:79], v[16:31]
    v_mfma_f32_32x32x16_bf16 v[32:47], v[68:71], v[72:75], v[32:47]
    v_mfma_f32_32x32x16_bf16 v[48:63], v[68:71], v[76:79], v[48:63]
    v_mfma_f32_16x16x32_bf16 v[106:109], v[102:105], v[72:75], v[106:109]
    s_waitcnt lgkmcnt(0)
    s_barrier
    ds_read_b128 v[64:67], v98 offset:32768
    ds_read_b128 v[68:71], v98 offset:36864
    ds_read_b64_tr_b16 v[72:73], v100 offset:24576
    ds_read_b64_tr_b16 v[74:75], v100 offset:25088
    ds_read_b64_tr_b16 v[76:77], v101 offset:24576
    ds_read_b64_tr_b16 v[78:79], v101 offset:25088
    v_mfma_f32_32x32x16_bf16 v[0:15], v[80:83], v[88:91], v[0:15]
    v_mfma_f32_32x32x16_bf16 v[16:31], v[80:83], v[92:95], v[16:31]
    v_mfma_f32_32x32x16_bf16 v[32:47], v[84:87], v[88:91], v[32:47]
    v_mfma_f32_32x32x16_bf16 v[48:63], v[84:87], v[92:95], v[48:63]
    v_mfma_f32_16x16x32_bf16 v[106:109], v[102:105], v[88:91], v[106:109]
    s_waitcnt lgkmcnt(0)
    ds_read_b128 v[80:83], v99 offset:32768
    ds_read_b128 v[84:87], v99 offset:36864
    ds_read_b64_tr_b16 v[88:89], v100 offset:26624
    ds_read_b64_tr_b16 v[90:91], v100 offset:27136
    ds_read_b64_tr_b16 v[92:93], v101 offset:26624
    ds_read_b64_tr_b16 v[94:95], v101 offset:27136
    v_mfma_f32_32x32x16_bf16 v[0:15], v[64:67], v[72:75], v[0:15]
    v_mfma_f32_32x32x16_bf16 v[16:31], v[64:67], v[76:79], v[16:31]
    v_mfma_f32_32x32x16_bf16 v[32:47], v[68:71], v[72:75], v[32:47]
    v_mfma_f32_32x32x16_bf16 v[48:63], v[68:71], v[76:79], v[48:63]
    v_mfma_f32_16x16x32_bf16 v[106:109], v[102:105], v[72:75], v[106:109]
    s_waitcnt lgkmcnt(0)
    s_barrier
    ds_read_b128 v[64:67], v96 offset:0
    ds_read_b128 v[68:71], v96 offset:4096
    ds_read_b64_tr_b16 v[72:73], v100 offset:0
    ds_read_b64_tr_b16 v[74:75], v100 offset:512
    ds_read_b64_tr_b16 v[76:77], v101 offset:0
    ds_read_b64_tr_b16 v[78:79], v101 offset:512
    v_mfma_f32_32x32x16_bf16 v[0:15], v[80:83], v[88:91], v[0:15]
    v_mfma_f32_32x32x16_bf16 v[16:31], v[80:83], v[92:95], v[16:31]
    v_mfma_f32_32x32x16_bf16 v[32:47], v[84:87], v[88:91], v[32:47]
    v_mfma_f32_32x32x16_bf16 v[48:63], v[84:87], v[92:95], v[48:63]
    v_mfma_f32_16x16x32_bf16 v[106:109], v[102:105], v[88:91], v[106:109]
    s_waitcnt lgkmcnt(0)
    ds_read_b128 v[80:83], v97 offset:0
    ds_read_b128 v[84:87], v97 offset:4096
    ds_read_b64_tr_b16 v[88:89], v100 offset:2048
    ds_read_b64_tr_b16 v[90:91], v100 offset:2560
    ds_read_b64_tr_b16 v[92:93], v101 offset:2048
    ds_read_b64_tr_b16 v[94:95], v101 offset:2560
    v_mfma_f32_32x32x16_bf16 v[0:15], v[64:67], v[72:75], v[0:15]
    v_mfma_f32_32x32x16_bf16 v[16:31], v[64:67], v[76:79], v[16:31]
    v_mfma_f32_32x32x16_bf16 v[32:47], v[68:71], v[72:75], v[32:47]
    v_mfma_f32_32x32x16_bf16 v[48:63], v[68:71], v[76:79], v[48:63]
    v_mfma_f32_16x16x32_bf16 v[106:109], v[102:105], v[72:75], v[106:109]
    s_waitcnt lgkmcnt(0)
    s_barrier
    ds_read_b128 v[64:67], v98 offset:0
    ds_read_b128 v[68:71], v98 offset:4096
    ds_read_b64_tr_b16 v[72:73], v100 offset:8192
    ds_read_b64_tr_b16 v[74:75], v100 offset:8704
    ds_read_b64_tr_b16 v[76:77], v101 offset:8192
    ds_read_b64_tr_b16 v[78:79], v101 offset:8704
    v_mfma_f32_32x32x16_bf16 v[0:15], v[80:83], v[88:91], v[0:15]
    v_mfma_f32_32x32x16_bf16 v[16:31], v[80:83], v[92:95], v[16:31]
    v_mfma_f32_32x32x16_bf16 v[32:47], v[84:87], v[88:91], v[32:47]
    v_mfma_f32_32x32x16_bf16 v[48:63], v[84:87], v[92:95], v[48:63]
    v_mfma_f32_16x16x32_bf16 v[106:109], v[102:105], v[88:91], v[106:109]
    s_waitcnt lgkmcnt(0)
    ds_read_b128 v[80:83], v99 offset:0
    ds_read_b128 v[84:87], v99 offset:4096
    ds_read_b64_tr_b16 v[88:89], v100 offset:10240
    ds_read_b64_tr_b16 v[90:91], v100 offset:10752
    ds_read_b64_tr_b16 v[92:93], v101 offset:10240
    ds_read_b64_tr_b16 v[94:95], v101 offset:10752
    v_mfma_f32_32x32x16_bf16 v[0:15], v[64:67], v[72:75], v[0:15]
    v_mfma_f32_32x32x16_bf16 v[16:31], v[64:67], v[76:79], v[16:31]
    v_mfma_f32_32x32x16_bf16 v[32:47], v[68:71], v[72:75], v[32:47]
    v_mfma_f32_32x32x16_bf16 v[48:63], v[68:71], v[76:79], v[48:63]
    v_mfma_f32_16x16x32_bf16 v[106:109], v[102:105], v[72:75], v[106:109]
    s_waitcnt lgkmcnt(0)
    s_barrier
    ds_read_b128 v[64:67], v96 offset:16384
    ds_read_b128 v[68:71], v96 offset:20480
    ds_read_b64_tr_b16 v[72:73], v100 offset:16384
    ds_read_b64_tr_b16 v[74:75], v100 offset:16896
    ds_read_b64_tr_b16 v[76:77], v101 offset:16384
    ds_read_b64_tr_b16 v[78:79], v101 offset:16896
    v_mfma_f32_32x32x16_bf16 v[0:15], v[80:83], v[88:91], v[0:15]
    v_mfma_f32_32x32x16_bf16 v[16:31], v[80:83], v[92:95], v[16:31]
    v_mfma_f32_32x32x16_bf16 v[32:47], v[84:87], v[88:91], v[32:47]
    v_mfma_f32_32x32x16_bf16 v[48:63], v[84:87], v[92:95], v[48:63]
    v_mfma_f32_16x16x32_bf16 v[106:109], v[102:105], v[88:91], v[106:109]
    s_waitcnt lgkmcnt(0)
    ds_read_b128 v[80:83], v97 offset:16384
    ds_read_b128 v[84:87], v97 offset:20480
    ds_read_b64_tr_b16 v[88:89], v100 offset:18432
    ds_read_b64_tr_b16 v[90:91], v100 offset:18944
    ds_read_b64_tr_b16 v[92:93], v101 offset:18432
    ds_read_b64_tr_b16 v[94:95], v101 offset:18944
    v_mfma_f32_32x32x16_bf16 v[0:15], v[64:67], v[72:75], v[0:15]
    v_mfma_f32_32x32x16_bf16 v[16:31], v[64:67], v[76:79], v[16:31]
    v_mfma_f32_32x32x16_bf16 v[32:47], v[68:71], v[72:75], v[32:47]
    v_mfma_f32_32x32x16_bf16 v[48:63], v[68:71], v[76:79], v[48:63]
    v_mfma_f32_16x16x32_bf16 v[106:109], v[102:105], v[72:75], v[106:109]
    s_waitcnt lgkmcnt(0)
    s_barrier
    ds_read_b128 v[64:67], v98 offset:16384
    ds_read_b128 v[68:71], v98 offset:20480
    ds_read_b64_tr_b16 v[72:73], v100 offset:24576
    ds_read_b64_tr_b16 v[74:75], v100 offset:25088
    ds_read_b64_tr_b16 v[76:77], v101 offset:24576
    ds_read_b64_tr_b16 v[78:79], v101 offset:25088
    v_mfma_f32_32x32x16_bf16 v[0:15], v[80:83], v[88:91], v[0:15]
    v_mfma_f32_32x32x16_bf16 v[16:31], v[80:83], v[92:95], v[16:31]
    v_mfma_f32_32x32x16_bf16 v[32:47], v[84:87], v[88:91], v[32:47]
    v_mfma_f32_32x32x16_bf16 v[48:63], v[84:87], v[92:95], v[48:63]
    v_mfma_f32_16x16x32_bf16 v[106:109], v[102:105], v[88:91], v[106:109]
    s_waitcnt lgkmcnt(0)
    ds_read_b128 v[80:83], v99 offset:16384
    ds_read_b128 v[84:87], v99 offset:20480
    ds_read_b64_tr_b16 v[88:89], v100 offset:26624
    ds_read_b64_tr_b16 v[90:91], v100 offset:27136
    ds_read_b64_tr_b16 v[92:93], v101 offset:26624
    ds_read_b64_tr_b16 v[94:95], v101 offset:27136
    v_mfma_f32_32x32x16_bf16 v[0:15], v[64:67], v[72:75], v[0:15]
    v_mfma_f32_32x32x16_bf16 v[16:31], v[64:67], v[76:79], v[16:31]
    v_mfma_f32_32x32x16_bf16 v[32:47], v[68:71], v[72:75], v[32:47]
    v_mfma_f32_32x32x16_bf16 v[48:63], v[68:71], v[76:79], v[48:63]
    v_mfma_f32_16x16x32_bf16 v[106:109], v[102:105], v[72:75], v[106:109]
    s_waitcnt lgkmcnt(0)
    s_barrier
    ds_read_b128 v[64:67], v96 offset:32768
    ds_read_b128 v[68:71], v96 offset:36864
    ds_read_b64_tr_b16 v[72:73], v100 offset:0
    ds_read_b64_tr_b16 v[74:75], v100 offset:512
    ds_read_b64_tr_b16 v[76:77], v101 offset:0
    ds_read_b64_tr_b16 v[78:79], v101 offset:512
    v_mfma_f32_32x32x16_bf16 v[0:15], v[80:83], v[88:91], v[0:15]
    v_mfma_f32_32x32x16_bf16 v[16:31], v[80:83], v[92:95], v[16:31]
    v_mfma_f32_32x32x16_bf16 v[32:47], v[84:87], v[88:91], v[32:47]
    v_mfma_f32_32x32x16_bf16 v[48:63], v[84:87], v[92:95], v[48:63]
    v_mfma_f32_16x16x32_bf16 v[106:109], v[102:105], v[88:91], v[106:109]
    s_waitcnt lgkmcnt(0)
    ds_read_b128 v[80:83], v97 offset:32768
    ds_read_b128 v[84:87], v97 offset:36864
    ds_read_b64_tr_b16 v[88:89], v100 offset:2048
    ds_read_b64_tr_b16 v[90:91], v100 offset:2560
    ds_read_b64_tr_b16 v[92:93], v101 offset:2048
    ds_read_b64_tr_b16 v[94:95], v101 offset:2560
    v_mfma_f32_32x32x16_bf16 v[0:15], v[64:67], v[72:75], v[0:15]
    v_mfma_f32_32x32x16_bf16 v[16:31], v[64:67], v[76:79], v[16:31]
    v_mfma_f32_32x32x16_bf16 v[32:47], v[68:71], v[72:75], v[32:47]
    v_mfma_f32_32x32x16_bf16 v[48:63], v[68:71], v[76:79], v[48:63]
    v_mfma_f32_16x16x32_bf16 v[106:109], v[102:105], v[72:75], v[106:109]
    s_waitcnt lgkmcnt(0)
    s_barrier
    ds_read_b128 v[64:67], v98 offset:32768
    ds_read_b128 v[68:71], v98 offset:36864
    ds_read_b64_tr_b16 v[72:73], v100 offset:8192
    ds_read_b64_tr_b16 v[74:75], v100 offset:8704
    ds_read_b64_tr_b16 v[76:77], v101 offset:8192
    ds_read_b64_tr_b16 v[78:79], v101 offset:8704
    v_mfma_f32_32x32x16_bf16 v[0:15], v[80:83], v[88:91], v[0:15]
    v_mfma_f32_32x32x16_bf16 v[16:31], v[80:83], v[92:95], v[16:31]
    v_mfma_f32_32x32x16_bf16 v[32:47], v[84:87], v[88:91], v[32:47]
    v_mfma_f32_32x32x16_bf16 v[48:63], v[84:87], v[92:95], v[48:63]
    v_mfma_f32_16x16x32_bf16 v[106:109], v[102:105], v[88:91], v[106:109]
    s_waitcnt lgkmcnt(0)
    ds_read_b128 v[80:83], v99 offset:32768
    ds_read_b128 v[84:87], v99 offset:36864
    ds_read_b64_tr_b16 v[88:89], v100 offset:10240
    ds_read_b64_tr_b16 v[90:91], v100 offset:10752
    ds_read_b64_tr_b16 v[92:93], v101 offset:10240
    ds_read_b64_tr_b16 v[94:95], v101 offset:10752
    v_mfma_f32_32x32x16_bf16 v[0:15], v[64:67], v[72:75], v[0:15]
    v_mfma_f32_32x32x16_bf16 v[16:31], v[64:67], v[76:79], v[16:31]
    v_mfma_f32_32x32x16_bf16 v[32:47], v[68:71], v[72:75], v[32:47]
    v_mfma_f32_32x32x16_bf16 v[48:63], v[68:71], v[76:79], v[48:63]
    v_mfma_f32_16x16x32_bf16 v[106:109], v[102:105], v[72:75], v[106:109]
    s_waitcnt lgkmcnt(0)
    s_barrier
    ds_read_b128 v[64:67], v96 offset:0
    ds_read_b128 v[68:71], v96 offset:4096
    ds_read_b64_tr_b16 v[72:73], v100 offset:16384
    ds_read_b64_tr_b16 v[74:75], v100 offset:16896
    ds_read_b64_tr_b16 v[76:77], v101 offset:16384
    ds_read_b64_tr_b16 v[78:79], v101 offset:16896
    v_mfma_f32_32x32x16_bf16 v[0:15], v[80:83], v[88:91], v[0:15]
    v_mfma_f32_32x32x16_bf16 v[16:31], v[80:83], v[92:95], v[16:31]
    v_mfma_f32_32x32x16_bf16 v[32:47], v[84:87], v[88:91], v[32:47]
    v_mfma_f32_32x32x16_bf16 v[48:63], v[84:87], v[92:95], v[48:63]
    v_mfma_f32_16x16x32_bf16 v[106:109], v[102:105], v[88:91], v[106:109]
    s_waitcnt lgkmcnt(0)
    ds_read_b128 v[80:83], v97 offset:0
    ds_read_b128 v[84:87], v97 offset:4096
    ds_read_b64_tr_b16 v[88:89], v100 offset:18432
    ds_read_b64_tr_b16 v[90:91], v100 offset:18944
    ds_read_b64_tr_b16 v[92:93], v101 offset:18432
    ds_read_b64_tr_b16 v[94:95], v101 offset:18944
    v_mfma_f32_32x32x16_bf16 v[0:15], v[64:67], v[72:75], v[0:15]
    v_mfma_f32_32x32x16_bf16 v[16:31], v[64:67], v[76:79], v[16:31]
    v_mfma_f32_32x32x16_bf16 v[32:47], v[68:71], v[72:75], v[32:47]
    v_mfma_f32_32x32x16_bf16 v[48:63], v[68:71], v[76:79], v[48:63]
    v_mfma_f32_16x16x32_bf16 v[106:109], v[102:105], v[72:75], v[106:109]
    s_waitcnt lgkmcnt(0)
    s_barrier
    ds_read_b128 v[64:67], v98 offset:0
    ds_read_b128 v[68:71], v98 offset:4096
    ds_read_b64_tr_b16 v[72:73], v100 offset:24576
    ds_read_b64_tr_b16 v[74:75], v100 offset:25088
    ds_read_b64_tr_b16 v[76:77], v101 offset:24576
    ds_read_b64_tr_b16 v[78:79], v101 offset:25088
    v_mfma_f32_32x32x16_bf16 v[0:15], v[80:83], v[88:91], v[0:15]
    v_mfma_f32_32x32x16_bf16 v[16:31], v[80:83], v[92:95], v[16:31]
    v_mfma_f32_32x32x16_bf16 v[32:47], v[84:87], v[88:91], v[32:47]
    v_mfma_f32_32x32x16_bf16 v[48:63], v[84:87], v[92:95], v[48:63]
    v_mfma_f32_16x16x32_bf16 v[106:109], v[102:105], v[88:91], v[106:109]
    s_waitcnt lgkmcnt(0)
    ds_read_b128 v[80:83], v99 offset:0
    ds_read_b128 v[84:87], v99 offset:4096
    ds_read_b64_tr_b16 v[88:89], v100 offset:26624
    ds_read_b64_tr_b16 v[90:91], v100 offset:27136
    ds_read_b64_tr_b16 v[92:93], v101 offset:26624
    ds_read_b64_tr_b16 v[94:95], v101 offset:27136
    v_mfma_f32_32x32x16_bf16 v[0:15], v[64:67], v[72:75], v[0:15]
    v_mfma_f32_32x32x16_bf16 v[16:31], v[64:67], v[76:79], v[16:31]
    v_mfma_f32_32x32x16_bf16 v[32:47], v[68:71], v[72:75], v[32:47]
    v_mfma_f32_32x32x16_bf16 v[48:63], v[68:71], v[76:79], v[48:63]
    v_mfma_f32_16x16x32_bf16 v[106:109], v[102:105], v[72:75], v[106:109]
    s_waitcnt lgkmcnt(0)
    v_mfma_f32_32x32x16_bf16 v[0:15], v[80:83], v[88:91], v[0:15]
    v_mfma_f32_32x32x16_bf16 v[16:31], v[80:83], v[92:95], v[16:31]
    v_mfma_f32_32x32x16_bf16 v[32:47], v[84:87], v[88:91], v[32:47]
    v_mfma_f32_32x32x16_bf16 v[48:63], v[84:87], v[92:95], v[48:63]
    v_mfma_f32_16x16x32_bf16 v[106:109], v[102:105], v[88:91], v[106:109]
    s_nop 7
    s_mov_b64 exec, 0xffff
    ds_write2_b32 v114, v106, v107 offset0:0 offset1:16
    s_mov_b64 exec, -1
    s_waitcnt lgkmcnt(0)
    s_barrier
    ds_read_b32 v120, v115
    ds_read_b32 v122, v116
    ds_read_b128 v[64:67], v118 offset:16896
    ds_read_b128 v[80:83], v118 offset:17408
    ds_read_b128 v[68:71], v118 offset:16928
    ds_read_b128 v[84:87], v118 offset:17440
    ds_read_b128 v[72:75], v118 offset:16960
    ds_read_b128 v[88:91], v118 offset:17472
    ds_read_b128 v[76:79], v118 offset:16992
    ds_read_b128 v[92:95], v118 offset:17504
    s_waitcnt lgkmcnt(0)
    v_pk_fma_f32 v[0:1], v[64:65], v[120:121], v[0:1] op_sel_hi:[1,0,1] neg_lo:[1,0,0] neg_hi:[1,0,0]
    v_pk_fma_f32 v[2:3], v[66:67], v[120:121], v[2:3] op_sel_hi:[1,0,1] neg_lo:[1,0,0] neg_hi:[1,0,0]
    v_pk_fma_f32 v[4:5], v[68:69], v[120:121], v[4:5] op_sel_hi:[1,0,1] neg_lo:[1,0,0] neg_hi:[1,0,0]
    v_pk_fma_f32 v[6:7], v[70:71], v[120:121], v[6:7] op_sel_hi:[1,0,1] neg_lo:[1,0,0] neg_hi:[1,0,0]
    v_pk_fma_f32 v[8:9], v[72:73], v[120:121], v[8:9] op_sel_hi:[1,0,1] neg_lo:[1,0,0] neg_hi:[1,0,0]
    v_pk_fma_f32 v[10:11], v[74:75], v[120:121], v[10:11] op_sel_hi:[1,0,1] neg_lo:[1,0,0] neg_hi:[1,0,0]
    v_pk_fma_f32 v[12:13], v[76:77], v[120:121], v[12:13] op_sel_hi:[1,0,1] neg_lo:[1,0,0] neg_hi:[1,0,0]
    v_pk_fma_f32 v[14:15], v[78:79], v[120:121], v[14:15] op_sel_hi:[1,0,1] neg_lo:[1,0,0] neg_hi:[1,0,0]
    v_pk_mul_f32 v[0:1], v[80:81], v[0:1]
    v_pk_mul_f32 v[2:3], v[82:83], v[2:3]
    v_pk_mul_f32 v[4:5], v[84:85], v[4:5]
    v_pk_mul_f32 v[6:7], v[86:87], v[6:7]
    v_pk_mul_f32 v[8:9], v[88:89], v[8:9]
    v_pk_mul_f32 v[10:11], v[90:91], v[10:11]
    v_pk_mul_f32 v[12:13], v[92:93], v[12:13]
    v_pk_mul_f32 v[14:15], v[94:95], v[14:15]
    v_pk_fma_f32 v[16:17], v[64:65], v[122:123], v[16:17] op_sel_hi:[1,0,1] neg_lo:[1,0,0] neg_hi:[1,0,0]
    v_pk_fma_f32 v[18:19], v[66:67], v[122:123], v[18:19] op_sel_hi:[1,0,1] neg_lo:[1,0,0] neg_hi:[1,0,0]
    v_pk_fma_f32 v[20:21], v[68:69], v[122:123], v[20:21] op_sel_hi:[1,0,1] neg_lo:[1,0,0] neg_hi:[1,0,0]
    v_pk_fma_f32 v[22:23], v[70:71], v[122:123], v[22:23] op_sel_hi:[1,0,1] neg_lo:[1,0,0] neg_hi:[1,0,0]
    v_pk_fma_f32 v[24:25], v[72:73], v[122:123], v[24:25] op_sel_hi:[1,0,1] neg_lo:[1,0,0] neg_hi:[1,0,0]
    v_pk_fma_f32 v[26:27], v[74:75], v[122:123], v[26:27] op_sel_hi:[1,0,1] neg_lo:[1,0,0] neg_hi:[1,0,0]
    v_pk_fma_f32 v[28:29], v[76:77], v[122:123], v[28:29] op_sel_hi:[1,0,1] neg_lo:[1,0,0] neg_hi:[1,0,0]
    v_pk_fma_f32 v[30:31], v[78:79], v[122:123], v[30:31] op_sel_hi:[1,0,1] neg_lo:[1,0,0] neg_hi:[1,0,0]
    v_pk_mul_f32 v[16:17], v[80:81], v[16:17]
    v_pk_mul_f32 v[18:19], v[82:83], v[18:19]
    v_pk_mul_f32 v[20:21], v[84:85], v[20:21]
    v_pk_mul_f32 v[22:23], v[86:87], v[22:23]
    v_pk_mul_f32 v[24:25], v[88:89], v[24:25]
    v_pk_mul_f32 v[26:27], v[90:91], v[26:27]
    v_pk_mul_f32 v[28:29], v[92:93], v[28:29]
    v_pk_mul_f32 v[30:31], v[94:95], v[30:31]
    ds_read_b128 v[64:67], v118 offset:17024
    ds_read_b128 v[80:83], v118 offset:17536
    ds_read_b128 v[68:71], v118 offset:17056
    ds_read_b128 v[84:87], v118 offset:17568
    ds_read_b128 v[72:75], v118 offset:17088
    ds_read_b128 v[88:91], v118 offset:17600
    ds_read_b128 v[76:79], v118 offset:17120
    ds_read_b128 v[92:95], v118 offset:17632
    v_cvt_pk_bf16_f32 v102, v0, v1
    v_cvt_pk_bf16_f32 v103, v2, v3
    v_cvt_pk_bf16_f32 v104, v4, v5
    v_cvt_pk_bf16_f32 v105, v6, v7
    buffer_store_dwordx4 v[102:105], v110, s[16:19], s50 offen offset:1280 sc1
    v_cvt_pk_bf16_f32 v106, v8, v9
    v_cvt_pk_bf16_f32 v107, v10, v11
    v_cvt_pk_bf16_f32 v108, v12, v13
    v_cvt_pk_bf16_f32 v109, v14, v15
    buffer_store_dwordx4 v[106:109], v110, s[16:19], s50 offen offset:1920 sc1
    v_cvt_pk_bf16_f32 v102, v16, v17
    v_cvt_pk_bf16_f32 v103, v18, v19
    v_cvt_pk_bf16_f32 v104, v20, v21
    v_cvt_pk_bf16_f32 v105, v22, v23
    buffer_store_dwordx4 v[102:105], v111, s[16:19], s50 offen offset:1280 sc1
    v_cvt_pk_bf16_f32 v106, v24, v25
    v_cvt_pk_bf16_f32 v107, v26, v27
    v_cvt_pk_bf16_f32 v108, v28, v29
    v_cvt_pk_bf16_f32 v109, v30, v31
    buffer_store_dwordx4 v[106:109], v111, s[16:19], s50 offen offset:1920 sc1
    s_waitcnt lgkmcnt(0)
    v_pk_fma_f32 v[32:33], v[64:65], v[120:121], v[32:33] op_sel_hi:[1,0,1] neg_lo:[1,0,0] neg_hi:[1,0,0]
    v_pk_fma_f32 v[34:35], v[66:67], v[120:121], v[34:35] op_sel_hi:[1,0,1] neg_lo:[1,0,0] neg_hi:[1,0,0]
    v_pk_fma_f32 v[36:37], v[68:69], v[120:121], v[36:37] op_sel_hi:[1,0,1] neg_lo:[1,0,0] neg_hi:[1,0,0]
    v_pk_fma_f32 v[38:39], v[70:71], v[120:121], v[38:39] op_sel_hi:[1,0,1] neg_lo:[1,0,0] neg_hi:[1,0,0]
    v_pk_fma_f32 v[40:41], v[72:73], v[120:121], v[40:41] op_sel_hi:[1,0,1] neg_lo:[1,0,0] neg_hi:[1,0,0]
    v_pk_fma_f32 v[42:43], v[74:75], v[120:121], v[42:43] op_sel_hi:[1,0,1] neg_lo:[1,0,0] neg_hi:[1,0,0]
    v_pk_fma_f32 v[44:45], v[76:77], v[120:121], v[44:45] op_sel_hi:[1,0,1] neg_lo:[1,0,0] neg_hi:[1,0,0]
    v_pk_fma_f32 v[46:47], v[78:79], v[120:121], v[46:47] op_sel_hi:[1,0,1] neg_lo:[1,0,0] neg_hi:[1,0,0]
    v_pk_mul_f32 v[32:33], v[80:81], v[32:33]
    v_pk_mul_f32 v[34:35], v[82:83], v[34:35]
    v_pk_mul_f32 v[36:37], v[84:85], v[36:37]
    v_pk_mul_f32 v[38:39], v[86:87], v[38:39]
    v_pk_mul_f32 v[40:41], v[88:89], v[40:41]
    v_pk_mul_f32 v[42:43], v[90:91], v[42:43]
    v_pk_mul_f32 v[44:45], v[92:93], v[44:45]
    v_pk_mul_f32 v[46:47], v[94:95], v[46:47]
    v_pk_fma_f32 v[48:49], v[64:65], v[122:123], v[48:49] op_sel_hi:[1,0,1] neg_lo:[1,0,0] neg_hi:[1,0,0]
    v_pk_fma_f32 v[50:51], v[66:67], v[122:123], v[50:51] op_sel_hi:[1,0,1] neg_lo:[1,0,0] neg_hi:[1,0,0]
    v_pk_fma_f32 v[52:53], v[68:69], v[122:123], v[52:53] op_sel_hi:[1,0,1] neg_lo:[1,0,0] neg_hi:[1,0,0]
    v_pk_fma_f32 v[54:55], v[70:71], v[122:123], v[54:55] op_sel_hi:[1,0,1] neg_lo:[1,0,0] neg_hi:[1,0,0]
    v_pk_fma_f32 v[56:57], v[72:73], v[122:123], v[56:57] op_sel_hi:[1,0,1] neg_lo:[1,0,0] neg_hi:[1,0,0]
    v_pk_fma_f32 v[58:59], v[74:75], v[122:123], v[58:59] op_sel_hi:[1,0,1] neg_lo:[1,0,0] neg_hi:[1,0,0]
    v_pk_fma_f32 v[60:61], v[76:77], v[122:123], v[60:61] op_sel_hi:[1,0,1] neg_lo:[1,0,0] neg_hi:[1,0,0]
    v_pk_fma_f32 v[62:63], v[78:79], v[122:123], v[62:63] op_sel_hi:[1,0,1] neg_lo:[1,0,0] neg_hi:[1,0,0]
    v_pk_mul_f32 v[48:49], v[80:81], v[48:49]
    v_pk_mul_f32 v[50:51], v[82:83], v[50:51]
    v_pk_mul_f32 v[52:53], v[84:85], v[52:53]
    v_pk_mul_f32 v[54:55], v[86:87], v[54:55]
    v_pk_mul_f32 v[56:57], v[88:89], v[56:57]
    v_pk_mul_f32 v[58:59], v[90:91], v[58:59]
    v_pk_mul_f32 v[60:61], v[92:93], v[60:61]
    v_pk_mul_f32 v[62:63], v[94:95], v[62:63]
    v_cvt_pk_bf16_f32 v102, v32, v33
    v_cvt_pk_bf16_f32 v103, v34, v35
    v_cvt_pk_bf16_f32 v104, v36, v37
    v_cvt_pk_bf16_f32 v105, v38, v39
    buffer_store_dwordx4 v[102:105], v110, s[16:19], s51 offen offset:1280 sc1
    v_cvt_pk_bf16_f32 v106, v40, v41
    v_cvt_pk_bf16_f32 v107, v42, v43
    v_cvt_pk_bf16_f32 v108, v44, v45
    v_cvt_pk_bf16_f32 v109, v46, v47
    buffer_store_dwordx4 v[106:109], v110, s[16:19], s51 offen offset:1920 sc1
    v_cvt_pk_bf16_f32 v102, v48, v49
    v_cvt_pk_bf16_f32 v103, v50, v51
    v_cvt_pk_bf16_f32 v104, v52, v53
    v_cvt_pk_bf16_f32 v105, v54, v55
    buffer_store_dwordx4 v[102:105], v111, s[16:19], s51 offen offset:1280 sc1
    v_cvt_pk_bf16_f32 v106, v56, v57
    v_cvt_pk_bf16_f32 v107, v58, v59
    v_cvt_pk_bf16_f32 v108, v60, v61
    v_cvt_pk_bf16_f32 v109, v62, v63
    buffer_store_dwordx4 v[106:109], v111, s[16:19], s51 offen offset:1920 sc1
L_q_done:
    s_waitcnt vmcnt(0)
    s_barrier
    s_cmp_lg_u32 s20, 0
    s_cbranch_scc1 L_arr_q
    s_add_u32 s30, s28, 96
    s_lshl_b32 s30, s30, 7
    v_mov_b32 v2, s30
    v_mov_b32 v3, 1
    s_mov_b64 exec, 1
    buffer_atomic_add v3, v2, s[44:47], 0 offen sc0 sc1
    s_mul_i32 s30, s28, 8
    s_add_u32 s30, s30, 56
    s_waitcnt vmcnt(0)
    v_readfirstlane_b32 s55, v3
    s_mov_b64 exec, -1
    s_cmp_lg_u32 s55, 15
    s_cbranch_scc1 L_arr_q
    v_mov_b32 v2, 5248
    v_mov_b32 v3, 1
    s_mov_b64 exec, 1
    buffer_atomic_add v3, v2, s[44:47], 0 offen sc0 sc1
    s_mov_b32 s30, 56
    s_waitcnt vmcnt(0)
    v_readfirstlane_b32 s55, v3
    s_mov_b64 exec, -1
    s_cmp_lg_u32 s55, 14
    s_cbranch_scc1 L_arr_q
    v_mbcnt_lo_u32_b32 v2, -1, 0
    v_add_lshl_u32 v2, v2, s30, 7
    v_mov_b32 v3, 1
    s_mov_b64 exec, 255
    buffer_store_dword v3, v2, s[44:47], 0 offen sc1
    s_mov_b64 exec, -1
L_arr_q:
    s_branch L_att
L_q_skip:
    s_waitcnt lgkmcnt(0)
    s_add_u32 s44, s38, 19988480
    s_addc_u32 s45, s39, 0
    s_mov_b32 s46, 20480
    s_mov_b32 s47, 0x00020000
    s_mov_b32 s60, s36
    s_mov_b32 s61, s37
    s_mov_b32 s62, 256
    s_mov_b32 s63, 0x00020000
    s_cmp_lg_u32 s20, 0
    s_cbranch_scc1 L_q_skip2
    s_and_b32 s30, s2, 1
    s_lshl_b32 s30, s30, 7
    v_mov_b32 v2, s30
    s_sleep 64
    s_mov_b32 s55, 262144
    s_mov_b64 exec, 1
L_poll_zqs:
    buffer_load_dword v3, v2, s[60:63], 0 offen sc1
    s_waitcnt vmcnt(0)
    v_cmp_ne_u32 vcc, 1, v3
    s_cbranch_vccz L_got_zqs
    s_sleep 32
    s_sub_u32 s55, s55, 1
    s_cbranch_scc0 L_poll_zqs
L_got_zqs:
    s_mov_b64 exec, -1
L_q_skip2:
L_att:
    v_mbcnt_lo_u32_b32 v118, -1, 0
    v_mbcnt_hi_u32_b32 v118, -1, v118
    s_and_b32 s21, s2, 7
    s_lshl_b32 s21, s21, 2
    s_bfe_u32 s22, s2, 0x20003
    s_add_u32 s21, s21, s22
    v_lshlrev_b32 v115, 4, v118
    v_and_b32 v116, 31, v118
    v_lshrrev_b32 v117, 5, v118
    s_and_b32 s25, s20, 3
    s_lshr_b32 s26, s20, 2
    s_lshr_b32 s22, s2, 5
    s_lshl_b32 s22, s22, 2
    s_add_u32 s22, s22, s25
    s_lshl_b32 s22, s22, 1
    s_xor_b32 s27, s26, 1
    s_add_u32 s27, s27, s22
    s_add_u32 s22, s22, s26
    s_mul_i32 s23, s21, 163840
    s_mul_i32 s28, s26, 81920
    s_lshl_b32 s29, s25, 10
    s_add_u32 s24, s23, s28
    s_add_u32 s24, s24, s29
    s_mul_i32 s28, s26, 40960
    s_add_u32 s29, s29, s28
    s_add_u32 s31, s29, 20480
    s_lshl_b32 s30, s21, 6
    s_add_u32 s32, s30, s22
    s_add_u32 s33, s30, s27
    s_mul_i32 s32, s32, 1280
    s_mul_i32 s33, s33, 1280
    v_lshlrev_b32 v113, 3, v116
    v_lshl_add_u32 v2, v117, 30, v113
    s_add_u32 s4, s38, 5242880
    s_addc_u32 s5, s39, 0
    s_mov_b32 s6, 5242880
    s_mov_b32 s7, 0x00020000
    s_add_u32 s8, s38, 2621440
    s_addc_u32 s9, s39, 0
    s_mov_b32 s10, 2621440
    s_mov_b32 s11, 0x00020000
    s_add_u32 s16, s38, 10485760
    s_addc_u32 s17, s39, 0
    s_mov_b32 s18, 8912896
    s_mov_b32 s19, 0x00020000
    v_mul_u32_u24 v114, 320, v117
    v_lshl_add_u32 v114, v116, 4, v114
    v_cmp_gt_u32 s[56:57], 20, v116
    v_cmp_eq_u32 vcc, 20, v116
    v_mov_b32 v3, 0x3f803f80
    s_mov_b32 s58, -1
    s_mov_b32 s59, 0
    v_cndmask_b32 v3, 0, v3, vcc
    v_mov_b32 v84, v3
    v_mov_b32 v85, v3
    v_mov_b32 v86, v3
    v_mov_b32 v87, v3
    v_mov_b32 v88, v3
    v_mov_b32 v89, v3
    v_mov_b32 v90, v3
    v_mov_b32 v91, v3
    v_mov_b32 v92, v3
    v_mov_b32 v93, v3
    v_mov_b32 v94, v3
    v_mov_b32 v95, v3
    v_mov_b32 v96, v3
    v_mov_b32 v97, v3
    v_mov_b32 v98, v3
    v_mov_b32 v99, v3
    v_mov_b32 v80, 0x3f80
    v_mov_b32 v81, 0
    v_mov_b32 v82, 0x3f80
    v_mov_b32 v83, 0
    v_mov_b32 v68, 0
    v_mov_b32 v69, 0
    v_mov_b32 v70, 0
    v_mov_b32 v71, 0
    s_lshr_b32 s41, s21, 1
    s_mul_i32 s41, s41, 5
    s_and_b32 s42, s21, 1
    s_add_u32 s43, s41, 4
    s_lshl_b32 s43, s43, 8
    s_lshl_b32 s40, s42, 3
    s_add_u32 s43, s43, s40
    s_lshl_b32 s42, s42, 1
    s_add_u32 s41, s41, s42
    s_lshl_b32 s41, s41, 8
    s_mul_i32 s40, s22, 139264
    s_add_u32 s41, s41, s40
    s_add_u32 s40, s43, s40
    v_bfe_u32 v119, v118, 4, 1
    v_mul_u32_u24 v119, 69632, v119
    v_and_b32 v3, 15, v118
    v_lshl_add_u32 v119, v3, 4, v119
    s_cmp_lg_u32 s20, 0
    s_cbranch_scc1 L_att_nopoll
    s_and_b32 s48, s2, 7
    s_add_u32 s48, s48, 56
    s_lshl_b32 s30, s48, 7
    v_mov_b32 v4, s30
    s_mov_b32 s55, 262144
    s_mov_b64 exec, 1
L_poll_att:
    buffer_load_dword v5, v4, s[44:47], 0 offen sc1
    s_waitcnt vmcnt(0)
    v_cmp_ne_u32 vcc, 1, v5
    s_cbranch_vccz L_got_att
    s_sleep 8
    s_sub_u32 s55, s55, 1
    s_cbranch_scc0 L_poll_att
L_got_att:
    s_mov_b64 exec, -1
L_att_nopoll:
    s_barrier
    buffer_load_dwordx4 v[100:103], v115, s[8:11], s32 offen sc1
    buffer_load_dwordx2 v[108:109], v2, s[8:11], s32 offen offset:1024 sc1
    buffer_load_dwordx4 v[104:107], v115, s[8:11], s33 offen sc1
    buffer_load_dwordx2 v[110:111], v2, s[8:11], s33 offen offset:1024 sc1
    s_add_u32 m0, s29, 0
    s_add_u32 s30, s24, 0
    buffer_load_dwordx4 v115, s[4:7], s30 offen sc1 lds
    s_add_u32 m0, s29, 4096
    s_add_u32 s30, s24, 4096
    buffer_load_dwordx4 v115, s[4:7], s30 offen sc1 lds
    s_add_u32 m0, s29, 8192
    s_add_u32 s30, s24, 8192
    buffer_load_dwordx4 v115, s[4:7], s30 offen sc1 lds
    s_add_u32 m0, s29, 12288
    s_add_u32 s30, s24, 12288
    buffer_load_dwordx4 v115, s[4:7], s30 offen sc1 lds
    s_add_u32 m0, s29, 16384
    s_add_u32 s30, s24, 16384
    buffer_load_dwordx4 v115, s[4:7], s30 offen sc1 lds
    s_add_u32 s24, s24, 20480
    s_waitcnt vmcnt(3)
    s_barrier
    ds_read_b128 v[72:75], v115 offset:0
    ds_read_b128 v[76:79], v115 offset:2560
    s_mov_b64 exec, s[58:59]
    ds_read_b64 v[80:81], v113 offset:1024
    ds_read_b64 v[82:83], v113 offset:3584
    s_mov_b64 exec, -1
    v_add_u32 v112, s28, v115
    v_add_u32 v113, s28, v113
    v_add_u32 v114, s28, v114
    s_waitcnt lgkmcnt(0)
    v_mfma_f32_32x32x16_bf16 v[0:15], v[72:75], v[100:103], 0
    v_mfma_f32_32x32x16_bf16 v[16:31], v[76:79], v[100:103], 0
    v_mfma_f32_32x32x16_bf16 v[32:47], v[72:75], v[104:107], 0
    v_mfma_f32_32x32x16_bf16 v[48:63], v[76:79], v[104:107], 0
    s_nop 6
    v_mfma_f32_32x32x8bf16_1k v[0:15], v[80:81], v[108:109], v[0:15]
    v_mfma_f32_32x32x8bf16_1k v[16:31], v[82:83], v[108:109], v[16:31]
    v_mfma_f32_32x32x8bf16_1k v[32:47], v[80:81], v[110:111], v[32:47]
    v_mfma_f32_32x32x8bf16_1k v[48:63], v[82:83], v[110:111], v[48:63]
    s_waitcnt vmcnt(0)
    s_barrier
    ds_read_b128 v[72:75], v112 offset:0
    s_mov_b64 exec, s[58:59]
    ds_read_b64 v[80:81], v113 offset:1024
    s_mov_b64 exec, s[56:57]
    ds_read_b128 v[84:87], v114 offset:1280
    ds_read_b128 v[88:91], v114 offset:1920
    s_mov_b64 exec, -1
    s_add_u32 m0, s31, 0
    s_add_u32 s30, s24, 0
    buffer_load_dwordx4 v115, s[4:7], s30 offen sc1 lds
    s_add_u32 m0, s31, 4096
    s_add_u32 s30, s24, 4096
    buffer_load_dwordx4 v115, s[4:7], s30 offen sc1 lds
    s_add_u32 m0, s31, 8192
    s_add_u32 s30, s24, 8192
    buffer_load_dwordx4 v115, s[4:7], s30 offen sc1 lds
    s_add_u32 m0, s31, 12288
    s_add_u32 s30, s24, 12288
    buffer_load_dwordx4 v115, s[4:7], s30 offen sc1 lds
    s_add_u32 m0, s31, 16384
    s_add_u32 s30, s24, 16384
    buffer_load_dwordx4 v115, s[4:7], s30 offen sc1 lds
    s_add_u32 s24, s24, 20480
    v_max3_f32 v120, v0, v1, v2
    v_max3_f32 v120, v120, v3, v4
    v_max3_f32 v120, v120, v5, v6
    v_max3_f32 v120, v120, v7, v8
    v_max3_f32 v120, v120, v9, v10
    v_max3_f32 v120, v120, v11, v12
    v_max3_f32 v120, v120, v13, v14
    v_max3_f32 v120, v120, v15, v16
    v_max3_f32 v120, v120, v17, v18
    v_max3_f32 v120, v120, v19, v20
    v_max3_f32 v120, v120, v21, v22
    v_max3_f32 v120, v120, v23, v24
    v_max3_f32 v120, v120, v25, v26
    v_max3_f32 v120, v120, v27, v28
    v_max3_f32 v120, v120, v29, v30
    v_max_f32 v120, v120, v31
    v_mov_b32 v122, v120
    v_max3_f32 v121, v32, v33, v34
    v_max3_f32 v121, v121, v35, v36
    v_max3_f32 v121, v121, v37, v38
    v_max3_f32 v121, v121, v39, v40
    v_max3_f32 v121, v121, v41, v42
    v_max3_f32 v121, v121, v43, v44
    v_max3_f32 v121, v121, v45, v46
    v_max3_f32 v121, v121, v47, v48
    v_max3_f32 v121, v121, v49, v50
    v_max3_f32 v121, v121, v51, v52
    v_max3_f32 v121, v121, v53, v54
    v_max3_f32 v121, v121, v55, v56
    v_max3_f32 v121, v121, v57, v58
    v_max3_f32 v121, v121, v59, v60
    v_max3_f32 v121, v121, v61, v62
    v_max_f32 v121, v121, v63
    v_mov_b32 v123, v121
    s_nop 0
    v_permlane32_swap_b32 v120, v122
    v_permlane32_swap_b32 v121, v123
    v_mov_b32 v32, 0
    v_mov_b32 v33, 0
    v_mov_b32 v34, 0
    v_mov_b32 v35, 0
    v_mov_b32 v36, 0
    v_mov_b32 v37, 0
    v_mov_b32 v38, 0
    v_mov_b32 v39, 0
    v_mov_b32 v40, 0
    v_mov_b32 v41, 0
    v_mov_b32 v42, 0
    v_mov_b32 v43, 0
    v_mov_b32 v44, 0
    v_mov_b32 v45, 0
    v_mov_b32 v46, 0
    v_mov_b32 v47, 0
    v_mov_b32 v48, 0
    v_mov_b32 v49, 0
    v_mov_b32 v50, 0
    v_mov_b32 v51, 0
    v_mov_b32 v52, 0
    v_mov_b32 v53, 0
    v_mov_b32 v54, 0
    v_mov_b32 v55, 0
    v_mov_b32 v56, 0
    v_mov_b32 v57, 0
    v_mov_b32 v58, 0
    v_mov_b32 v59, 0
    v_mov_b32 v60, 0
    v_mov_b32 v61, 0
    v_mov_b32 v62, 0
    v_mov_b32 v63, 0
    v_max_f32 v120, v120, v122
    v_sub_f32 v120, 0xc2c80000, v120
    v_cvt_pk_bf16_f32 v120, v120, 0
    v_max_f32 v121, v121, v123
    v_sub_f32 v121, 0xc2c80000, v121
    v_cvt_pk_bf16_f32 v121, v121, 0
    s_not_b64 exec, s[58:59]
    v_mov_b32 v108, v120
    v_mov_b32 v110, v121
    s_mov_b64 exec, -1
    s_waitcnt lgkmcnt(0)
    v_mfma_f32_32x32x16_bf16 v[0:15], v[72:75], v[100:103], 0
    s_mov_b32 s42, 0
    s_mov_b32 s54, 0x07060302
    s_mov_b32 s43, 20480
    s_nop 7
    v_mfma_f32_32x32x8bf16_1k v[0:15], v[80:81], v[108:109], v[0:15]
    s_nop 11
    s_setprio 2
.p2align 6
L_att_loop:
    v_exp_f32 v0, v0
    v_exp_f32 v1, v1
    v_mfma_f32_32x32x16_bf16 v[48:63], v[96:99], v[68:71], v[48:63]
    ds_read_b128 v[76:79], v112 offset:2560
    s_mov_b64 exec, s[58:59]
    ds_read_b64 v[82:83], v113 offset:3584
    s_mov_b64 exec, s[56:57]
    ds_read_b128 v[92:95], v114 offset:3840
    ds_read_b128 v[96:99], v114 offset:4480
    s_mov_b64 exec, -1
    v_exp_f32 v2, v2
    v_exp_f32 v3, v3
    v_cvt_pk_bf16_f32 v64, v0, v1
    v_exp_f32 v4, v4
    v_mfma_f32_32x32x16_bf16 v[16:31], v[72:75], v[104:107], 0
    v_exp_f32 v5, v5
    v_cvt_pk_bf16_f32 v65, v2, v3
    v_exp_f32 v6, v6
    v_exp_f32 v7, v7
    v_cvt_pk_bf16_f32 v66, v4, v5
    v_exp_f32 v8, v8
    v_mfma_f32_32x32x8bf16_1k v[16:31], v[80:81], v[110:111], v[16:31]
    v_exp_f32 v9, v9
    v_cvt_pk_bf16_f32 v67, v6, v7
    v_exp_f32 v10, v10
    v_exp_f32 v11, v11
    v_cvt_pk_bf16_f32 v68, v8, v9
    v_mfma_f32_32x32x16_bf16 v[32:47], v[84:87], v[64:67], v[32:47]
    v_exp_f32 v12, v12
    v_exp_f32 v13, v13
    v_cvt_pk_bf16_f32 v69, v10, v11
    v_exp_f32 v14, v14
    v_exp_f32 v15, v15
    v_cvt_pk_bf16_f32 v70, v12, v13
    v_cvt_pk_bf16_f32 v71, v14, v15
    s_waitcnt lgkmcnt(0)
    v_exp_f32 v16, v16
    v_exp_f32 v17, v17
    v_mfma_f32_32x32x16_bf16 v[32:47], v[88:91], v[68:71], v[32:47]
    v_exp_f32 v18, v18
    v_exp_f32 v19, v19
    v_cvt_pk_bf16_f32 v64, v16, v17
    v_exp_f32 v20, v20
    v_mfma_f32_32x32x16_bf16 v[0:15], v[76:79], v[100:103], 0
    v_exp_f32 v21, v21
    v_cvt_pk_bf16_f32 v65, v18, v19
    v_exp_f32 v22, v22
    v_exp_f32 v23, v23
    v_cvt_pk_bf16_f32 v66, v20, v21
    v_exp_f32 v24, v24
    v_mfma_f32_32x32x8bf16_1k v[0:15], v[82:83], v[108:109], v[0:15]
    v_exp_f32 v25, v25
    v_cvt_pk_bf16_f32 v67, v22, v23
    v_exp_f32 v26, v26
    v_exp_f32 v27, v27
    v_cvt_pk_bf16_f32 v68, v24, v25
    v_mfma_f32_32x32x16_bf16 v[48:63], v[84:87], v[64:67], v[48:63]
    v_exp_f32 v28, v28
    v_exp_f32 v29, v29
    v_cvt_pk_bf16_f32 v69, v26, v27
    v_exp_f32 v30, v30
    v_exp_f32 v31, v31
    v_cvt_pk_bf16_f32 v70, v28, v29
    v_cvt_pk_bf16_f32 v71, v30, v31
    v_exp_f32 v0, v0
    v_exp_f32 v1, v1
    v_mfma_f32_32x32x16_bf16 v[48:63], v[88:91], v[68:71], v[48:63]
    ds_read_b128 v[72:75], v112 offset:5120
    s_mov_b64 exec, s[58:59]
    ds_read_b64 v[80:81], v113 offset:6144
    s_mov_b64 exec, s[56:57]
    ds_read_b128 v[84:87], v114 offset:6400
    ds_read_b128 v[88:91], v114 offset:7040
    s_mov_b64 exec, -1
    v_exp_f32 v2, v2
    v_exp_f32 v3, v3
    v_cvt_pk_bf16_f32 v64, v0, v1
    v_exp_f32 v4, v4
    v_mfma_f32_32x32x16_bf16 v[16:31], v[76:79], v[104:107], 0
    v_exp_f32 v5, v5
    v_cvt_pk_bf16_f32 v65, v2, v3
    v_exp_f32 v6, v6
    v_exp_f32 v7, v7
    v_cvt_pk_bf16_f32 v66, v4, v5
    v_exp_f32 v8, v8
    v_mfma_f32_32x32x8bf16_1k v[16:31], v[82:83], v[110:111], v[16:31]
    v_exp_f32 v9, v9
    v_cvt_pk_bf16_f32 v67, v6, v7
    v_exp_f32 v10, v10
    v_exp_f32 v11, v11
    v_cvt_pk_bf16_f32 v68, v8, v9
    v_mfma_f32_32x32x16_bf16 v[32:47], v[92:95], v[64:67], v[32:47]
    v_exp_f32 v12, v12
    v_exp_f32 v13, v13
    v_cvt_pk_bf16_f32 v69, v10, v11
    v_exp_f32 v14, v14
    v_exp_f32 v15, v15
    v_cvt_pk_bf16_f32 v70, v12, v13
    v_cvt_pk_bf16_f32 v71, v14, v15
    s_waitcnt lgkmcnt(0)
    v_exp_f32 v16, v16
    v_exp_f32 v17, v17
    v_mfma_f32_32x32x16_bf16 v[32:47], v[96:99], v[68:71], v[32:47]
    v_exp_f32 v18, v18
    v_exp_f32 v19, v19
    v_cvt_pk_bf16_f32 v64, v16, v17
    v_exp_f32 v20, v20
    v_mfma_f32_32x32x16_bf16 v[0:15], v[72:75], v[100:103], 0
    v_exp_f32 v21, v21
    v_cvt_pk_bf16_f32 v65, v18, v19
    v_exp_f32 v22, v22
    v_exp_f32 v23, v23
    v_cvt_pk_bf16_f32 v66, v20, v21
    v_exp_f32 v24, v24
    v_mfma_f32_32x32x8bf16_1k v[0:15], v[80:81], v[108:109], v[0:15]
    v_exp_f32 v25, v25
    v_cvt_pk_bf16_f32 v67, v22, v23
    v_exp_f32 v26, v26
    v_exp_f32 v27, v27
    v_cvt_pk_bf16_f32 v68, v24, v25
    v_mfma_f32_32x32x16_bf16 v[48:63], v[92:95], v[64:67], v[48:63]
    v_exp_f32 v28, v28
    v_exp_f32 v29, v29
    v_cvt_pk_bf16_f32 v69, v26, v27
    v_exp_f32 v30, v30
    v_exp_f32 v31, v31
    v_cvt_pk_bf16_f32 v70, v28, v29
    v_cvt_pk_bf16_f32 v71, v30, v31
    v_exp_f32 v0, v0
    v_exp_f32 v1, v1
    v_mfma_f32_32x32x16_bf16 v[48:63], v[96:99], v[68:71], v[48:63]
    ds_read_b128 v[76:79], v112 offset:7680
    s_mov_b64 exec, s[58:59]
    ds_read_b64 v[82:83], v113 offset:8704
    s_mov_b64 exec, s[56:57]
    ds_read_b128 v[92:95], v114 offset:8960
    ds_read_b128 v[96:99], v114 offset:9600
    s_mov_b64 exec, -1
    v_exp_f32 v2, v2
    v_exp_f32 v3, v3
    v_cvt_pk_bf16_f32 v64, v0, v1
    v_exp_f32 v4, v4
    v_mfma_f32_32x32x16_bf16 v[16:31], v[72:75], v[104:107], 0
    v_exp_f32 v5, v5
    v_cvt_pk_bf16_f32 v65, v2, v3
    v_exp_f32 v6, v6
    v_exp_f32 v7, v7
    v_cvt_pk_bf16_f32 v66, v4, v5
    v_exp_f32 v8, v8
    v_mfma_f32_32x32x8bf16_1k v[16:31], v[80:81], v[110:111], v[16:31]
    v_exp_f32 v9, v9
    v_cvt_pk_bf16_f32 v67, v6, v7
    v_exp_f32 v10, v10
    v_exp_f32 v11, v11
    v_cvt_pk_bf16_f32 v68, v8, v9
    v_mfma_f32_32x32x16_bf16 v[32:47], v[84:87], v[64:67], v[32:47]
    v_exp_f32 v12, v12
    v_exp_f32 v13, v13
    v_cvt_pk_bf16_f32 v69, v10, v11
    v_exp_f32 v14, v14
    v_exp_f32 v15, v15
    v_cvt_pk_bf16_f32 v70, v12, v13
    v_cvt_pk_bf16_f32 v71, v14, v15
    s_waitcnt lgkmcnt(0)
    v_exp_f32 v16, v16
    v_exp_f32 v17, v17
    v_mfma_f32_32x32x16_bf16 v[32:47], v[88:91], v[68:71], v[32:47]
    v_exp_f32 v18, v18
    v_exp_f32 v19, v19
    v_cvt_pk_bf16_f32 v64, v16, v17
    v_exp_f32 v20, v20
    v_mfma_f32_32x32x16_bf16 v[0:15], v[76:79], v[100:103], 0
    v_exp_f32 v21, v21
    v_cvt_pk_bf16_f32 v65, v18, v19
    v_exp_f32 v22, v22
    v_exp_f32 v23, v23
    v_cvt_pk_bf16_f32 v66, v20, v21
    v_exp_f32 v24, v24
    v_mfma_f32_32x32x8bf16_1k v[0:15], v[82:83], v[108:109], v[0:15]
    v_exp_f32 v25, v25
    v_cvt_pk_bf16_f32 v67, v22, v23
    v_exp_f32 v26, v26
    v_exp_f32 v27, v27
    v_cvt_pk_bf16_f32 v68, v24, v25
    v_mfma_f32_32x32x16_bf16 v[48:63], v[84:87], v[64:67], v[48:63]
    v_exp_f32 v28, v28
    v_exp_f32 v29, v29
    v_cvt_pk_bf16_f32 v69, v26, v27
    v_exp_f32 v30, v30
    v_exp_f32 v31, v31
    v_cvt_pk_bf16_f32 v70, v28, v29
    v_cvt_pk_bf16_f32 v71, v30, v31
    v_exp_f32 v0, v0
    v_exp_f32 v1, v1
    v_mfma_f32_32x32x16_bf16 v[48:63], v[88:91], v[68:71], v[48:63]
    ds_read_b128 v[72:75], v112 offset:10240
    s_mov_b64 exec, s[58:59]
    ds_read_b64 v[80:81], v113 offset:11264
    s_mov_b64 exec, s[56:57]
    ds_read_b128 v[84:87], v114 offset:11520
    ds_read_b128 v[88:91], v114 offset:12160
    s_mov_b64 exec, -1
    v_exp_f32 v2, v2
    v_exp_f32 v3, v3
    v_cvt_pk_bf16_f32 v64, v0, v1
    v_exp_f32 v4, v4
    v_mfma_f32_32x32x16_bf16 v[16:31], v[76:79], v[104:107], 0
    v_exp_f32 v5, v5
    v_cvt_pk_bf16_f32 v65, v2, v3
    v_exp_f32 v6, v6
    v_exp_f32 v7, v7
    v_cvt_pk_bf16_f32 v66, v4, v5
    v_exp_f32 v8, v8
    v_mfma_f32_32x32x8bf16_1k v[16:31], v[82:83], v[110:111], v[16:31]
    v_exp_f32 v9, v9
    v_cvt_pk_bf16_f32 v67, v6, v7
    v_exp_f32 v10, v10
    v_exp_f32 v11, v11
    v_cvt_pk_bf16_f32 v68, v8, v9
    v_mfma_f32_32x32x16_bf16 v[32:47], v[92:95], v[64:67], v[32:47]
    v_exp_f32 v12, v12
    v_exp_f32 v13, v13
    v_cvt_pk_bf16_f32 v69, v10, v11
    v_exp_f32 v14, v14
    v_exp_f32 v15, v15
    v_cvt_pk_bf16_f32 v70, v12, v13
    v_cvt_pk_bf16_f32 v71, v14, v15
    s_waitcnt lgkmcnt(0)
    v_exp_f32 v16, v16
    v_exp_f32 v17, v17
    v_mfma_f32_32x32x16_bf16 v[32:47], v[96:99], v[68:71], v[32:47]
    v_exp_f32 v18, v18
    v_exp_f32 v19, v19
    v_cvt_pk_bf16_f32 v64, v16, v17
    v_exp_f32 v20, v20
    v_mfma_f32_32x32x16_bf16 v[0:15], v[72:75], v[100:103], 0
    v_exp_f32 v21, v21
    v_cvt_pk_bf16_f32 v65, v18, v19
    v_exp_f32 v22, v22
    v_exp_f32 v23, v23
    v_cvt_pk_bf16_f32 v66, v20, v21
    v_exp_f32 v24, v24
    v_mfma_f32_32x32x8bf16_1k v[0:15], v[80:81], v[108:109], v[0:15]
    v_exp_f32 v25, v25
    v_cvt_pk_bf16_f32 v67, v22, v23
    v_exp_f32 v26, v26
    v_exp_f32 v27, v27
    v_cvt_pk_bf16_f32 v68, v24, v25
    v_mfma_f32_32x32x16_bf16 v[48:63], v[92:95], v[64:67], v[48:63]
    v_exp_f32 v28, v28
    v_exp_f32 v29, v29
    v_cvt_pk_bf16_f32 v69, v26, v27
    v_exp_f32 v30, v30
    v_exp_f32 v31, v31
    v_cvt_pk_bf16_f32 v70, v28, v29
    v_cvt_pk_bf16_f32 v71, v30, v31
    s_lshl_b32 s30, s42, 3
    s_add_u32 s30, s30, s20
    s_lshr_b32 s48, s2, 3
    s_lshl_b32 s48, s48, 5
    s_add_u32 s30, s30, s48
    s_cmp_lg_u32 s30, 31
    s_cbranch_scc1 L_nolate
    s_add_u32 s30, s2, 152
    s_lshl_b32 s30, s30, 7
    v_mov_b32 v120, s30
    v_mov_b32 v121, 1
    s_mov_b64 exec, 1
    buffer_store_dword v121, v120, s[44:47], 0 offen sc1
    s_mov_b64 exec, -1
L_nolate:
    v_exp_f32 v0, v0
    v_exp_f32 v1, v1
    v_mfma_f32_32x32x16_bf16 v[48:63], v[96:99], v[68:71], v[48:63]
    ds_read_b128 v[76:79], v112 offset:12800
    s_mov_b64 exec, s[58:59]
    ds_read_b64 v[82:83], v113 offset:13824
    s_mov_b64 exec, s[56:57]
    ds_read_b128 v[92:95], v114 offset:14080
    ds_read_b128 v[96:99], v114 offset:14720
    s_mov_b64 exec, -1
    v_exp_f32 v2, v2
    v_exp_f32 v3, v3
    v_cvt_pk_bf16_f32 v64, v0, v1
    v_exp_f32 v4, v4
    v_mfma_f32_32x32x16_bf16 v[16:31], v[72:75], v[104:107], 0
    v_exp_f32 v5, v5
    v_cvt_pk_bf16_f32 v65, v2, v3
    v_exp_f32 v6, v6
    v_exp_f32 v7, v7
    v_cvt_pk_bf16_f32 v66, v4, v5
    v_exp_f32 v8, v8
    v_mfma_f32_32x32x8bf16_1k v[16:31], v[80:81], v[110:111], v[16:31]
    v_exp_f32 v9, v9
    v_cvt_pk_bf16_f32 v67, v6, v7
    v_exp_f32 v10, v10
    v_exp_f32 v11, v11
    v_cvt_pk_bf16_f32 v68, v8, v9
    v_mfma_f32_32x32x16_bf16 v[32:47], v[84:87], v[64:67], v[32:47]
    v_exp_f32 v12, v12
    v_exp_f32 v13, v13
    v_cvt_pk_bf16_f32 v69, v10, v11
    v_exp_f32 v14, v14
    v_exp_f32 v15, v15
    v_cvt_pk_bf16_f32 v70, v12, v13
    v_cvt_pk_bf16_f32 v71, v14, v15
    s_waitcnt lgkmcnt(0)
    v_exp_f32 v16, v16
    v_exp_f32 v17, v17
    v_mfma_f32_32x32x16_bf16 v[32:47], v[88:91], v[68:71], v[32:47]
    v_exp_f32 v18, v18
    v_exp_f32 v19, v19
    v_cvt_pk_bf16_f32 v64, v16, v17
    v_exp_f32 v20, v20
    v_mfma_f32_32x32x16_bf16 v[0:15], v[76:79], v[100:103], 0
    v_exp_f32 v21, v21
    v_cvt_pk_bf16_f32 v65, v18, v19
    v_exp_f32 v22, v22
    v_exp_f32 v23, v23
    v_cvt_pk_bf16_f32 v66, v20, v21
    v_exp_f32 v24, v24
    v_mfma_f32_32x32x8bf16_1k v[0:15], v[82:83], v[108:109], v[0:15]
    v_exp_f32 v25, v25
    v_cvt_pk_bf16_f32 v67, v22, v23
    v_exp_f32 v26, v26
    v_exp_f32 v27, v27
    v_cvt_pk_bf16_f32 v68, v24, v25
    v_mfma_f32_32x32x16_bf16 v[48:63], v[84:87], v[64:67], v[48:63]
    v_exp_f32 v28, v28
    v_exp_f32 v29, v29
    v_cvt_pk_bf16_f32 v69, v26, v27
    v_exp_f32 v30, v30
    v_exp_f32 v31, v31
    v_cvt_pk_bf16_f32 v70, v28, v29
    v_cvt_pk_bf16_f32 v71, v30, v31
    v_exp_f32 v0, v0
    v_exp_f32 v1, v1
    v_mfma_f32_32x32x16_bf16 v[48:63], v[88:91], v[68:71], v[48:63]
    ds_read_b128 v[72:75], v112 offset:15360
    s_mov_b64 exec, s[58:59]
    ds_read_b64 v[80:81], v113 offset:16384
    s_mov_b64 exec, s[56:57]
    ds_read_b128 v[84:87], v114 offset:16640
    ds_read_b128 v[88:91], v114 offset:17280
    s_mov_b64 exec, -1
    v_exp_f32 v2, v2
    v_exp_f32 v3, v3
    v_cvt_pk_bf16_f32 v64, v0, v1
    v_exp_f32 v4, v4
    v_mfma_f32_32x32x16_bf16 v[16:31], v[76:79], v[104:107], 0
    v_exp_f32 v5, v5
    v_cvt_pk_bf16_f32 v65, v2, v3
    v_exp_f32 v6, v6
    v_exp_f32 v7, v7
    v_cvt_pk_bf16_f32 v66, v4, v5
    v_exp_f32 v8, v8
    v_mfma_f32_32x32x8bf16_1k v[16:31], v[82:83], v[110:111], v[16:31]
    v_exp_f32 v9, v9
    v_cvt_pk_bf16_f32 v67, v6, v7
    v_exp_f32 v10, v10
    v_exp_f32 v11, v11
    v_cvt_pk_bf16_f32 v68, v8, v9
    v_mfma_f32_32x32x16_bf16 v[32:47], v[92:95], v[64:67], v[32:47]
    v_exp_f32 v12, v12
    v_exp_f32 v13, v13
    v_cvt_pk_bf16_f32 v69, v10, v11
    v_exp_f32 v14, v14
    v_exp_f32 v15, v15
    v_cvt_pk_bf16_f32 v70, v12, v13
    v_cvt_pk_bf16_f32 v71, v14, v15
    s_waitcnt lgkmcnt(0)
    s_cmp_ge_u32 s20, 4
    s_cbranch_scc1 L_y11
    s_setprio 1
L_y11:
    v_exp_f32 v16, v16
    v_exp_f32 v17, v17
    v_mfma_f32_32x32x16_bf16 v[32:47], v[96:99], v[68:71], v[32:47]
    v_exp_f32 v18, v18
    v_exp_f32 v19, v19
    v_cvt_pk_bf16_f32 v64, v16, v17
    v_exp_f32 v20, v20
    v_mfma_f32_32x32x16_bf16 v[0:15], v[72:75], v[100:103], 0
    v_exp_f32 v21, v21
    v_cvt_pk_bf16_f32 v65, v18, v19
    v_exp_f32 v22, v22
    v_exp_f32 v23, v23
    v_cvt_pk_bf16_f32 v66, v20, v21
    v_exp_f32 v24, v24
    v_mfma_f32_32x32x8bf16_1k v[0:15], v[80:81], v[108:109], v[0:15]
    v_exp_f32 v25, v25
    v_cvt_pk_bf16_f32 v67, v22, v23
    v_exp_f32 v26, v26
    v_exp_f32 v27, v27
    v_cvt_pk_bf16_f32 v68, v24, v25
    v_mfma_f32_32x32x16_bf16 v[48:63], v[92:95], v[64:67], v[48:63]
    v_exp_f32 v28, v28
    v_exp_f32 v29, v29
    v_cvt_pk_bf16_f32 v69, v26, v27
    v_exp_f32 v30, v30
    v_exp_f32 v31, v31
    v_cvt_pk_bf16_f32 v70, v28, v29
    v_cvt_pk_bf16_f32 v71, v30, v31
    v_exp_f32 v0, v0
    v_exp_f32 v1, v1
    v_mfma_f32_32x32x16_bf16 v[48:63], v[96:99], v[68:71], v[48:63]
    ds_read_b128 v[76:79], v112 offset:17920
    s_mov_b64 exec, s[58:59]
    ds_read_b64 v[82:83], v113 offset:18944
    s_mov_b64 exec, s[56:57]
    ds_read_b128 v[92:95], v114 offset:19200
    ds_read_b128 v[96:99], v114 offset:19840
    s_mov_b64 exec, -1
    v_exp_f32 v2, v2
    v_exp_f32 v3, v3
    v_cvt_pk_bf16_f32 v64, v0, v1
    v_exp_f32 v4, v4
    v_mfma_f32_32x32x16_bf16 v[16:31], v[72:75], v[104:107], 0
    v_exp_f32 v5, v5
    v_cvt_pk_bf16_f32 v65, v2, v3
    v_exp_f32 v6, v6
    v_exp_f32 v7, v7
    v_cvt_pk_bf16_f32 v66, v4, v5
    v_exp_f32 v8, v8
    v_mfma_f32_32x32x8bf16_1k v[16:31], v[80:81], v[110:111], v[16:31]
    v_exp_f32 v9, v9
    v_cvt_pk_bf16_f32 v67, v6, v7
    v_exp_f32 v10, v10
    v_exp_f32 v11, v11
    v_cvt_pk_bf16_f32 v68, v8, v9
    v_mfma_f32_32x32x16_bf16 v[32:47], v[84:87], v[64:67], v[32:47]
    v_exp_f32 v12, v12
    v_exp_f32 v13, v13
    v_cvt_pk_bf16_f32 v69, v10, v11
    v_exp_f32 v14, v14
    v_exp_f32 v15, v15
    v_cvt_pk_bf16_f32 v70, v12, v13
    v_cvt_pk_bf16_f32 v71, v14, v15
    s_waitcnt lgkmcnt(0)
    v_exp_f32 v16, v16
    v_exp_f32 v17, v17
    v_mfma_f32_32x32x16_bf16 v[32:47], v[88:91], v[68:71], v[32:47]
    v_exp_f32 v18, v18
    v_exp_f32 v19, v19
    v_cvt_pk_bf16_f32 v64, v16, v17
    v_exp_f32 v20, v20
    v_mfma_f32_32x32x16_bf16 v[0:15], v[76:79], v[100:103], 0
    v_exp_f32 v21, v21
    v_cvt_pk_bf16_f32 v65, v18, v19
    v_exp_f32 v22, v22
    v_exp_f32 v23, v23
    v_cvt_pk_bf16_f32 v66, v20, v21
    v_exp_f32 v24, v24
    v_mfma_f32_32x32x8bf16_1k v[0:15], v[82:83], v[108:109], v[0:15]
    v_exp_f32 v25, v25
    v_cvt_pk_bf16_f32 v67, v22, v23
    v_exp_f32 v26, v26
    v_exp_f32 v27, v27
    v_cvt_pk_bf16_f32 v68, v24, v25
    v_mfma_f32_32x32x16_bf16 v[48:63], v[84:87], v[64:67], v[48:63]
    v_exp_f32 v28, v28
    v_exp_f32 v29, v29
    v_cvt_pk_bf16_f32 v69, v26, v27
    v_exp_f32 v30, v30
    v_exp_f32 v31, v31
    v_cvt_pk_bf16_f32 v70, v28, v29
    v_cvt_pk_bf16_f32 v71, v30, v31
    v_exp_f32 v0, v0
    v_exp_f32 v1, v1
    v_mfma_f32_32x32x16_bf16 v[48:63], v[88:91], v[68:71], v[48:63]
    s_waitcnt vmcnt(0)
    s_barrier
    s_setprio 2
    v_add_u32 v112, s43, v112
    v_add_u32 v113, s43, v113
    v_add_u32 v114, s43, v114
    ds_read_b128 v[72:75], v112 offset:0
    s_mov_b64 exec, s[58:59]
    ds_read_b64 v[80:81], v113 offset:1024
    s_mov_b64 exec, s[56:57]
    ds_read_b128 v[84:87], v114 offset:1280
    ds_read_b128 v[88:91], v114 offset:1920
    s_mov_b64 exec, -1
    s_cmp_ge_u32 s42, 2
    s_cbranch_scc1 L_att_nodma
    s_add_u32 m0, s29, 0
    s_add_u32 s30, s24, 0
    buffer_load_dwordx4 v115, s[4:7], s30 offen sc1 lds
    s_add_u32 m0, s29, 4096
    s_add_u32 s30, s24, 4096
    buffer_load_dwordx4 v115, s[4:7], s30 offen sc1 lds
    s_add_u32 m0, s29, 8192
    s_add_u32 s30, s24, 8192
    buffer_load_dwordx4 v115, s[4:7], s30 offen sc1 lds
    s_add_u32 m0, s29, 12288
    s_add_u32 s30, s24, 12288
    buffer_load_dwordx4 v115, s[4:7], s30 offen sc1 lds
    s_add_u32 m0, s29, 16384
    s_add_u32 s30, s24, 16384
    buffer_load_dwordx4 v115, s[4:7], s30 offen sc1 lds
    s_add_u32 s24, s24, 20480
    s_mov_b32 s29, s31
L_att_nodma:
    v_exp_f32 v2, v2
    v_exp_f32 v3, v3
    v_cvt_pk_bf16_f32 v64, v0, v1
    v_exp_f32 v4, v4
    v_mfma_f32_32x32x16_bf16 v[16:31], v[76:79], v[104:107], 0
    v_exp_f32 v5, v5
    v_cvt_pk_bf16_f32 v65, v2, v3
    v_exp_f32 v6, v6
    v_exp_f32 v7, v7
    v_cvt_pk_bf16_f32 v66, v4, v5
    v_exp_f32 v8, v8
    v_mfma_f32_32x32x8bf16_1k v[16:31], v[82:83], v[110:111], v[16:31]
    v_exp_f32 v9, v9
    v_cvt_pk_bf16_f32 v67, v6, v7
    v_exp_f32 v10, v10
    v_exp_f32 v11, v11
    v_cvt_pk_bf16_f32 v68, v8, v9
    v_mfma_f32_32x32x16_bf16 v[32:47], v[92:95], v[64:67], v[32:47]
    v_exp_f32 v12, v12
    v_exp_f32 v13, v13
    v_cvt_pk_bf16_f32 v69, v10, v11
    v_exp_f32 v14, v14
    v_exp_f32 v15, v15
    v_cvt_pk_bf16_f32 v70, v12, v13
    v_cvt_pk_bf16_f32 v71, v14, v15
    s_waitcnt lgkmcnt(0)
    v_exp_f32 v16, v16
    v_exp_f32 v17, v17
    v_mfma_f32_32x32x16_bf16 v[32:47], v[96:99], v[68:71], v[32:47]
    v_exp_f32 v18, v18
    v_exp_f32 v19, v19
    v_cvt_pk_bf16_f32 v64, v16, v17
    v_exp_f32 v20, v20
    v_mfma_f32_32x32x16_bf16 v[0:15], v[72:75], v[100:103], 0
    v_exp_f32 v21, v21
    v_cvt_pk_bf16_f32 v65, v18, v19
    v_exp_f32 v22, v22
    v_exp_f32 v23, v23
    v_cvt_pk_bf16_f32 v66, v20, v21
    v_exp_f32 v24, v24
    v_mfma_f32_32x32x8bf16_1k v[0:15], v[80:81], v[108:109], v[0:15]
    v_exp_f32 v25, v25
    v_cvt_pk_bf16_f32 v67, v22, v23
    v_exp_f32 v26, v26
    v_exp_f32 v27, v27
    v_cvt_pk_bf16_f32 v68, v24, v25
    v_mfma_f32_32x32x16_bf16 v[48:63], v[92:95], v[64:67], v[48:63]
    v_exp_f32 v28, v28
    v_exp_f32 v29, v29
    v_cvt_pk_bf16_f32 v69, v26, v27
    v_exp_f32 v30, v30
    v_exp_f32 v31, v31
    v_cvt_pk_bf16_f32 v70, v28, v29
    v_cvt_pk_bf16_f32 v71, v30, v31
    s_sub_u32 s43, 0, s43
    s_add_u32 s42, s42, 1
    s_cmp_lt_u32 s42, 4
    s_cbranch_scc1 L_att_loop
    v_mfma_f32_32x32x16_bf16 v[48:63], v[96:99], v[68:71], v[48:63]
    s_mul_i32 s48, s25, 3072
    s_add_u32 s49, s48, s28
    s_xor_b32 s50, s28, 40960
    s_add_u32 s50, s50, s48
    v_add_u32 v120, s49, v115
    v_add_u32 v121, s50, v115
    s_nop 5
    ds_write_b128 v120, v[48:51] offset:0
    ds_write_b128 v120, v[52:55] offset:1024
    ds_write_b128 v120, v[56:59] offset:2048
    s_waitcnt lgkmcnt(0)
    s_barrier
    ds_read_b128 v[0:3], v121 offset:0
    ds_read_b128 v[4:7], v121 offset:1024
    ds_read_b128 v[8:11], v121 offset:2048
    s_mov_b32 s49, 0x1f8
    s_mov_b32 s50, 0x71800000
    s_waitcnt lgkmcnt(0)
    v_add_f32 v32, v32, v0
    v_add_f32 v33, v33, v1
    v_add_f32 v34, v34, v2
    v_add_f32 v35, v35, v3
    v_add_f32 v36, v36, v4
    v_add_f32 v37, v37, v5
    v_add_f32 v38, v38, v6
    v_add_f32 v39, v39, v7
    v_add_f32 v40, v40, v8
    v_add_f32 v41, v41, v9
    v_add_f32 v42, v42, v10
    v_add_f32 v43, v43, v11
    v_mov_b32 v121, v40
    v_mov_b32 v120, v40
    s_mov_b64 s[52:53], -1
    v_cmp_class_f32_e64 vcc, v32, s49
    s_and_b64 s[52:53], s[52:53], vcc
    v_cmp_class_f32_e64 vcc, v33, s49
    s_and_b64 s[52:53], s[52:53], vcc
    v_cmp_class_f32_e64 vcc, v34, s49
    s_and_b64 s[52:53], s[52:53], vcc
    v_cmp_class_f32_e64 vcc, v35, s49
    s_and_b64 s[52:53], s[52:53], vcc
    v_cmp_class_f32_e64 vcc, v36, s49
    s_and_b64 s[52:53], s[52:53], vcc
    v_cmp_class_f32_e64 vcc, v37, s49
    s_and_b64 s[52:53], s[52:53], vcc
    v_cmp_class_f32_e64 vcc, v38, s49
    s_and_b64 s[52:53], s[52:53], vcc
    v_cmp_class_f32_e64 vcc, v39, s49
    s_and_b64 s[52:53], s[52:53], vcc
    v_cmp_class_f32_e64 vcc, v40, s49
    s_and_b64 s[52:53], s[52:53], vcc
    v_cmp_class_f32_e64 vcc, v41, s49
    s_and_b64 s[52:53], s[52:53], vcc
    v_cmp_class_f32_e64 vcc, v42, s49
    s_and_b64 s[52:53], s[52:53], vcc
    v_cmp_class_f32_e64 vcc, v43, s49
    s_and_b64 s[52:53], s[52:53], vcc
    v_permlane32_swap_b32 v121, v120
    v_max3_f32 v122, abs(v32), abs(v33), abs(v34)
    v_max3_f32 v123, abs(v35), abs(v36), abs(v37)
    v_max3_f32 v122, v122, abs(v38), abs(v39)
    v_max_f32 v122, v122, v123
    v_cmp_le_f32 vcc, 0x8800000, v122
    s_and_b64 s[52:53], s[52:53], vcc
    v_cmp_ge_f32 vcc, s50, v120
    s_and_b64 s[52:53], s[52:53], vcc
    s_cmp_eq_u64 s[52:53], -1
    s_cbranch_scc0 L_att_slow
L_att_fin:
    v_rcp_f32 v120, v120
    v_lshl_add_u32 v121, v117, 8, v119
    v_mul_f32 v32, v32, v120
    v_mul_f32 v33, v33, v120
    v_mul_f32 v34, v34, v120
    v_mul_f32 v35, v35, v120
    v_mul_f32 v36, v36, v120
    v_mul_f32 v37, v37, v120
    v_mul_f32 v38, v38, v120
    v_mul_f32 v39, v39, v120
    v_mul_f32 v40, v40, v120
    v_mul_f32 v41, v41, v120
    v_mul_f32 v42, v42, v120
    v_mul_f32 v43, v43, v120
    v_cvt_pk_bf16_f32 v64, v32, v33
    v_cvt_pk_bf16_f32 v65, v34, v35
    v_cvt_pk_bf16_f32 v66, v36, v37
    v_cvt_pk_bf16_f32 v67, v38, v39
    v_cvt_pk_bf16_f32 v68, v40, v41
    v_cvt_pk_bf16_f32 v69, v42, v43
    buffer_store_dwordx4 v[64:67], v121, s[16:19], s41 offen sc1
    s_mov_b32 exec_hi, 0
    buffer_store_dwordx2 v[68:69], v119, s[16:19], s40 offen sc1
    s_mov_b32 exec_hi, -1
    s_lshr_b32 s31, s2, 5
    s_waitcnt vmcnt(0)
    s_barrier
    s_cmp_lg_u32 s20, 0
    s_cbranch_scc1 L_arr_o
    s_add_u32 s30, s31, 32
    s_lshl_b32 s30, s30, 7
    v_mov_b32 v2, s30
    v_mov_b32 v3, 1
    s_mov_b64 exec, 1
    buffer_atomic_add v3, v2, s[44:47], 0 offen sc0 sc1
    s_mul_i32 s30, s31, 2
    s_add_u32 s30, s30, 80
    s_waitcnt vmcnt(0)
    v_readfirstlane_b32 s55, v3
    s_mov_b64 exec, -1
    s_cmp_lg_u32 s55, 31
    s_cbranch_scc1 L_arr_o
    v_mbcnt_lo_u32_b32 v2, -1, 0
    v_add_lshl_u32 v2, v2, s30, 7
    v_mov_b32 v3, 1
    s_mov_b64 exec, 3
    buffer_store_dword v3, v2, s[44:47], 0 offen sc1
    s_mov_b64 exec, -1
L_arr_o:
    s_endpgm
L_att_slow:
    v_lshlrev_b32 v113, 3, v116
    v_mul_u32_u24 v114, 320, v117
    v_lshl_add_u32 v114, v116, 4, v114
    v_mov_b32 v120, 0xff800000
    s_not_b64 exec, s[58:59]
    v_mov_b32 v108, 0
    s_mov_b64 exec, -1
    s_mov_b32 s42, s23
    s_add_u32 s43, s23, 163840
L_att_slow1:
    buffer_load_dwordx4 v[72:75], v115, s[4:7], s42 offen sc1
    buffer_load_dwordx2 v[80:81], v113, s[4:7], s42 offen offset:1024 sc1
    s_waitcnt vmcnt(0)
    v_mfma_f32_32x32x16_bf16 v[0:15], v[72:75], v[100:103], 0
    s_nop 9
    v_mfma_f32_32x32x8bf16_1k v[0:15], v[80:81], v[108:109], v[0:15]
    s_nop 11
    v_max3_f32 v120, v120, v0, v1
    v_max3_f32 v120, v120, v2, v3
    v_max3_f32 v120, v120, v4, v5
    v_max3_f32 v120, v120, v6, v7
    v_max3_f32 v120, v120, v8, v9
    v_max3_f32 v120, v120, v10, v11
    v_max3_f32 v120, v120, v12, v13
    v_max3_f32 v120, v120, v14, v15
    s_add_u32 s42, s42, 2560
    s_cmp_lt_u32 s42, s43
    s_cbranch_scc1 L_att_slow1
    v_mov_b32 v121, v120
    s_nop 1
    v_permlane32_swap_b32 v120, v121
    s_nop 1
    v_max_f32 v120, v120, v121
    v_sub_f32 v120, 0, v120
    v_mov_b32 v16, v120
    v_mov_b32 v32, 0
    v_mov_b32 v17, v120
    v_mov_b32 v33, 0
    v_mov_b32 v18, v120
    v_mov_b32 v34, 0
    v_mov_b32 v19, v120
    v_mov_b32 v35, 0
    v_mov_b32 v20, v120
    v_mov_b32 v36, 0
    v_mov_b32 v21, v120
    v_mov_b32 v37, 0
    v_mov_b32 v22, v120
    v_mov_b32 v38, 0
    v_mov_b32 v23, v120
    v_mov_b32 v39, 0
    v_mov_b32 v24, v120
    v_mov_b32 v40, 0
    v_mov_b32 v25, v120
    v_mov_b32 v41, 0
    v_mov_b32 v26, v120
    v_mov_b32 v42, 0
    v_mov_b32 v27, v120
    v_mov_b32 v43, 0
    v_mov_b32 v28, v120
    v_mov_b32 v44, 0
    v_mov_b32 v29, v120
    v_mov_b32 v45, 0
    v_mov_b32 v30, v120
    v_mov_b32 v46, 0
    v_mov_b32 v31, v120
    v_mov_b32 v47, 0
    s_mov_b32 s42, s23
L_att_slow2:
    buffer_load_dwordx4 v[72:75], v115, s[4:7], s42 offen sc1
    buffer_load_dwordx2 v[80:81], v113, s[4:7], s42 offen offset:1024 sc1
    s_mov_b64 exec, s[56:57]
    buffer_load_dwordx4 v[84:87], v114, s[4:7], s42 offen offset:1280 sc1
    buffer_load_dwordx4 v[88:91], v114, s[4:7], s42 offen offset:1920 sc1
    s_mov_b64 exec, -1
    s_waitcnt vmcnt(0)
    v_mfma_f32_32x32x16_bf16 v[0:15], v[72:75], v[100:103], v[16:31]
    s_nop 9
    v_mfma_f32_32x32x8bf16_1k v[0:15], v[80:81], v[108:109], v[0:15]
    s_nop 11
    v_exp_f32 v0, v0
    v_exp_f32 v1, v1
    v_exp_f32 v2, v2
    v_exp_f32 v3, v3
    v_exp_f32 v4, v4
    v_exp_f32 v5, v5
    v_exp_f32 v6, v6
    v_exp_f32 v7, v7
    v_exp_f32 v8, v8
    v_exp_f32 v9, v9
    v_exp_f32 v10, v10
    v_exp_f32 v11, v11
    v_exp_f32 v12, v12
    v_exp_f32 v13, v13
    v_exp_f32 v14, v14
    v_exp_f32 v15, v15
    v_cvt_pk_bf16_f32 v64, v0, v1
    v_cvt_pk_bf16_f32 v65, v2, v3
    v_cvt_pk_bf16_f32 v66, v4, v5
    v_cvt_pk_bf16_f32 v67, v6, v7
    v_cvt_pk_bf16_f32 v68, v8, v9
    v_cvt_pk_bf16_f32 v69, v10, v11
    v_cvt_pk_bf16_f32 v70, v12, v13
    v_cvt_pk_bf16_f32 v71, v14, v15
    s_nop 1
    v_mfma_f32_32x32x16_bf16 v[32:47], v[84:87], v[64:67], v[32:47]
    v_mfma_f32_32x32x16_bf16 v[32:47], v[88:91], v[68:71], v[32:47]
    s_add_u32 s42, s42, 2560
    s_cmp_lt_u32 s42, s43
    s_cbranch_scc1 L_att_slow2
    s_nop 11
    v_mov_b32 v121, v40
    v_mov_b32 v120, v40
    s_nop 1
    v_permlane32_swap_b32 v121, v120
    s_nop 1
    s_branch L_att_fin
.p2align 6
L_B:
    s_sub_u32 s2, s2, 256
    s_mov_b32 s23, s2
    s_load_dwordx4 s[16:19], s[0:1], 32
    s_lshl_b32 s30, s2, 3
    s_add_u32 s30, s30, s20
    s_cmp_lg_u32 s30, 1831
    s_cbranch_scc1 L_nozero
    v_lshlrev_b32 v5, 4, v103
    v_mov_b32 v8, 0
    v_mov_b32 v9, 0
    v_mov_b32 v10, 0
    v_mov_b32 v11, 0
    s_waitcnt lgkmcnt(0)
    s_add_u32 s44, s38, 19988480
    s_addc_u32 s45, s39, 0
    s_mov_b32 s46, 20480
    s_mov_b32 s47, 0x00020000
    s_mov_b32 s60, s36
    s_mov_b32 s61, s37
    s_mov_b32 s62, 256
    s_mov_b32 s63, 0x00020000
    s_mov_b32 s30, 0
    buffer_store_dwordx4 v[8:11], v5, s[44:47], s30 offen offset:0 sc1
    buffer_store_dwordx4 v[8:11], v5, s[44:47], s30 offen offset:1024 sc1
    buffer_store_dwordx4 v[8:11], v5, s[44:47], s30 offen offset:2048 sc1
    buffer_store_dwordx4 v[8:11], v5, s[44:47], s30 offen offset:3072 sc1
    s_mov_b32 s30, 4096
    buffer_store_dwordx4 v[8:11], v5, s[44:47], s30 offen offset:0 sc1
    buffer_store_dwordx4 v[8:11], v5, s[44:47], s30 offen offset:1024 sc1
    buffer_store_dwordx4 v[8:11], v5, s[44:47], s30 offen offset:2048 sc1
    buffer_store_dwordx4 v[8:11], v5, s[44:47], s30 offen offset:3072 sc1
    s_mov_b32 s30, 8192
    buffer_store_dwordx4 v[8:11], v5, s[44:47], s30 offen offset:0 sc1
    buffer_store_dwordx4 v[8:11], v5, s[44:47], s30 offen offset:1024 sc1
    buffer_store_dwordx4 v[8:11], v5, s[44:47], s30 offen offset:2048 sc1
    buffer_store_dwordx4 v[8:11], v5, s[44:47], s30 offen offset:3072 sc1
    s_mov_b32 s30, 12288
    buffer_store_dwordx4 v[8:11], v5, s[44:47], s30 offen offset:0 sc1
    buffer_store_dwordx4 v[8:11], v5, s[44:47], s30 offen offset:1024 sc1
    buffer_store_dwordx4 v[8:11], v5, s[44:47], s30 offen offset:2048 sc1
    buffer_store_dwordx4 v[8:11], v5, s[44:47], s30 offen offset:3072 sc1
    s_mov_b32 s30, 16384
    buffer_store_dwordx4 v[8:11], v5, s[44:47], s30 offen offset:0 sc1
    buffer_store_dwordx4 v[8:11], v5, s[44:47], s30 offen offset:1024 sc1
    buffer_store_dwordx4 v[8:11], v5, s[44:47], s30 offen offset:2048 sc1
    buffer_store_dwordx4 v[8:11], v5, s[44:47], s30 offen offset:3072 sc1
    v_lshlrev_b32 v6, 3, v5
    v_mov_b32 v5, 1
    s_waitcnt vmcnt(0)
    s_mov_b64 exec, 3
    buffer_store_dword v5, v6, s[60:63], 0 offen sc1
    s_mov_b64 exec, -1
L_nozero:
    v_lshlrev_b32 v100, 4, v103
    s_lshl_b32 s29, s20, 10
    s_and_b32 s31, s23, 3
    s_lshl_b32 s31, s31, 2
    s_bfe_u32 s30, s23, 0x20003
    s_add_u32 s31, s31, s30
    s_waitcnt lgkmcnt(0)
    s_setprio 3
    s_cmp_ge_u32 s20, 2
    s_cbranch_scc1 L_q_norows
    v_and_b32 v2, 15, v103
    v_lshrrev_b32 v3, 4, v103
    s_bfe_u32 s40, s23, 0x10002
    s_lshl_b32 s40, s40, 3
    s_lshr_b32 s41, s23, 5
    s_add_u32 s40, s40, s41
    s_lshl_b32 s41, s31, 4
    s_add_u32 s40, s40, s41
    s_lshl_b32 s40, s40, 1
    s_add_u32 s40, s40, s20
    s_lshl_b32 s40, s40, 2
    v_mul_u32_u24 v4, 1280, v3
    v_lshl_add_u32 v4, v2, 4, v4
    s_mul_i32 s42, s40, 1280
    s_mov_b32 s4, s32
    s_mov_b32 s5, s33
    s_mov_b32 s6, 2621440
    s_mov_b32 s7, 0x00020000
    buffer_load_dwordx4 v[8:11], v4, s[4:7], s42 offen offset:0
    buffer_load_dwordx4 v[12:15], v4, s[4:7], s42 offen offset:256
    buffer_load_dwordx4 v[16:19], v4, s[4:7], s42 offen offset:512
    buffer_load_dwordx4 v[20:23], v4, s[4:7], s42 offen offset:768
    buffer_load_dwordx4 v[24:27], v4, s[4:7], s42 offen offset:1024
    s_mov_b32 s8, s38
    s_mov_b32 s9, s39
    s_mov_b32 s10, 2621440
    s_mov_b32 s11, 0x00020000
    s_add_u32 s48, s38, 19922944
    s_addc_u32 s49, s39, 0
    s_mov_b32 s50, 16384
    s_mov_b32 s51, 0x00020000
    v_add_u32 v5, s40, v3
    s_lshr_b32 s43, s40, 5
    s_mul_i32 s43, s43, 40960
    v_and_b32 v7, 31, v5
    v_lshlrev_b32 v6, 4, v7
    v_lshl_add_u32 v6, v2, 9, v6
    v_lshlrev_b32 v5, 2, v5
    v_cmp_eq_u32 s[56:57], 0, v2
    s_waitcnt vmcnt(0)
    v_lshlrev_b32 v28, 16, v8
    v_and_b32 v29, 0xffff0000, v8
    v_lshlrev_b32 v30, 16, v9
    v_and_b32 v31, 0xffff0000, v9
    v_lshlrev_b32 v32, 16, v10
    v_and_b32 v33, 0xffff0000, v10
    v_lshlrev_b32 v34, 16, v11
    v_and_b32 v35, 0xffff0000, v11
    v_lshlrev_b32 v36, 16, v12
    v_and_b32 v37, 0xffff0000, v12
    v_lshlrev_b32 v38, 16, v13
    v_and_b32 v39, 0xffff0000, v13
    v_lshlrev_b32 v40, 16, v14
    v_and_b32 v41, 0xffff0000, v14
    v_lshlrev_b32 v42, 16, v15
    v_and_b32 v43, 0xffff0000, v15
    v_lshlrev_b32 v44, 16, v16
    v_and_b32 v45, 0xffff0000, v16
    v_lshlrev_b32 v46, 16, v17
    v_and_b32 v47, 0xffff0000, v17
    v_lshlrev_b32 v48, 16, v18
    v_and_b32 v49, 0xffff0000, v18
    v_lshlrev_b32 v50, 16, v19
    v_and_b32 v51, 0xffff0000, v19
    v_lshlrev_b32 v52, 16, v20
    v_and_b32 v53, 0xffff0000, v20
    v_lshlrev_b32 v54, 16, v21
    v_and_b32 v55, 0xffff0000, v21
    v_lshlrev_b32 v56, 16, v22
    v_and_b32 v57, 0xffff0000, v22
    v_lshlrev_b32 v58, 16, v23
    v_and_b32 v59, 0xffff0000, v23
    v_lshlrev_b32 v60, 16, v24
    v_and_b32 v61, 0xffff0000, v24
    v_lshlrev_b32 v62, 16, v25
    v_and_b32 v63, 0xffff0000, v25
    v_lshlrev_b32 v64, 16, v26
    v_and_b32 v65, 0xffff0000, v26
    v_lshlrev_b32 v66, 16, v27
    v_and_b32 v67, 0xffff0000, v27
    v_pk_add_f32 v[88:89], v[28:29], v[30:31]
    v_pk_add_f32 v[88:89], v[88:89], v[32:33]
    v_pk_add_f32 v[88:89], v[88:89], v[34:35]
    v_pk_add_f32 v[88:89], v[88:89], v[36:37]
    v_pk_add_f32 v[88:89], v[88:89], v[38:39]
    v_pk_add_f32 v[88:89], v[88:89], v[40:41]
    v_pk_add_f32 v[88:89], v[88:89], v[42:43]
    v_pk_add_f32 v[88:89], v[88:89], v[44:45]
    v_pk_add_f32 v[88:89], v[88:89], v[46:47]
    v_pk_add_f32 v[88:89], v[88:89], v[48:49]
    v_pk_add_f32 v[88:89], v[88:89], v[50:51]
    v_pk_add_f32 v[88:89], v[88:89], v[52:53]
    v_pk_add_f32 v[88:89], v[88:89], v[54:55]
    v_pk_add_f32 v[88:89], v[88:89], v[56:57]
    v_pk_add_f32 v[88:89], v[88:89], v[58:59]
    v_pk_add_f32 v[88:89], v[88:89], v[60:61]
    v_pk_add_f32 v[88:89], v[88:89], v[62:63]
    v_pk_add_f32 v[88:89], v[88:89], v[64:65]
    v_pk_add_f32 v[88:89], v[88:89], v[66:67]
    v_add_f32 v88, v88, v89
    s_nop 1
    v_add_f32_dpp v88, v88, v88 quad_perm:[1,0,3,2] row_mask:0xf bank_mask:0xf
    s_nop 1
    v_add_f32_dpp v88, v88, v88 quad_perm:[2,3,0,1] row_mask:0xf bank_mask:0xf
    s_nop 1
    v_add_f32_dpp v88, v88, v88 row_half_mirror row_mask:0xf bank_mask:0xf
    s_nop 1
    v_add_f32_dpp v88, v88, v88 row_mirror row_mask:0xf bank_mask:0xf
    v_mul_f32 v88, 0xbacccccd, v88
    v_pk_add_f32 v[28:29], v[28:29], v[88:89] op_sel_hi:[1,0]
    v_pk_add_f32 v[30:31], v[30:31], v[88:89] op_sel_hi:[1,0]
    v_pk_add_f32 v[32:33], v[32:33], v[88:89] op_sel_hi:[1,0]
    v_pk_add_f32 v[34:35], v[34:35], v[88:89] op_sel_hi:[1,0]
    v_pk_add_f32 v[36:37], v[36:37], v[88:89] op_sel_hi:[1,0]
    v_pk_add_f32 v[38:39], v[38:39], v[88:89] op_sel_hi:[1,0]
    v_pk_add_f32 v[40:41], v[40:41], v[88:89] op_sel_hi:[1,0]
    v_pk_add_f32 v[42:43], v[42:43], v[88:89] op_sel_hi:[1,0]
    v_pk_add_f32 v[44:45], v[44:45], v[88:89] op_sel_hi:[1,0]
    v_pk_add_f32 v[46:47], v[46:47], v[88:89] op_sel_hi:[1,0]
    v_pk_add_f32 v[48:49], v[48:49], v[88:89] op_sel_hi:[1,0]
    v_pk_add_f32 v[50:51], v[50:51], v[88:89] op_sel_hi:[1,0]
    v_pk_add_f32 v[52:53], v[52:53], v[88:89] op_sel_hi:[1,0]
    v_pk_add_f32 v[54:55], v[54:55], v[88:89] op_sel_hi:[1,0]
    v_pk_add_f32 v[56:57], v[56:57], v[88:89] op_sel_hi:[1,0]
    v_pk_add_f32 v[58:59], v[58:59], v[88:89] op_sel_hi:[1,0]
    v_pk_add_f32 v[60:61], v[60:61], v[88:89] op_sel_hi:[1,0]
    v_pk_add_f32 v[62:63], v[62:63], v[88:89] op_sel_hi:[1,0]
    v_pk_add_f32 v[64:65], v[64:65], v[88:89] op_sel_hi:[1,0]
    v_pk_add_f32 v[66:67], v[66:67], v[88:89] op_sel_hi:[1,0]
    v_pk_mul_f32 v[90:91], v[28:29], v[28:29]
    v_pk_fma_f32 v[90:91], v[30:31], v[30:31], v[90:91]
    v_pk_fma_f32 v[90:91], v[32:33], v[32:33], v[90:91]
    v_pk_fma_f32 v[90:91], v[34:35], v[34:35], v[90:91]
    v_pk_fma_f32 v[90:91], v[36:37], v[36:37], v[90:91]
    v_pk_fma_f32 v[90:91], v[38:39], v[38:39], v[90:91]
    v_pk_fma_f32 v[90:91], v[40:41], v[40:41], v[90:91]
    v_pk_fma_f32 v[90:91], v[42:43], v[42:43], v[90:91]
    v_pk_fma_f32 v[90:91], v[44:45], v[44:45], v[90:91]
    v_pk_fma_f32 v[90:91], v[46:47], v[46:47], v[90:91]
    v_pk_fma_f32 v[90:91], v[48:49], v[48:49], v[90:91]
    v_pk_fma_f32 v[90:91], v[50:51], v[50:51], v[90:91]
    v_pk_fma_f32 v[90:91], v[52:53], v[52:53], v[90:91]
    v_pk_fma_f32 v[90:91], v[54:55], v[54:55], v[90:91]
    v_pk_fma_f32 v[90:91], v[56:57], v[56:57], v[90:91]
    v_pk_fma_f32 v[90:91], v[58:59], v[58:59], v[90:91]
    v_pk_fma_f32 v[90:91], v[60:61], v[60:61], v[90:91]
    v_pk_fma_f32 v[90:91], v[62:63], v[62:63], v[90:91]
    v_pk_fma_f32 v[90:91], v[64:65], v[64:65], v[90:91]
    v_pk_fma_f32 v[90:91], v[66:67], v[66:67], v[90:91]
    v_add_f32 v89, v90, v91
    s_nop 1
    v_add_f32_dpp v89, v89, v89 quad_perm:[1,0,3,2] row_mask:0xf bank_mask:0xf
    s_nop 1
    v_add_f32_dpp v89, v89, v89 quad_perm:[2,3,0,1] row_mask:0xf bank_mask:0xf
    s_nop 1
    v_add_f32_dpp v89, v89, v89 row_half_mirror row_mask:0xf bank_mask:0xf
    s_nop 1
    v_add_f32_dpp v89, v89, v89 row_mirror row_mask:0xf bank_mask:0xf
    v_mov_b32 v90, 0x3727c5ac
    v_fmac_f32 v90, 0x3acccccd, v89
    v_rsq_f32 v90, v90
    v_sub_f32 v88, 0, v88
    s_mov_b64 exec, s[56:57]
    s_mov_b32 s41, 8192
    buffer_store_dword v88, v5, s[48:51], 0 offen sc1
    buffer_store_dword v90, v5, s[48:51], s41 offen sc1
    s_mov_b64 exec, -1
    v_pk_mul_f32 v[28:29], v[28:29], v[90:91] op_sel_hi:[1,0]
    v_pk_mul_f32 v[30:31], v[30:31], v[90:91] op_sel_hi:[1,0]
    v_pk_mul_f32 v[32:33], v[32:33], v[90:91] op_sel_hi:[1,0]
    v_pk_mul_f32 v[34:35], v[34:35], v[90:91] op_sel_hi:[1,0]
    v_pk_mul_f32 v[36:37], v[36:37], v[90:91] op_sel_hi:[1,0]
    v_pk_mul_f32 v[38:39], v[38:39], v[90:91] op_sel_hi:[1,0]
    v_pk_mul_f32 v[40:41], v[40:41], v[90:91] op_sel_hi:[1,0]
    v_pk_mul_f32 v[42:43], v[42:43], v[90:91] op_sel_hi:[1,0]
    v_pk_mul_f32 v[44:45], v[44:45], v[90:91] op_sel_hi:[1,0]
    v_pk_mul_f32 v[46:47], v[46:47], v[90:91] op_sel_hi:[1,0]
    v_pk_mul_f32 v[48:49], v[48:49], v[90:91] op_sel_hi:[1,0]
    v_pk_mul_f32 v[50:51], v[50:51], v[90:91] op_sel_hi:[1,0]
    v_pk_mul_f32 v[52:53], v[52:53], v[90:91] op_sel_hi:[1,0]
    v_pk_mul_f32 v[54:55], v[54:55], v[90:91] op_sel_hi:[1,0]
    v_pk_mul_f32 v[56:57], v[56:57], v[90:91] op_sel_hi:[1,0]
    v_pk_mul_f32 v[58:59], v[58:59], v[90:91] op_sel_hi:[1,0]
    v_pk_mul_f32 v[60:61], v[60:61], v[90:91] op_sel_hi:[1,0]
    v_pk_mul_f32 v[62:63], v[62:63], v[90:91] op_sel_hi:[1,0]
    v_pk_mul_f32 v[64:65], v[64:65], v[90:91] op_sel_hi:[1,0]
    v_pk_mul_f32 v[66:67], v[66:67], v[90:91] op_sel_hi:[1,0]
    v_cvt_pk_bf16_f32 v8, v28, v29
    v_cvt_pk_bf16_f32 v9, v30, v31
    v_cvt_pk_bf16_f32 v10, v32, v33
    v_cvt_pk_bf16_f32 v11, v34, v35
    buffer_store_dwordx4 v[8:11], v6, s[8:11], s43 offen sc1
    s_add_u32 s43, s43, 8192
    v_cvt_pk_bf16_f32 v12, v36, v37
    v_cvt_pk_bf16_f32 v13, v38, v39
    v_cvt_pk_bf16_f32 v14, v40, v41
    v_cvt_pk_bf16_f32 v15, v42, v43
    buffer_store_dwordx4 v[12:15], v6, s[8:11], s43 offen sc1
    s_add_u32 s43, s43, 8192
    v_cvt_pk_bf16_f32 v16, v44, v45
    v_cvt_pk_bf16_f32 v17, v46, v47
    v_cvt_pk_bf16_f32 v18, v48, v49
    v_cvt_pk_bf16_f32 v19, v50, v51
    buffer_store_dwordx4 v[16:19], v6, s[8:11], s43 offen sc1
    s_add_u32 s43, s43, 8192
    v_cvt_pk_bf16_f32 v20, v52, v53
    v_cvt_pk_bf16_f32 v21, v54, v55
    v_cvt_pk_bf16_f32 v22, v56, v57
    v_cvt_pk_bf16_f32 v23, v58, v59
    buffer_store_dwordx4 v[20:23], v6, s[8:11], s43 offen sc1
    s_add_u32 s43, s43, 8192
    v_cvt_pk_bf16_f32 v24, v60, v61
    v_cvt_pk_bf16_f32 v25, v62, v63
    v_cvt_pk_bf16_f32 v26, v64, v65
    v_cvt_pk_bf16_f32 v27, v66, v67
    buffer_store_dwordx4 v[24:27], v6, s[8:11], s43 offen sc1
    s_add_u32 s43, s43, 8192
L_q_norows:
    s_add_u32 s44, s38, 19988480
    s_addc_u32 s45, s39, 0
    s_mov_b32 s46, 20480
    s_mov_b32 s47, 0x00020000
    s_mov_b32 s60, s36
    s_mov_b32 s61, s37
    s_mov_b32 s62, 256
    s_mov_b32 s63, 0x00020000
    s_setprio 0
    s_cmp_lg_u32 s20, 5
    s_cbranch_scc1 L_s_nozg
    s_and_b32 s30, s2, 1
    s_lshl_b32 s30, s30, 7
    v_mov_b32 v2, s30
    s_sleep 32
    s_mov_b32 s55, 262144
    s_mov_b64 exec, 1
L_poll_zstg:
    buffer_load_dword v3, v2, s[60:63], 0 offen sc1
    s_waitcnt vmcnt(0)
    v_cmp_ne_u32 vcc, 1, v3
    s_cbranch_vccz L_got_zstg
    s_sleep 12
    s_sub_u32 s55, s55, 1
    s_cbranch_scc0 L_poll_zstg
L_got_zstg:
    s_mov_b64 exec, -1
L_s_nozg:
    s_waitcnt vmcnt(0)
    s_barrier
    s_cmp_lg_u32 s20, 0
    s_cbranch_scc1 L_arr_xng
    s_add_u32 s30, s31, 16
    s_lshl_b32 s30, s30, 7
    v_mov_b32 v2, s30
    v_mov_b32 v3, 1
    s_mov_b64 exec, 1
    buffer_atomic_add v3, v2, s[44:47], 0 offen sc0 sc1
    s_mul_i32 s30, s31, 1
    s_add_u32 s30, s30, 64
    s_waitcnt vmcnt(0)
    v_readfirstlane_b32 s55, v3
    s_mov_b64 exec, -1
    s_cmp_lg_u32 s55, 15
    s_cbranch_scc1 L_arr_xng
    v_mbcnt_lo_u32_b32 v2, -1, 0
    v_add_lshl_u32 v2, v2, s30, 7
    v_mov_b32 v3, 1
    s_mov_b64 exec, 1
    buffer_store_dword v3, v2, s[44:47], 0 offen sc1
    s_mov_b64 exec, -1
L_arr_xng:
    s_mov_b64 s[52:53], s[16:17]
    s_sub_u32 s48, 7, s20
    s_lshl_b32 s48, s48, 8
    s_add_u32 s48, s48, s2
    s_cmp_ge_u32 s48, 544
    s_cbranch_scc1 L_rl_end
    v_mbcnt_lo_u32_b32 v103, -1, 0
    v_mbcnt_hi_u32_b32 v103, -1, v103
    v_lshlrev_b32 v100, 4, v103
    s_load_dwordx2 s[40:41], s[0:1], 16
    s_load_dwordx2 s[42:43], s[0:1], 48
    s_mul_i32 s28, s20, 5120
    s_and_b32 s22, s48, 7
    s_lshr_b32 s21, s48, 3
    v_add_u32 v2, 0, v103
    v_mul_u32_u24 v3, 6554, v2
    v_lshrrev_b32 v50, 16, v3
    v_mul_u32_u24 v4, 10, v50
    v_sub_u32 v2, v2, v4
    v_lshlrev_b32 v56, 4, v2
    v_add_u32 v2, 64, v103
    v_mul_u32_u24 v3, 6554, v2
    v_lshrrev_b32 v51, 16, v3
    v_mul_u32_u24 v4, 10, v51
    v_sub_u32 v2, v2, v4
    v_lshlrev_b32 v57, 4, v2
    v_add_u32 v2, 128, v103
    v_mul_u32_u24 v3, 6554, v2
    v_lshrrev_b32 v52, 16, v3
    v_mul_u32_u24 v4, 10, v52
    v_sub_u32 v2, v2, v4
    v_lshlrev_b32 v58, 4, v2
    v_add_u32 v2, 192, v103
    v_mul_u32_u24 v3, 6554, v2
    v_lshrrev_b32 v53, 16, v3
    v_mul_u32_u24 v4, 10, v53
    v_sub_u32 v2, v2, v4
    v_lshlrev_b32 v59, 4, v2
    v_add_u32 v2, 256, v103
    v_mul_u32_u24 v3, 6554, v2
    v_lshrrev_b32 v54, 16, v3
    v_mul_u32_u24 v4, 10, v54
    v_sub_u32 v2, v2, v4
    v_lshlrev_b32 v60, 4, v2
    s_mul_i32 s24, s22, 160
    s_cmp_ge_u32 s21, 20
    s_cbranch_scc1 L_rl_wd
    s_lshl_b32 s25, s21, 2
    v_lshrrev_b32 v2, 4, v50
    v_bfe_u32 v3, v50, 2, 1
    v_lshl_add_u32 v2, v2, 1, v3
    v_add_u32 v2, s25, v2
    v_mul_u32_u24 v3, 205, v2
    v_lshrrev_b32 v3, 10, v3
    v_mul_u32_u24 v4, 5, v3
    v_sub_u32 v2, v2, v4
    v_bfe_u32 v4, v50, 3, 1
    v_lshrrev_b32 v5, 1, v2
    v_mul_u32_u24 v5, 20, v5
    v_and_b32 v6, 1, v2
    v_lshl_add_u32 v5, v6, 2, v5
    v_lshl_add_u32 v5, v4, 3, v5
    v_mul_u32_u24 v6, 20, v4
    v_add_u32 v6, 16, v6
    v_cmp_eq_u32 vcc, 4, v2
    v_mul_u32_u24 v3, 40, v3
    v_and_b32 v4, 3, v50
    v_cndmask_b32 v5, v5, v6, vcc
    v_add3_u32 v50, v5, v3, v4
    v_lshrrev_b32 v2, 4, v51
    v_bfe_u32 v3, v51, 2, 1
    v_lshl_add_u32 v2, v2, 1, v3
    v_add_u32 v2, s25, v2
    v_mul_u32_u24 v3, 205, v2
    v_lshrrev_b32 v3, 10, v3
    v_mul_u32_u24 v4, 5, v3
    v_sub_u32 v2, v2, v4
    v_bfe_u32 v4, v51, 3, 1
    v_lshrrev_b32 v5, 1, v2
    v_mul_u32_u24 v5, 20, v5
    v_and_b32 v6, 1, v2
    v_lshl_add_u32 v5, v6, 2, v5
    v_lshl_add_u32 v5, v4, 3, v5
    v_mul_u32_u24 v6, 20, v4
    v_add_u32 v6, 16, v6
    v_cmp_eq_u32 vcc, 4, v2
    v_mul_u32_u24 v3, 40, v3
    v_and_b32 v4, 3, v51
    v_cndmask_b32 v5, v5, v6, vcc
    v_add3_u32 v51, v5, v3, v4
    v_lshrrev_b32 v2, 4, v52
    v_bfe_u32 v3, v52, 2, 1
    v_lshl_add_u32 v2, v2, 1, v3
    v_add_u32 v2, s25, v2
    v_mul_u32_u24 v3, 205, v2
    v_lshrrev_b32 v3, 10, v3
    v_mul_u32_u24 v4, 5, v3
    v_sub_u32 v2, v2, v4
    v_bfe_u32 v4, v52, 3, 1
    v_lshrrev_b32 v5, 1, v2
    v_mul_u32_u24 v5, 20, v5
    v_and_b32 v6, 1, v2
    v_lshl_add_u32 v5, v6, 2, v5
    v_lshl_add_u32 v5, v4, 3, v5
    v_mul_u32_u24 v6, 20, v4
    v_add_u32 v6, 16, v6
    v_cmp_eq_u32 vcc, 4, v2
    v_mul_u32_u24 v3, 40, v3
    v_and_b32 v4, 3, v52
    v_cndmask_b32 v5, v5, v6, vcc
    v_add3_u32 v52, v5, v3, v4
    v_lshrrev_b32 v2, 4, v53
    v_bfe_u32 v3, v53, 2, 1
    v_lshl_add_u32 v2, v2, 1, v3
    v_add_u32 v2, s25, v2
    v_mul_u32_u24 v3, 205, v2
    v_lshrrev_b32 v3, 10, v3
    v_mul_u32_u24 v4, 5, v3
    v_sub_u32 v2, v2, v4
    v_bfe_u32 v4, v53, 3, 1
    v_lshrrev_b32 v5, 1, v2
    v_mul_u32_u24 v5, 20, v5
    v_and_b32 v6, 1, v2
    v_lshl_add_u32 v5, v6, 2, v5
    v_lshl_add_u32 v5, v4, 3, v5
    v_mul_u32_u24 v6, 20, v4
    v_add_u32 v6, 16, v6
    v_cmp_eq_u32 vcc, 4, v2
    v_mul_u32_u24 v3, 40, v3
    v_and_b32 v4, 3, v53
    v_cndmask_b32 v5, v5, v6, vcc
    v_add3_u32 v53, v5, v3, v4
    v_lshrrev_b32 v2, 4, v54
    v_bfe_u32 v3, v54, 2, 1
    v_lshl_add_u32 v2, v2, 1, v3
    v_add_u32 v2, s25, v2
    v_mul_u32_u24 v3, 205, v2
    v_lshrrev_b32 v3, 10, v3
    v_mul_u32_u24 v4, 5, v3
    v_sub_u32 v2, v2, v4
    v_bfe_u32 v4, v54, 3, 1
    v_lshrrev_b32 v5, 1, v2
    v_mul_u32_u24 v5, 20, v5
    v_and_b32 v6, 1, v2
    v_lshl_add_u32 v5, v6, 2, v5
    v_lshl_add_u32 v5, v4, 3, v5
    v_mul_u32_u24 v6, 20, v4
    v_add_u32 v6, 16, v6
    v_cmp_eq_u32 vcc, 4, v2
    v_mul_u32_u24 v3, 40, v3
    v_and_b32 v4, 3, v54
    v_cndmask_b32 v5, v5, v6, vcc
    v_add3_u32 v54, v5, v3, v4
    s_waitcnt lgkmcnt(0)
    s_mov_b32 s8, s40
    s_mov_b32 s9, s41
    s_mov_b32 s10, 819200
    s_mov_b32 s11, 0x00020000
    s_branch L_rl_go
L_rl_wd:
    s_sub_u32 s25, s21, 20
    s_mul_i32 s25, s25, 40960
    s_add_u32 s24, s24, s25
    s_waitcnt lgkmcnt(0)
    s_mov_b32 s8, s42
    s_mov_b32 s9, s43
    s_mov_b32 s10, 1966080
    s_mov_b32 s11, 0x00020000
L_rl_go:
    v_mul_u32_u24 v5, 1280, v50
    s_add_u32 m0, s28, 0
    v_add_u32 v5, v5, v56
    buffer_load_dwordx4 v5, s[8:11], s24 offen lds
    v_mul_u32_u24 v5, 1280, v51
    s_add_u32 m0, s28, 1024
    v_add_u32 v5, v5, v57
    buffer_load_dwordx4 v5, s[8:11], s24 offen lds
    v_mul_u32_u24 v5, 1280, v52
    s_add_u32 m0, s28, 2048
    v_add_u32 v5, v5, v58
    buffer_load_dwordx4 v5, s[8:11], s24 offen lds
    v_mul_u32_u24 v5, 1280, v53
    s_add_u32 m0, s28, 3072
    v_add_u32 v5, v5, v59
    buffer_load_dwordx4 v5, s[8:11], s24 offen lds
    v_mul_u32_u24 v5, 1280, v54
    s_add_u32 m0, s28, 4096
    v_add_u32 v5, v5, v60
    buffer_load_dwordx4 v5, s[8:11], s24 offen lds
    v_lshrrev_b32 v2, 5, v103
    v_lshlrev_b32 v2, 4, v2
    v_bfe_u32 v3, v103, 4, 1
    v_lshl_add_u32 v2, v3, 2, v2
    v_bfe_u32 v3, v103, 2, 2
    v_add_u32 v2, v2, v3
    v_mul_u32_u24 v2, 160, v2
    v_and_b32 v3, 3, v103
    v_lshl_add_u32 v2, v3, 3, v2
    v_add_u32 v16, s28, v2
    s_add_u32 s4, s38, 25165824
    s_addc_u32 s5, s39, 0
    s_mov_b32 s6, 2785280
    s_mov_b32 s7, 0x00020000
    s_mul_i32 s26, s22, 68
    s_add_u32 s26, s26, s21
    s_mul_i32 s26, s26, 5120
    s_add_u32 s27, s26, 4096
    s_waitcnt vmcnt(0)
    ds_read_b64_tr_b16 v[24:25], v16 offset:0
    ds_read_b64_tr_b16 v[26:27], v16 offset:1280
    ds_read_b64_tr_b16 v[28:29], v16 offset:32
    ds_read_b64_tr_b16 v[30:31], v16 offset:1312
    ds_read_b64_tr_b16 v[32:33], v16 offset:64
    ds_read_b64_tr_b16 v[34:35], v16 offset:1344
    ds_read_b64_tr_b16 v[36:37], v16 offset:96
    ds_read_b64_tr_b16 v[38:39], v16 offset:1376
    ds_read_b64_tr_b16 v[40:41], v16 offset:128
    ds_read_b64_tr_b16 v[42:43], v16 offset:1408
    s_waitcnt lgkmcnt(0)
    buffer_store_dwordx4 v[24:27], v100, s[4:7], s26 offen offset:0 sc1
    buffer_store_dwordx4 v[28:31], v100, s[4:7], s26 offen offset:1024 sc1
    buffer_store_dwordx4 v[32:35], v100, s[4:7], s26 offen offset:2048 sc1
    buffer_store_dwordx4 v[36:39], v100, s[4:7], s26 offen offset:3072 sc1
    buffer_store_dwordx4 v[40:43], v100, s[4:7], s27 offen offset:0 sc1
L_rl_end:
    s_bfe_u32 s40, s23, 0x10002
    s_lshl_b32 s40, s40, 3
    s_lshr_b32 s30, s23, 5
    s_add_u32 s40, s40, s30
    s_bfe_u32 s21, s20, 0x10001
    s_and_b32 s43, s20, 1
    s_cmp_ge_u32 s20, 4
    s_cselect_b32 s22, 2, s43
    s_cselect_b32 s43, s43, 0
    s_lshl_b32 s27, s31, 2
    s_lshr_b32 s30, s20, 1
    s_add_u32 s27, s27, s30
    s_mul_i32 s27, s27, 40960
    s_and_b32 s30, s20, 1
    s_lshl_b32 s30, s30, 10
    s_add_u32 s27, s27, s30
    s_mul_i32 s26, s31, 5
    s_lshr_b32 s26, s26, 2
    s_lshl_b32 s24, s26, 11
    s_add_u32 s24, s24, s27
    s_mov_b32 s28, 98304
    s_mul_i32 s25, s26, s28
    s_mul_i32 s30, s40, 192
    s_add_u32 s25, s25, s30
    v_mul_u32_u24 v2, 5462, v0
    v_lshrrev_b32 v2, 16, v2
    v_mul_u32_u24 v3, 12, v2
    v_sub_u32 v3, v0, v3
    v_mul_u32_u24 v4, 3072, v2
    v_lshl_add_u32 v101, v3, 4, v4
    v_lshrrev_b32 v2, 5, v2
    v_lshl_add_u32 v101, v2, 30, v101
    s_mov_b32 s4, s38
    s_mov_b32 s5, s39
    s_mov_b32 s6, 2621440
    s_mov_b32 s7, 0x00020000
    s_mov_b32 s8, s16
    s_mov_b32 s9, s17
    s_mov_b32 s10, 1966080
    s_mov_b32 s11, 0x00020000
    s_mov_b32 s12, s18
    s_mov_b32 s13, s19
    s_mov_b32 s14, 1966080
    s_mov_b32 s15, 0x00020000
    s_add_u32 s16, s38, 10485760
    s_addc_u32 s17, s39, 0
    s_mov_b32 s18, 8912896
    s_mov_b32 s19, 0x00020000
    s_lshl_b32 s30, s21, 12
    s_mul_i32 s41, s43, 3072
    s_add_u32 s30, s30, s41
    v_add_u32 v96, s30, v100
    s_xor_b32 s30, s30, 2048
    v_add_u32 v97, s30, v100
    v_lshrrev_b32 v105, 5, v103
    v_bfe_u32 v2, v103, 2, 2
    v_lshl_add_u32 v3, v105, 3, v2
    v_mul_u32_u24 v3, 192, v3
    v_bfe_u32 v2, v103, 4, 1
    v_lshl_add_u32 v3, v2, 5, v3
    v_and_b32 v2, 3, v103
    v_lshl_add_u32 v3, v2, 3, v3
    s_lshl_b32 s30, s22, 6
    s_add_u32 s30, s30, s41
    s_add_u32 s30, s30, 8192
    v_add_u32 v98, s30, v3
    s_cmp_lg_u32 s20, 0
    s_cbranch_scc1 L_gu_nopoll
    s_add_u32 s41, s31, 64
    s_lshl_b32 s30, s41, 7
    v_mov_b32 v2, s30
    s_mov_b32 s55, 262144
    s_mov_b64 exec, 1
L_poll_gu:
    buffer_load_dword v3, v2, s[44:47], 0 offen sc1
    s_waitcnt vmcnt(0)
    v_cmp_ne_u32 vcc, 1, v3
    s_cbranch_vccz L_got_gu
    s_sleep 16
    s_sub_u32 s55, s55, 1
    s_cbranch_scc0 L_poll_gu
L_got_gu:
    s_mov_b64 exec, -1
L_gu_nopoll:
    s_barrier
    s_add_u32 m0, s29, 0
    s_add_u32 s26, s26, 1
    buffer_load_dwordx4 v100, s[4:7], s24 offen sc1 lds
    s_add_u32 m0, s29, 8192
    s_add_u32 s24, s24, 2048
    buffer_load_dwordx4 v101, s[8:11], s25 offen lds
    s_add_u32 m0, s29, 16384
    s_cmp_eq_u32 s26, 20
    buffer_load_dwordx4 v101, s[12:15], s25 offen lds
    s_cselect_b32 s24, s27, s24
    s_cselect_b32 s30, 4293099520, s28
    s_add_u32 s25, s25, s30
    s_add_u32 m0, s29, 24576
    s_add_u32 s26, s26, 1
    buffer_load_dwordx4 v100, s[4:7], s24 offen sc1 lds
    s_add_u32 m0, s29, 32768
    s_add_u32 s24, s24, 2048
    buffer_load_dwordx4 v101, s[8:11], s25 offen lds
    s_add_u32 m0, s29, 40960
    s_cmp_eq_u32 s26, 20
    buffer_load_dwordx4 v101, s[12:15], s25 offen lds
    s_cselect_b32 s24, s27, s24
    s_cselect_b32 s30, 4293099520, s28
    s_add_u32 s25, s25, s30
    s_add_u32 m0, s29, 49152
    s_add_u32 s26, s26, 1
    buffer_load_dwordx4 v100, s[4:7], s24 offen sc1 lds
    s_add_u32 m0, s29, 57344
    s_add_u32 s24, s24, 2048
    buffer_load_dwordx4 v101, s[8:11], s25 offen lds
    s_add_u32 m0, s29, 65536
    s_cmp_eq_u32 s26, 20
    buffer_load_dwordx4 v101, s[12:15], s25 offen lds
    s_cselect_b32 s24, s27, s24
    s_cselect_b32 s30, 4293099520, s28
    s_add_u32 s25, s25, s30
    v_bfe_u32 v104, v103, 4, 1
    v_mul_u32_u24 v104, 69632, v104
    v_lshl_add_u32 v104, v105, 8, v104
    v_and_b32 v2, 15, v103
    v_lshl_add_u32 v104, v2, 4, v104
    s_lshl_b32 s48, s31, 2
    s_lshl_b32 s49, s21, 1
    s_add_u32 s48, s48, s49
    s_add_u32 s48, s48, s43
    s_mul_i32 s50, s48, 139264
    s_mul_i32 s51, s40, 3
    s_add_u32 s51, s51, s22
    s_add_u32 s51, s51, 20
    s_lshl_b32 s51, s51, 10
    s_add_u32 s50, s50, s51
    s_add_u32 s51, s50, 139264
    s_mov_b32 s48, 0xbfb8aa3b
    s_waitcnt vmcnt(6)
    s_barrier
    s_cmp_lg_u32 s20, 7
    s_cbranch_scc1 L_nowf
    s_and_b32 s30, s2, 7
    s_add_u32 s30, s30, 48
    s_lshl_b32 s30, s30, 7
    v_mov_b32 v2, s30
    v_mov_b32 v3, 1
    s_mov_b64 exec, 1
    buffer_atomic_add v3, v2, s[44:47], 0 offen sc1
    s_mov_b64 exec, -1
L_nowf:
    s_cmp_ge_u32 s20, 4
    s_cbranch_scc1 L_gu_split
    ds_read_b128 v[64:67], v96 offset:0
    ds_read_b128 v[68:71], v97 offset:0
    ds_read_b64_tr_b16 v[72:73], v98 offset:0
    ds_read_b64_tr_b16 v[74:75], v98 offset:768
    ds_read_b64_tr_b16 v[76:77], v98 offset:8192
    ds_read_b64_tr_b16 v[78:79], v98 offset:8960
    s_waitcnt lgkmcnt(0)
    ds_read_b128 v[80:83], v96 offset:1024
    ds_read_b128 v[84:87], v97 offset:1024
    ds_read_b64_tr_b16 v[88:89], v98 offset:3072
    ds_read_b64_tr_b16 v[90:91], v98 offset:3840
    ds_read_b64_tr_b16 v[92:93], v98 offset:11264
    ds_read_b64_tr_b16 v[94:95], v98 offset:12032
    v_mfma_f32_32x32x16_bf16 v[0:15], v[72:75], v[64:67], 0
    v_mfma_f32_32x32x16_bf16 v[16:31], v[76:79], v[64:67], 0
    v_mfma_f32_32x32x16_bf16 v[32:47], v[72:75], v[68:71], 0
    v_mfma_f32_32x32x16_bf16 v[48:63], v[76:79], v[68:71], 0
    s_waitcnt lgkmcnt(0)
    v_mfma_f32_32x32x16_bf16 v[0:15], v[88:91], v[80:83], v[0:15]
    v_mfma_f32_32x32x16_bf16 v[16:31], v[92:95], v[80:83], v[16:31]
    s_waitcnt vmcnt(3)
    s_barrier
    ds_read_b128 v[64:67], v96 offset:24576
    ds_read_b128 v[68:71], v97 offset:24576
    ds_read_b64_tr_b16 v[72:73], v98 offset:24576
    ds_read_b64_tr_b16 v[74:75], v98 offset:25344
    ds_read_b64_tr_b16 v[76:77], v98 offset:32768
    ds_read_b64_tr_b16 v[78:79], v98 offset:33536
    v_mfma_f32_32x32x16_bf16 v[32:47], v[88:91], v[84:87], v[32:47]
    v_mfma_f32_32x32x16_bf16 v[48:63], v[92:95], v[84:87], v[48:63]
    s_add_u32 m0, s29, 0
    s_add_u32 s26, s26, 1
    buffer_load_dwordx4 v100, s[4:7], s24 offen sc1 lds
    s_add_u32 m0, s29, 8192
    s_add_u32 s24, s24, 2048
    buffer_load_dwordx4 v101, s[8:11], s25 offen lds
    s_add_u32 m0, s29, 16384
    s_cmp_eq_u32 s26, 20
    buffer_load_dwordx4 v101, s[12:15], s25 offen lds
    s_cselect_b32 s24, s27, s24
    s_cselect_b32 s30, 4293099520, s28
    s_add_u32 s25, s25, s30
    s_waitcnt lgkmcnt(0)
    ds_read_b128 v[80:83], v96 offset:25600
    ds_read_b128 v[84:87], v97 offset:25600
    ds_read_b64_tr_b16 v[88:89], v98 offset:27648
    ds_read_b64_tr_b16 v[90:91], v98 offset:28416
    ds_read_b64_tr_b16 v[92:93], v98 offset:35840
    ds_read_b64_tr_b16 v[94:95], v98 offset:36608
    v_mfma_f32_32x32x16_bf16 v[0:15], v[72:75], v[64:67], v[0:15]
    v_mfma_f32_32x32x16_bf16 v[16:31], v[76:79], v[64:67], v[16:31]
    v_mfma_f32_32x32x16_bf16 v[32:47], v[72:75], v[68:71], v[32:47]
    v_mfma_f32_32x32x16_bf16 v[48:63], v[76:79], v[68:71], v[48:63]
    s_waitcnt lgkmcnt(0)
    v_mfma_f32_32x32x16_bf16 v[0:15], v[88:91], v[80:83], v[0:15]
    v_mfma_f32_32x32x16_bf16 v[16:31], v[92:95], v[80:83], v[16:31]
    s_waitcnt vmcnt(3)
    s_barrier
    ds_read_b128 v[64:67], v96 offset:49152
    ds_read_b128 v[68:71], v97 offset:49152
    ds_read_b64_tr_b16 v[72:73], v98 offset:49152
    ds_read_b64_tr_b16 v[74:75], v98 offset:49920
    ds_read_b64_tr_b16 v[76:77], v98 offset:57344
    ds_read_b64_tr_b16 v[78:79], v98 offset:58112
    v_mfma_f32_32x32x16_bf16 v[32:47], v[88:91], v[84:87], v[32:47]
    v_mfma_f32_32x32x16_bf16 v[48:63], v[92:95], v[84:87], v[48:63]
    s_add_u32 m0, s29, 24576
    s_add_u32 s26, s26, 1
    buffer_load_dwordx4 v100, s[4:7], s24 offen sc1 lds
    s_add_u32 m0, s29, 32768
    s_add_u32 s24, s24, 2048
    buffer_load_dwordx4 v101, s[8:11], s25 offen lds
    s_add_u32 m0, s29, 40960
    s_cmp_eq_u32 s26, 20
    buffer_load_dwordx4 v101, s[12:15], s25 offen lds
    s_cselect_b32 s24, s27, s24
    s_cselect_b32 s30, 4293099520, s28
    s_add_u32 s25, s25, s30
    s_waitcnt lgkmcnt(0)
    ds_read_b128 v[80:83], v96 offset:50176
    ds_read_b128 v[84:87], v97 offset:50176
    ds_read_b64_tr_b16 v[88:89], v98 offset:52224
    ds_read_b64_tr_b16 v[90:91], v98 offset:52992
    ds_read_b64_tr_b16 v[92:93], v98 offset:60416
    ds_read_b64_tr_b16 v[94:95], v98 offset:61184
    v_mfma_f32_32x32x16_bf16 v[0:15], v[72:75], v[64:67], v[0:15]
    v_mfma_f32_32x32x16_bf16 v[16:31], v[76:79], v[64:67], v[16:31]
    v_mfma_f32_32x32x16_bf16 v[32:47], v[72:75], v[68:71], v[32:47]
    v_mfma_f32_32x32x16_bf16 v[48:63], v[76:79], v[68:71], v[48:63]
    s_waitcnt lgkmcnt(0)
    v_mfma_f32_32x32x16_bf16 v[0:15], v[88:91], v[80:83], v[0:15]
    v_mfma_f32_32x32x16_bf16 v[16:31], v[92:95], v[80:83], v[16:31]
    s_waitcnt vmcnt(3)
    s_barrier
    ds_read_b128 v[64:67], v96 offset:0
    ds_read_b128 v[68:71], v97 offset:0
    ds_read_b64_tr_b16 v[72:73], v98 offset:0
    ds_read_b64_tr_b16 v[74:75], v98 offset:768
    ds_read_b64_tr_b16 v[76:77], v98 offset:8192
    ds_read_b64_tr_b16 v[78:79], v98 offset:8960
    v_mfma_f32_32x32x16_bf16 v[32:47], v[88:91], v[84:87], v[32:47]
    v_mfma_f32_32x32x16_bf16 v[48:63], v[92:95], v[84:87], v[48:63]
    s_add_u32 m0, s29, 49152
    s_add_u32 s26, s26, 1
    buffer_load_dwordx4 v100, s[4:7], s24 offen sc1 lds
    s_add_u32 m0, s29, 57344
    s_add_u32 s24, s24, 2048
    buffer_load_dwordx4 v101, s[8:11], s25 offen lds
    s_add_u32 m0, s29, 65536
    s_cmp_eq_u32 s26, 20
    buffer_load_dwordx4 v101, s[12:15], s25 offen lds
    s_cselect_b32 s24, s27, s24
    s_cselect_b32 s30, 4293099520, s28
    s_add_u32 s25, s25, s30
    s_waitcnt lgkmcnt(0)
    ds_read_b128 v[80:83], v96 offset:1024
    ds_read_b128 v[84:87], v97 offset:1024
    ds_read_b64_tr_b16 v[88:89], v98 offset:3072
    ds_read_b64_tr_b16 v[90:91], v98 offset:3840
    ds_read_b64_tr_b16 v[92:93], v98 offset:11264
    ds_read_b64_tr_b16 v[94:95], v98 offset:12032
    v_mfma_f32_32x32x16_bf16 v[0:15], v[72:75], v[64:67], v[0:15]
    v_mfma_f32_32x32x16_bf16 v[16:31], v[76:79], v[64:67], v[16:31]
    v_mfma_f32_32x32x16_bf16 v[32:47], v[72:75], v[68:71], v[32:47]
    v_mfma_f32_32x32x16_bf16 v[48:63], v[76:79], v[68:71], v[48:63]
    s_waitcnt lgkmcnt(0)
    v_mfma_f32_32x32x16_bf16 v[0:15], v[88:91], v[80:83], v[0:15]
    v_mfma_f32_32x32x16_bf16 v[16:31], v[92:95], v[80:83], v[16:31]
    s_waitcnt vmcnt(3)
    s_barrier
    ds_read_b128 v[64:67], v96 offset:24576
    ds_read_b128 v[68:71], v97 offset:24576
    ds_read_b64_tr_b16 v[72:73], v98 offset:24576
    ds_read_b64_tr_b16 v[74:75], v98 offset:25344
    ds_read_b64_tr_b16 v[76:77], v98 offset:32768
    ds_read_b64_tr_b16 v[78:79], v98 offset:33536
    v_mfma_f32_32x32x16_bf16 v[32:47], v[88:91], v[84:87], v[32:47]
    v_mfma_f32_32x32x16_bf16 v[48:63], v[92:95], v[84:87], v[48:63]
    s_add_u32 m0, s29, 0
    s_add_u32 s26, s26, 1
    buffer_load_dwordx4 v100, s[4:7], s24 offen sc1 lds
    s_add_u32 m0, s29, 8192
    s_add_u32 s24, s24, 2048
    buffer_load_dwordx4 v101, s[8:11], s25 offen lds
    s_add_u32 m0, s29, 16384
    s_cmp_eq_u32 s26, 20
    buffer_load_dwordx4 v101, s[12:15], s25 offen lds
    s_cselect_b32 s24, s27, s24
    s_cselect_b32 s30, 4293099520, s28
    s_add_u32 s25, s25, s30
    s_waitcnt lgkmcnt(0)
    ds_read_b128 v[80:83], v96 offset:25600
    ds_read_b128 v[84:87], v97 offset:25600
    ds_read_b64_tr_b16 v[88:89], v98 offset:27648
    ds_read_b64_tr_b16 v[90:91], v98 offset:28416
    ds_read_b64_tr_b16 v[92:93], v98 offset:35840
    ds_read_b64_tr_b16 v[94:95], v98 offset:36608
    v_mfma_f32_32x32x16_bf16 v[0:15], v[72:75], v[64:67], v[0:15]
    v_mfma_f32_32x32x16_bf16 v[16:31], v[76:79], v[64:67], v[16:31]
    v_mfma_f32_32x32x16_bf16 v[32:47], v[72:75], v[68:71], v[32:47]
    v_mfma_f32_32x32x16_bf16 v[48:63], v[76:79], v[68:71], v[48:63]
    s_waitcnt lgkmcnt(0)
    v_mfma_f32_32x32x16_bf16 v[0:15], v[88:91], v[80:83], v[0:15]
    v_mfma_f32_32x32x16_bf16 v[16:31], v[92:95], v[80:83], v[16:31]
    s_waitcnt vmcnt(3)
    s_barrier
    ds_read_b128 v[64:67], v96 offset:49152
    ds_read_b128 v[68:71], v97 offset:49152
    ds_read_b64_tr_b16 v[72:73], v98 offset:49152
    ds_read_b64_tr_b16 v[74:75], v98 offset:49920
    ds_read_b64_tr_b16 v[76:77], v98 offset:57344
    ds_read_b64_tr_b16 v[78:79], v98 offset:58112
    v_mfma_f32_32x32x16_bf16 v[32:47], v[88:91], v[84:87], v[32:47]
    v_mfma_f32_32x32x16_bf16 v[48:63], v[92:95], v[84:87], v[48:63]
    s_add_u32 m0, s29, 24576
    s_add_u32 s26, s26, 1
    buffer_load_dwordx4 v100, s[4:7], s24 offen sc1 lds
    s_add_u32 m0, s29, 32768
    s_add_u32 s24, s24, 2048
    buffer_load_dwordx4 v101, s[8:11], s25 offen lds
    s_add_u32 m0, s29, 40960
    s_cmp_eq_u32 s26, 20
    buffer_load_dwordx4 v101, s[12:15], s25 offen lds
    s_cselect_b32 s24, s27, s24
    s_cselect_b32 s30, 4293099520, s28
    s_add_u32 s25, s25, s30
    s_waitcnt lgkmcnt(0)
    ds_read_b128 v[80:83], v96 offset:50176
    ds_read_b128 v[84:87], v97 offset:50176
    ds_read_b64_tr_b16 v[88:89], v98 offset:52224
    ds_read_b64_tr_b16 v[90:91], v98 offset:52992
    ds_read_b64_tr_b16 v[92:93], v98 offset:60416
    ds_read_b64_tr_b16 v[94:95], v98 offset:61184
    v_mfma_f32_32x32x16_bf16 v[0:15], v[72:75], v[64:67], v[0:15]
    v_mfma_f32_32x32x16_bf16 v[16:31], v[76:79], v[64:67], v[16:31]
    v_mfma_f32_32x32x16_bf16 v[32:47], v[72:75], v[68:71], v[32:47]
    v_mfma_f32_32x32x16_bf16 v[48:63], v[76:79], v[68:71], v[48:63]
    s_waitcnt lgkmcnt(0)
    v_mfma_f32_32x32x16_bf16 v[0:15], v[88:91], v[80:83], v[0:15]
    v_mfma_f32_32x32x16_bf16 v[16:31], v[92:95], v[80:83], v[16:31]
    s_waitcnt vmcnt(3)
    s_barrier
    ds_read_b128 v[64:67], v96 offset:0
    ds_read_b128 v[68:71], v97 offset:0
    ds_read_b64_tr_b16 v[72:73], v98 offset:0
    ds_read_b64_tr_b16 v[74:75], v98 offset:768
    ds_read_b64_tr_b16 v[76:77], v98 offset:8192
    ds_read_b64_tr_b16 v[78:79], v98 offset:8960
    v_mfma_f32_32x32x16_bf16 v[32:47], v[88:91], v[84:87], v[32:47]
    v_mfma_f32_32x32x16_bf16 v[48:63], v[92:95], v[84:87], v[48:63]
    s_add_u32 m0, s29, 49152
    s_add_u32 s26, s26, 1
    buffer_load_dwordx4 v100, s[4:7], s24 offen sc1 lds
    s_add_u32 m0, s29, 57344
    s_add_u32 s24, s24, 2048
    buffer_load_dwordx4 v101, s[8:11], s25 offen lds
    s_add_u32 m0, s29, 65536
    s_cmp_eq_u32 s26, 20
    buffer_load_dwordx4 v101, s[12:15], s25 offen lds
    s_cselect_b32 s24, s27, s24
    s_cselect_b32 s30, 4293099520, s28
    s_add_u32 s25, s25, s30
    s_waitcnt lgkmcnt(0)
    ds_read_b128 v[80:83], v96 offset:1024
    ds_read_b128 v[84:87], v97 offset:1024
    ds_read_b64_tr_b16 v[88:89], v98 offset:3072
    ds_read_b64_tr_b16 v[90:91], v98 offset:3840
    ds_read_b64_tr_b16 v[92:93], v98 offset:11264
    ds_read_b64_tr_b16 v[94:95], v98 offset:12032
    v_mfma_f32_32x32x16_bf16 v[0:15], v[72:75], v[64:67], v[0:15]
    v_mfma_f32_32x32x16_bf16 v[16:31], v[76:79], v[64:67], v[16:31]
    v_mfma_f32_32x32x16_bf16 v[32:47], v[72:75], v[68:71], v[32:47]
    v_mfma_f32_32x32x16_bf16 v[48:63], v[76:79], v[68:71], v[48:63]
    s_waitcnt lgkmcnt(0)
    v_mfma_f32_32x32x16_bf16 v[0:15], v[88:91], v[80:83], v[0:15]
    v_mfma_f32_32x32x16_bf16 v[16:31], v[92:95], v[80:83], v[16:31]
    s_waitcnt vmcnt(3)
    s_barrier
    ds_read_b128 v[64:67], v96 offset:24576
    ds_read_b128 v[68:71], v97 offset:24576
    ds_read_b64_tr_b16 v[72:73], v98 offset:24576
    ds_read_b64_tr_b16 v[74:75], v98 offset:25344
    ds_read_b64_tr_b16 v[76:77], v98 offset:32768
    ds_read_b64_tr_b16 v[78:79], v98 offset:33536
    v_mfma_f32_32x32x16_bf16 v[32:47], v[88:91], v[84:87], v[32:47]
    v_mfma_f32_32x32x16_bf16 v[48:63], v[92:95], v[84:87], v[48:63]
    s_add_u32 m0, s29, 0
    s_add_u32 s26, s26, 1
    buffer_load_dwordx4 v100, s[4:7], s24 offen sc1 lds
    s_add_u32 m0, s29, 8192
    s_add_u32 s24, s24, 2048
    buffer_load_dwordx4 v101, s[8:11], s25 offen lds
    s_add_u32 m0, s29, 16384
    s_cmp_eq_u32 s26, 20
    buffer_load_dwordx4 v101, s[12:15], s25 offen lds
    s_cselect_b32 s24, s27, s24
    s_cselect_b32 s30, 4293099520, s28
    s_add_u32 s25, s25, s30
    s_waitcnt lgkmcnt(0)
    ds_read_b128 v[80:83], v96 offset:25600
    ds_read_b128 v[84:87], v97 offset:25600
    ds_read_b64_tr_b16 v[88:89], v98 offset:27648
    ds_read_b64_tr_b16 v[90:91], v98 offset:28416
    ds_read_b64_tr_b16 v[92:93], v98 offset:35840
    ds_read_b64_tr_b16 v[94:95], v98 offset:36608
    v_mfma_f32_32x32x16_bf16 v[0:15], v[72:75], v[64:67], v[0:15]
    v_mfma_f32_32x32x16_bf16 v[16:31], v[76:79], v[64:67], v[16:31]
    v_mfma_f32_32x32x16_bf16 v[32:47], v[72:75], v[68:71], v[32:47]
    v_mfma_f32_32x32x16_bf16 v[48:63], v[76:79], v[68:71], v[48:63]
    s_waitcnt lgkmcnt(0)
    v_mfma_f32_32x32x16_bf16 v[0:15], v[88:91], v[80:83], v[0:15]
    v_mfma_f32_32x32x16_bf16 v[16:31], v[92:95], v[80:83], v[16:31]
    s_waitcnt vmcnt(3)
    s_barrier
    ds_read_b128 v[64:67], v96 offset:49152
    ds_read_b128 v[68:71], v97 offset:49152
    ds_read_b64_tr_b16 v[72:73], v98 offset:49152
    ds_read_b64_tr_b16 v[74:75], v98 offset:49920
    ds_read_b64_tr_b16 v[76:77], v98 offset:57344
    ds_read_b64_tr_b16 v[78:79], v98 offset:58112
    v_mfma_f32_32x32x16_bf16 v[32:47], v[88:91], v[84:87], v[32:47]
    v_mfma_f32_32x32x16_bf16 v[48:63], v[92:95], v[84:87], v[48:63]
    s_add_u32 m0, s29, 24576
    s_add_u32 s26, s26, 1
    buffer_load_dwordx4 v100, s[4:7], s24 offen sc1 lds
    s_add_u32 m0, s29, 32768
    s_add_u32 s24, s24, 2048
    buffer_load_dwordx4 v101, s[8:11], s25 offen lds
    s_add_u32 m0, s29, 40960
    s_cmp_eq_u32 s26, 20
    buffer_load_dwordx4 v101, s[12:15], s25 offen lds
    s_cselect_b32 s24, s27, s24
    s_cselect_b32 s30, 4293099520, s28
    s_add_u32 s25, s25, s30
    s_waitcnt lgkmcnt(0)
    ds_read_b128 v[80:83], v96 offset:50176
    ds_read_b128 v[84:87], v97 offset:50176
    ds_read_b64_tr_b16 v[88:89], v98 offset:52224
    ds_read_b64_tr_b16 v[90:91], v98 offset:52992
    ds_read_b64_tr_b16 v[92:93], v98 offset:60416
    ds_read_b64_tr_b16 v[94:95], v98 offset:61184
    v_mfma_f32_32x32x16_bf16 v[0:15], v[72:75], v[64:67], v[0:15]
    v_mfma_f32_32x32x16_bf16 v[16:31], v[76:79], v[64:67], v[16:31]
    v_mfma_f32_32x32x16_bf16 v[32:47], v[72:75], v[68:71], v[32:47]
    v_mfma_f32_32x32x16_bf16 v[48:63], v[76:79], v[68:71], v[48:63]
    s_waitcnt lgkmcnt(0)
    v_mfma_f32_32x32x16_bf16 v[0:15], v[88:91], v[80:83], v[0:15]
    v_mfma_f32_32x32x16_bf16 v[16:31], v[92:95], v[80:83], v[16:31]
    s_waitcnt vmcnt(3)
    s_barrier
    ds_read_b128 v[64:67], v96 offset:0
    ds_read_b128 v[68:71], v97 offset:0
    ds_read_b64_tr_b16 v[72:73], v98 offset:0
    ds_read_b64_tr_b16 v[74:75], v98 offset:768
    ds_read_b64_tr_b16 v[76:77], v98 offset:8192
    ds_read_b64_tr_b16 v[78:79], v98 offset:8960
    v_mfma_f32_32x32x16_bf16 v[32:47], v[88:91], v[84:87], v[32:47]
    v_mfma_f32_32x32x16_bf16 v[48:63], v[92:95], v[84:87], v[48:63]
    s_add_u32 m0, s29, 49152
    s_add_u32 s26, s26, 1
    buffer_load_dwordx4 v100, s[4:7], s24 offen sc1 lds
    s_add_u32 m0, s29, 57344
    s_add_u32 s24, s24, 2048
    buffer_load_dwordx4 v101, s[8:11], s25 offen lds
    s_add_u32 m0, s29, 65536
    s_cmp_eq_u32 s26, 20
    buffer_load_dwordx4 v101, s[12:15], s25 offen lds
    s_cselect_b32 s24, s27, s24
    s_cselect_b32 s30, 4293099520, s28
    s_add_u32 s25, s25, s30
    s_waitcnt lgkmcnt(0)
    ds_read_b128 v[80:83], v96 offset:1024
    ds_read_b128 v[84:87], v97 offset:1024
    ds_read_b64_tr_b16 v[88:89], v98 offset:3072
    ds_read_b64_tr_b16 v[90:91], v98 offset:3840
    ds_read_b64_tr_b16 v[92:93], v98 offset:11264
    ds_read_b64_tr_b16 v[94:95], v98 offset:12032
    v_mfma_f32_32x32x16_bf16 v[0:15], v[72:75], v[64:67], v[0:15]
    v_mfma_f32_32x32x16_bf16 v[16:31], v[76:79], v[64:67], v[16:31]
    v_mfma_f32_32x32x16_bf16 v[32:47], v[72:75], v[68:71], v[32:47]
    v_mfma_f32_32x32x16_bf16 v[48:63], v[76:79], v[68:71], v[48:63]
    s_waitcnt lgkmcnt(0)
    v_mfma_f32_32x32x16_bf16 v[0:15], v[88:91], v[80:83], v[0:15]
    v_mfma_f32_32x32x16_bf16 v[16:31], v[92:95], v[80:83], v[16:31]
    s_waitcnt vmcnt(3)
    s_barrier
    ds_read_b128 v[64:67], v96 offset:24576
    ds_read_b128 v[68:71], v97 offset:24576
    ds_read_b64_tr_b16 v[72:73], v98 offset:24576
    ds_read_b64_tr_b16 v[74:75], v98 offset:25344
    ds_read_b64_tr_b16 v[76:77], v98 offset:32768
    ds_read_b64_tr_b16 v[78:79], v98 offset:33536
    v_mfma_f32_32x32x16_bf16 v[32:47], v[88:91], v[84:87], v[32:47]
    v_mfma_f32_32x32x16_bf16 v[48:63], v[92:95], v[84:87], v[48:63]
    s_add_u32 m0, s29, 0
    s_add_u32 s26, s26, 1
    buffer_load_dwordx4 v100, s[4:7], s24 offen sc1 lds
    s_add_u32 m0, s29, 8192
    s_add_u32 s24, s24, 2048
    buffer_load_dwordx4 v101, s[8:11], s25 offen lds
    s_add_u32 m0, s29, 16384
    s_cmp_eq_u32 s26, 20
    buffer_load_dwordx4 v101, s[12:15], s25 offen lds
    s_cselect_b32 s24, s27, s24
    s_cselect_b32 s30, 4293099520, s28
    s_add_u32 s25, s25, s30
    s_waitcnt lgkmcnt(0)
    ds_read_b128 v[80:83], v96 offset:25600
    ds_read_b128 v[84:87], v97 offset:25600
    ds_read_b64_tr_b16 v[88:89], v98 offset:27648
    ds_read_b64_tr_b16 v[90:91], v98 offset:28416
    ds_read_b64_tr_b16 v[92:93], v98 offset:35840
    ds_read_b64_tr_b16 v[94:95], v98 offset:36608
    v_mfma_f32_32x32x16_bf16 v[0:15], v[72:75], v[64:67], v[0:15]
    v_mfma_f32_32x32x16_bf16 v[16:31], v[76:79], v[64:67], v[16:31]
    v_mfma_f32_32x32x16_bf16 v[32:47], v[72:75], v[68:71], v[32:47]
    v_mfma_f32_32x32x16_bf16 v[48:63], v[76:79], v[68:71], v[48:63]
    s_waitcnt lgkmcnt(0)
    v_mfma_f32_32x32x16_bf16 v[0:15], v[88:91], v[80:83], v[0:15]
    v_mfma_f32_32x32x16_bf16 v[16:31], v[92:95], v[80:83], v[16:31]
    s_waitcnt vmcnt(3)
    s_barrier
    ds_read_b128 v[64:67], v96 offset:49152
    ds_read_b128 v[68:71], v97 offset:49152
    ds_read_b64_tr_b16 v[72:73], v98 offset:49152
    ds_read_b64_tr_b16 v[74:75], v98 offset:49920
    ds_read_b64_tr_b16 v[76:77], v98 offset:57344
    ds_read_b64_tr_b16 v[78:79], v98 offset:58112
    v_mfma_f32_32x32x16_bf16 v[32:47], v[88:91], v[84:87], v[32:47]
    v_mfma_f32_32x32x16_bf16 v[48:63], v[92:95], v[84:87], v[48:63]
    s_add_u32 m0, s29, 24576
    s_add_u32 s26, s26, 1
    buffer_load_dwordx4 v100, s[4:7], s24 offen sc1 lds
    s_add_u32 m0, s29, 32768
    s_add_u32 s24, s24, 2048
    buffer_load_dwordx4 v101, s[8:11], s25 offen lds
    s_add_u32 m0, s29, 40960
    s_cmp_eq_u32 s26, 20
    buffer_load_dwordx4 v101, s[12:15], s25 offen lds
    s_cselect_b32 s24, s27, s24
    s_cselect_b32 s30, 4293099520, s28
    s_add_u32 s25, s25, s30
    s_waitcnt lgkmcnt(0)
    ds_read_b128 v[80:83], v96 offset:50176
    ds_read_b128 v[84:87], v97 offset:50176
    ds_read_b64_tr_b16 v[88:89], v98 offset:52224
    ds_read_b64_tr_b16 v[90:91], v98 offset:52992
    ds_read_b64_tr_b16 v[92:93], v98 offset:60416
    ds_read_b64_tr_b16 v[94:95], v98 offset:61184
    v_mfma_f32_32x32x16_bf16 v[0:15], v[72:75], v[64:67], v[0:15]
    v_mfma_f32_32x32x16_bf16 v[16:31], v[76:79], v[64:67], v[16:31]
    v_mfma_f32_32x32x16_bf16 v[32:47], v[72:75], v[68:71], v[32:47]
    v_mfma_f32_32x32x16_bf16 v[48:63], v[76:79], v[68:71], v[48:63]
    s_waitcnt lgkmcnt(0)
    v_mfma_f32_32x32x16_bf16 v[0:15], v[88:91], v[80:83], v[0:15]
    v_mfma_f32_32x32x16_bf16 v[16:31], v[92:95], v[80:83], v[16:31]
    s_waitcnt vmcnt(3)
    s_barrier
    ds_read_b128 v[64:67], v96 offset:0
    ds_read_b128 v[68:71], v97 offset:0
    ds_read_b64_tr_b16 v[72:73], v98 offset:0
    ds_read_b64_tr_b16 v[74:75], v98 offset:768
    ds_read_b64_tr_b16 v[76:77], v98 offset:8192
    ds_read_b64_tr_b16 v[78:79], v98 offset:8960
    v_mfma_f32_32x32x16_bf16 v[32:47], v[88:91], v[84:87], v[32:47]
    v_mfma_f32_32x32x16_bf16 v[48:63], v[92:95], v[84:87], v[48:63]
    s_add_u32 m0, s29, 49152
    s_add_u32 s26, s26, 1
    buffer_load_dwordx4 v100, s[4:7], s24 offen sc1 lds
    s_add_u32 m0, s29, 57344
    s_add_u32 s24, s24, 2048
    buffer_load_dwordx4 v101, s[8:11], s25 offen lds
    s_add_u32 m0, s29, 65536
    s_cmp_eq_u32 s26, 20
    buffer_load_dwordx4 v101, s[12:15], s25 offen lds
    s_cselect_b32 s24, s27, s24
    s_cselect_b32 s30, 4293099520, s28
    s_add_u32 s25, s25, s30
    s_waitcnt lgkmcnt(0)
    ds_read_b128 v[80:83], v96 offset:1024
    ds_read_b128 v[84:87], v97 offset:1024
    ds_read_b64_tr_b16 v[88:89], v98 offset:3072
    ds_read_b64_tr_b16 v[90:91], v98 offset:3840
    ds_read_b64_tr_b16 v[92:93], v98 offset:11264
    ds_read_b64_tr_b16 v[94:95], v98 offset:12032
    v_mfma_f32_32x32x16_bf16 v[0:15], v[72:75], v[64:67], v[0:15]
    v_mfma_f32_32x32x16_bf16 v[16:31], v[76:79], v[64:67], v[16:31]
    v_mfma_f32_32x32x16_bf16 v[32:47], v[72:75], v[68:71], v[32:47]
    v_mfma_f32_32x32x16_bf16 v[48:63], v[76:79], v[68:71], v[48:63]
    s_waitcnt lgkmcnt(0)
    v_mfma_f32_32x32x16_bf16 v[0:15], v[88:91], v[80:83], v[0:15]
    v_mfma_f32_32x32x16_bf16 v[16:31], v[92:95], v[80:83], v[16:31]
    s_waitcnt vmcnt(3)
    s_barrier
    ds_read_b128 v[64:67], v96 offset:24576
    ds_read_b128 v[68:71], v97 offset:24576
    ds_read_b64_tr_b16 v[72:73], v98 offset:24576
    ds_read_b64_tr_b16 v[74:75], v98 offset:25344
    ds_read_b64_tr_b16 v[76:77], v98 offset:32768
    ds_read_b64_tr_b16 v[78:79], v98 offset:33536
    v_mfma_f32_32x32x16_bf16 v[32:47], v[88:91], v[84:87], v[32:47]
    v_mfma_f32_32x32x16_bf16 v[48:63], v[92:95], v[84:87], v[48:63]
    s_add_u32 m0, s29, 0
    s_add_u32 s26, s26, 1
    buffer_load_dwordx4 v100, s[4:7], s24 offen sc1 lds
    s_add_u32 m0, s29, 8192
    s_add_u32 s24, s24, 2048
    buffer_load_dwordx4 v101, s[8:11], s25 offen lds
    s_add_u32 m0, s29, 16384
    s_cmp_eq_u32 s26, 20
    buffer_load_dwordx4 v101, s[12:15], s25 offen lds
    s_cselect_b32 s24, s27, s24
    s_cselect_b32 s30, 4293099520, s28
    s_add_u32 s25, s25, s30
    s_waitcnt lgkmcnt(0)
    ds_read_b128 v[80:83], v96 offset:25600
    ds_read_b128 v[84:87], v97 offset:25600
    ds_read_b64_tr_b16 v[88:89], v98 offset:27648
    ds_read_b64_tr_b16 v[90:91], v98 offset:28416
    ds_read_b64_tr_b16 v[92:93], v98 offset:35840
    ds_read_b64_tr_b16 v[94:95], v98 offset:36608
    v_mfma_f32_32x32x16_bf16 v[0:15], v[72:75], v[64:67], v[0:15]
    v_mfma_f32_32x32x16_bf16 v[16:31], v[76:79], v[64:67], v[16:31]
    v_mfma_f32_32x32x16_bf16 v[32:47], v[72:75], v[68:71], v[32:47]
    v_mfma_f32_32x32x16_bf16 v[48:63], v[76:79], v[68:71], v[48:63]
    s_waitcnt lgkmcnt(0)
    v_mfma_f32_32x32x16_bf16 v[0:15], v[88:91], v[80:83], v[0:15]
    v_mfma_f32_32x32x16_bf16 v[16:31], v[92:95], v[80:83], v[16:31]
    s_waitcnt vmcnt(3)
    s_barrier
    ds_read_b128 v[64:67], v96 offset:49152
    ds_read_b128 v[68:71], v97 offset:49152
    ds_read_b64_tr_b16 v[72:73], v98 offset:49152
    ds_read_b64_tr_b16 v[74:75], v98 offset:49920
    ds_read_b64_tr_b16 v[76:77], v98 offset:57344
    ds_read_b64_tr_b16 v[78:79], v98 offset:58112
    v_mfma_f32_32x32x16_bf16 v[32:47], v[88:91], v[84:87], v[32:47]
    v_mfma_f32_32x32x16_bf16 v[48:63], v[92:95], v[84:87], v[48:63]
    s_add_u32 m0, s29, 24576
    s_add_u32 s26, s26, 1
    buffer_load_dwordx4 v100, s[4:7], s24 offen sc1 lds
    s_add_u32 m0, s29, 32768
    s_add_u32 s24, s24, 2048
    buffer_load_dwordx4 v101, s[8:11], s25 offen lds
    s_add_u32 m0, s29, 40960
    s_cmp_eq_u32 s26, 20
    buffer_load_dwordx4 v101, s[12:15], s25 offen lds
    s_cselect_b32 s24, s27, s24
    s_cselect_b32 s30, 4293099520, s28
    s_add_u32 s25, s25, s30
    s_waitcnt lgkmcnt(0)
    ds_read_b128 v[80:83], v96 offset:50176
    ds_read_b128 v[84:87], v97 offset:50176
    ds_read_b64_tr_b16 v[88:89], v98 offset:52224
    ds_read_b64_tr_b16 v[90:91], v98 offset:52992
    ds_read_b64_tr_b16 v[92:93], v98 offset:60416
    ds_read_b64_tr_b16 v[94:95], v98 offset:61184
    v_mfma_f32_32x32x16_bf16 v[0:15], v[72:75], v[64:67], v[0:15]
    v_mfma_f32_32x32x16_bf16 v[16:31], v[76:79], v[64:67], v[16:31]
    v_mfma_f32_32x32x16_bf16 v[32:47], v[72:75], v[68:71], v[32:47]
    v_mfma_f32_32x32x16_bf16 v[48:63], v[76:79], v[68:71], v[48:63]
    s_waitcnt lgkmcnt(0)
    v_mfma_f32_32x32x16_bf16 v[0:15], v[88:91], v[80:83], v[0:15]
    v_mfma_f32_32x32x16_bf16 v[16:31], v[92:95], v[80:83], v[16:31]
    s_waitcnt vmcnt(3)
    s_barrier
    ds_read_b128 v[64:67], v96 offset:0
    ds_read_b128 v[68:71], v97 offset:0
    ds_read_b64_tr_b16 v[72:73], v98 offset:0
    ds_read_b64_tr_b16 v[74:75], v98 offset:768
    ds_read_b64_tr_b16 v[76:77], v98 offset:8192
    ds_read_b64_tr_b16 v[78:79], v98 offset:8960
    v_mfma_f32_32x32x16_bf16 v[32:47], v[88:91], v[84:87], v[32:47]
    v_mfma_f32_32x32x16_bf16 v[48:63], v[92:95], v[84:87], v[48:63]
    s_add_u32 m0, s29, 49152
    s_add_u32 s26, s26, 1
    buffer_load_dwordx4 v100, s[4:7], s24 offen sc1 lds
    s_add_u32 m0, s29, 57344
    s_add_u32 s24, s24, 2048
    buffer_load_dwordx4 v101, s[8:11], s25 offen lds
    s_add_u32 m0, s29, 65536
    s_cmp_eq_u32 s26, 20
    buffer_load_dwordx4 v101, s[12:15], s25 offen lds
    s_cselect_b32 s24, s27, s24
    s_cselect_b32 s30, 4293099520, s28
    s_add_u32 s25, s25, s30
    s_waitcnt lgkmcnt(0)
    ds_read_b128 v[80:83], v96 offset:1024
    ds_read_b128 v[84:87], v97 offset:1024
    ds_read_b64_tr_b16 v[88:89], v98 offset:3072
    ds_read_b64_tr_b16 v[90:91], v98 offset:3840
    ds_read_b64_tr_b16 v[92:93], v98 offset:11264
    ds_read_b64_tr_b16 v[94:95], v98 offset:12032
    v_mfma_f32_32x32x16_bf16 v[0:15], v[72:75], v[64:67], v[0:15]
    v_mfma_f32_32x32x16_bf16 v[16:31], v[76:79], v[64:67], v[16:31]
    v_mfma_f32_32x32x16_bf16 v[32:47], v[72:75], v[68:71], v[32:47]
    v_mfma_f32_32x32x16_bf16 v[48:63], v[76:79], v[68:71], v[48:63]
    s_waitcnt lgkmcnt(0)
    v_mfma_f32_32x32x16_bf16 v[0:15], v[88:91], v[80:83], v[0:15]
    v_mfma_f32_32x32x16_bf16 v[16:31], v[92:95], v[80:83], v[16:31]
    s_waitcnt vmcnt(3)
    s_barrier
    ds_read_b128 v[64:67], v96 offset:24576
    ds_read_b128 v[68:71], v97 offset:24576
    ds_read_b64_tr_b16 v[72:73], v98 offset:24576
    ds_read_b64_tr_b16 v[74:75], v98 offset:25344
    ds_read_b64_tr_b16 v[76:77], v98 offset:32768
    ds_read_b64_tr_b16 v[78:79], v98 offset:33536
    v_mfma_f32_32x32x16_bf16 v[32:47], v[88:91], v[84:87], v[32:47]
    v_mfma_f32_32x32x16_bf16 v[48:63], v[92:95], v[84:87], v[48:63]
    s_add_u32 m0, s29, 0
    s_add_u32 s26, s26, 1
    buffer_load_dwordx4 v100, s[4:7], s24 offen sc1 lds
    s_add_u32 m0, s29, 8192
    s_add_u32 s24, s24, 2048
    buffer_load_dwordx4 v101, s[8:11], s25 offen lds
    s_add_u32 m0, s29, 16384
    s_cmp_eq_u32 s26, 20
    buffer_load_dwordx4 v101, s[12:15], s25 offen lds
    s_cselect_b32 s24, s27, s24
    s_cselect_b32 s30, 4293099520, s28
    s_add_u32 s25, s25, s30
    s_waitcnt lgkmcnt(0)
    ds_read_b128 v[80:83], v96 offset:25600
    ds_read_b128 v[84:87], v97 offset:25600
    ds_read_b64_tr_b16 v[88:89], v98 offset:27648
    ds_read_b64_tr_b16 v[90:91], v98 offset:28416
    ds_read_b64_tr_b16 v[92:93], v98 offset:35840
    ds_read_b64_tr_b16 v[94:95], v98 offset:36608
    v_mfma_f32_32x32x16_bf16 v[0:15], v[72:75], v[64:67], v[0:15]
    v_mfma_f32_32x32x16_bf16 v[16:31], v[76:79], v[64:67], v[16:31]
    v_mfma_f32_32x32x16_bf16 v[32:47], v[72:75], v[68:71], v[32:47]
    v_mfma_f32_32x32x16_bf16 v[48:63], v[76:79], v[68:71], v[48:63]
    s_waitcnt lgkmcnt(0)
    v_mfma_f32_32x32x16_bf16 v[0:15], v[88:91], v[80:83], v[0:15]
    v_mfma_f32_32x32x16_bf16 v[16:31], v[92:95], v[80:83], v[16:31]
    s_waitcnt vmcnt(3)
    s_barrier
    ds_read_b128 v[64:67], v96 offset:49152
    ds_read_b128 v[68:71], v97 offset:49152
    ds_read_b64_tr_b16 v[72:73], v98 offset:49152
    ds_read_b64_tr_b16 v[74:75], v98 offset:49920
    ds_read_b64_tr_b16 v[76:77], v98 offset:57344
    ds_read_b64_tr_b16 v[78:79], v98 offset:58112
    v_mfma_f32_32x32x16_bf16 v[32:47], v[88:91], v[84:87], v[32:47]
    v_mfma_f32_32x32x16_bf16 v[48:63], v[92:95], v[84:87], v[48:63]
    s_add_u32 m0, s29, 24576
    s_add_u32 s26, s26, 1
    buffer_load_dwordx4 v100, s[4:7], s24 offen sc1 lds
    s_add_u32 m0, s29, 32768
    s_add_u32 s24, s24, 2048
    buffer_load_dwordx4 v101, s[8:11], s25 offen lds
    s_add_u32 m0, s29, 40960
    s_cmp_eq_u32 s26, 20
    buffer_load_dwordx4 v101, s[12:15], s25 offen lds
    s_cselect_b32 s24, s27, s24
    s_cselect_b32 s30, 4293099520, s28
    s_add_u32 s25, s25, s30
    s_waitcnt lgkmcnt(0)
    ds_read_b128 v[80:83], v96 offset:50176
    ds_read_b128 v[84:87], v97 offset:50176
    ds_read_b64_tr_b16 v[88:89], v98 offset:52224
    ds_read_b64_tr_b16 v[90:91], v98 offset:52992
    ds_read_b64_tr_b16 v[92:93], v98 offset:60416
    ds_read_b64_tr_b16 v[94:95], v98 offset:61184
    v_mfma_f32_32x32x16_bf16 v[0:15], v[72:75], v[64:67], v[0:15]
    v_mfma_f32_32x32x16_bf16 v[16:31], v[76:79], v[64:67], v[16:31]
    v_mfma_f32_32x32x16_bf16 v[32:47], v[72:75], v[68:71], v[32:47]
    v_mfma_f32_32x32x16_bf16 v[48:63], v[76:79], v[68:71], v[48:63]
    s_waitcnt lgkmcnt(0)
    v_mfma_f32_32x32x16_bf16 v[0:15], v[88:91], v[80:83], v[0:15]
    v_mfma_f32_32x32x16_bf16 v[16:31], v[92:95], v[80:83], v[16:31]
    s_waitcnt vmcnt(3)
    s_barrier
    ds_read_b128 v[64:67], v96 offset:0
    ds_read_b128 v[68:71], v97 offset:0
    ds_read_b64_tr_b16 v[72:73], v98 offset:0
    ds_read_b64_tr_b16 v[74:75], v98 offset:768
    ds_read_b64_tr_b16 v[76:77], v98 offset:8192
    ds_read_b64_tr_b16 v[78:79], v98 offset:8960
    v_mfma_f32_32x32x16_bf16 v[32:47], v[88:91], v[84:87], v[32:47]
    v_mfma_f32_32x32x16_bf16 v[48:63], v[92:95], v[84:87], v[48:63]
    s_waitcnt lgkmcnt(0)
    ds_read_b128 v[80:83], v96 offset:1024
    ds_read_b128 v[84:87], v97 offset:1024
    ds_read_b64_tr_b16 v[88:89], v98 offset:3072
    ds_read_b64_tr_b16 v[90:91], v98 offset:3840
    ds_read_b64_tr_b16 v[92:93], v98 offset:11264
    ds_read_b64_tr_b16 v[94:95], v98 offset:12032
    v_mfma_f32_32x32x16_bf16 v[0:15], v[72:75], v[64:67], v[0:15]
    v_mfma_f32_32x32x16_bf16 v[16:31], v[76:79], v[64:67], v[16:31]
    v_mfma_f32_32x32x16_bf16 v[32:47], v[72:75], v[68:71], v[32:47]
    v_mfma_f32_32x32x16_bf16 v[48:63], v[76:79], v[68:71], v[48:63]
    s_waitcnt lgkmcnt(0)
    v_mfma_f32_32x32x16_bf16 v[0:15], v[88:91], v[80:83], v[0:15]
    v_mfma_f32_32x32x16_bf16 v[16:31], v[92:95], v[80:83], v[16:31]
    s_waitcnt vmcnt(0)
    s_barrier
    ds_read_b128 v[64:67], v96 offset:24576
    ds_read_b128 v[68:71], v97 offset:24576
    ds_read_b64_tr_b16 v[72:73], v98 offset:24576
    ds_read_b64_tr_b16 v[74:75], v98 offset:25344
    ds_read_b64_tr_b16 v[76:77], v98 offset:32768
    ds_read_b64_tr_b16 v[78:79], v98 offset:33536
    v_mfma_f32_32x32x16_bf16 v[32:47], v[88:91], v[84:87], v[32:47]
    v_mfma_f32_32x32x16_bf16 v[48:63], v[92:95], v[84:87], v[48:63]
    s_waitcnt lgkmcnt(0)
    ds_read_b128 v[80:83], v96 offset:25600
    ds_read_b128 v[84:87], v97 offset:25600
    ds_read_b64_tr_b16 v[88:89], v98 offset:27648
    ds_read_b64_tr_b16 v[90:91], v98 offset:28416
    ds_read_b64_tr_b16 v[92:93], v98 offset:35840
    ds_read_b64_tr_b16 v[94:95], v98 offset:36608
    v_mfma_f32_32x32x16_bf16 v[0:15], v[72:75], v[64:67], v[0:15]
    v_mfma_f32_32x32x16_bf16 v[16:31], v[76:79], v[64:67], v[16:31]
    v_mfma_f32_32x32x16_bf16 v[32:47], v[72:75], v[68:71], v[32:47]
    v_mfma_f32_32x32x16_bf16 v[48:63], v[76:79], v[68:71], v[48:63]
    s_waitcnt lgkmcnt(0)
    v_mfma_f32_32x32x16_bf16 v[0:15], v[88:91], v[80:83], v[0:15]
    v_mfma_f32_32x32x16_bf16 v[16:31], v[92:95], v[80:83], v[16:31]
    v_mfma_f32_32x32x16_bf16 v[32:47], v[88:91], v[84:87], v[32:47]
    v_mfma_f32_32x32x16_bf16 v[48:63], v[92:95], v[84:87], v[48:63]
    s_setprio 3
    v_mov_b32 v64, v104
    s_nop 9
    v_mul_f32 v68, s48, v0
    v_mul_f32 v69, s48, v1
    v_mul_f32 v70, s48, v2
    v_mul_f32 v71, s48, v3
    v_mul_f32 v72, s48, v4
    v_mul_f32 v73, s48, v5
    v_mul_f32 v74, s48, v6
    v_mul_f32 v75, s48, v7
    v_exp_f32 v68, v68
    v_exp_f32 v69, v69
    v_exp_f32 v70, v70
    v_exp_f32 v71, v71
    v_exp_f32 v72, v72
    v_exp_f32 v73, v73
    v_exp_f32 v74, v74
    v_exp_f32 v75, v75
    v_mul_f32 v0, v0, v16
    v_mul_f32 v1, v1, v17
    v_mul_f32 v2, v2, v18
    v_mul_f32 v3, v3, v19
    v_mul_f32 v4, v4, v20
    v_mul_f32 v5, v5, v21
    v_mul_f32 v6, v6, v22
    v_mul_f32 v7, v7, v23
    v_add_f32 v68, 1.0, v68
    v_add_f32 v69, 1.0, v69
    v_add_f32 v70, 1.0, v70
    v_add_f32 v71, 1.0, v71
    v_add_f32 v72, 1.0, v72
    v_add_f32 v73, 1.0, v73
    v_add_f32 v74, 1.0, v74
    v_add_f32 v75, 1.0, v75
    v_rcp_f32 v68, v68
    v_rcp_f32 v69, v69
    v_rcp_f32 v70, v70
    v_rcp_f32 v71, v71
    v_rcp_f32 v72, v72
    v_rcp_f32 v73, v73
    v_rcp_f32 v74, v74
    v_rcp_f32 v75, v75
    s_nop 0
    v_mul_f32 v68, v68, v0
    v_mul_f32 v69, v69, v1
    v_mul_f32 v70, v70, v2
    v_mul_f32 v71, v71, v3
    v_mul_f32 v72, v72, v4
    v_mul_f32 v73, v73, v5
    v_mul_f32 v74, v74, v6
    v_mul_f32 v75, v75, v7
    v_cvt_pk_bf16_f32 v80, v68, v69
    v_cvt_pk_bf16_f32 v81, v70, v71
    v_cvt_pk_bf16_f32 v82, v72, v73
    v_cvt_pk_bf16_f32 v83, v74, v75
    buffer_store_dwordx4 v[80:83], v64, s[16:19], s50 offen offset:0 sc1
    v_mul_f32 v68, s48, v8
    v_mul_f32 v69, s48, v9
    v_mul_f32 v70, s48, v10
    v_mul_f32 v71, s48, v11
    v_mul_f32 v72, s48, v12
    v_mul_f32 v73, s48, v13
    v_mul_f32 v74, s48, v14
    v_mul_f32 v75, s48, v15
    v_exp_f32 v68, v68
    v_exp_f32 v69, v69
    v_exp_f32 v70, v70
    v_exp_f32 v71, v71
    v_exp_f32 v72, v72
    v_exp_f32 v73, v73
    v_exp_f32 v74, v74
    v_exp_f32 v75, v75
    v_mul_f32 v8, v8, v24
    v_mul_f32 v9, v9, v25
    v_mul_f32 v10, v10, v26
    v_mul_f32 v11, v11, v27
    v_mul_f32 v12, v12, v28
    v_mul_f32 v13, v13, v29
    v_mul_f32 v14, v14, v30
    v_mul_f32 v15, v15, v31
    v_add_f32 v68, 1.0, v68
    v_add_f32 v69, 1.0, v69
    v_add_f32 v70, 1.0, v70
    v_add_f32 v71, 1.0, v71
    v_add_f32 v72, 1.0, v72
    v_add_f32 v73, 1.0, v73
    v_add_f32 v74, 1.0, v74
    v_add_f32 v75, 1.0, v75
    v_rcp_f32 v68, v68
    v_rcp_f32 v69, v69
    v_rcp_f32 v70, v70
    v_rcp_f32 v71, v71
    v_rcp_f32 v72, v72
    v_rcp_f32 v73, v73
    v_rcp_f32 v74, v74
    v_rcp_f32 v75, v75
    s_nop 0
    v_mul_f32 v68, v68, v8
    v_mul_f32 v69, v69, v9
    v_mul_f32 v70, v70, v10
    v_mul_f32 v71, v71, v11
    v_mul_f32 v72, v72, v12
    v_mul_f32 v73, v73, v13
    v_mul_f32 v74, v74, v14
    v_mul_f32 v75, v75, v15
    v_cvt_pk_bf16_f32 v84, v68, v69
    v_cvt_pk_bf16_f32 v85, v70, v71
    v_cvt_pk_bf16_f32 v86, v72, v73
    v_cvt_pk_bf16_f32 v87, v74, v75
    buffer_store_dwordx4 v[84:87], v64, s[16:19], s50 offen offset:512 sc1
    s_barrier
    v_mul_f32 v68, s48, v32
    v_mul_f32 v69, s48, v33
    v_mul_f32 v70, s48, v34
    v_mul_f32 v71, s48, v35
    v_mul_f32 v72, s48, v36
    v_mul_f32 v73, s48, v37
    v_mul_f32 v74, s48, v38
    v_mul_f32 v75, s48, v39
    v_exp_f32 v68, v68
    v_exp_f32 v69, v69
    v_exp_f32 v70, v70
    v_exp_f32 v71, v71
    v_exp_f32 v72, v72
    v_exp_f32 v73, v73
    v_exp_f32 v74, v74
    v_exp_f32 v75, v75
    v_mul_f32 v32, v32, v48
    v_mul_f32 v33, v33, v49
    v_mul_f32 v34, v34, v50
    v_mul_f32 v35, v35, v51
    v_mul_f32 v36, v36, v52
    v_mul_f32 v37, v37, v53
    v_mul_f32 v38, v38, v54
    v_mul_f32 v39, v39, v55
    v_add_f32 v68, 1.0, v68
    v_add_f32 v69, 1.0, v69
    v_add_f32 v70, 1.0, v70
    v_add_f32 v71, 1.0, v71
    v_add_f32 v72, 1.0, v72
    v_add_f32 v73, 1.0, v73
    v_add_f32 v74, 1.0, v74
    v_add_f32 v75, 1.0, v75
    v_rcp_f32 v68, v68
    v_rcp_f32 v69, v69
    v_rcp_f32 v70, v70
    v_rcp_f32 v71, v71
    v_rcp_f32 v72, v72
    v_rcp_f32 v73, v73
    v_rcp_f32 v74, v74
    v_rcp_f32 v75, v75
    s_nop 0
    v_mul_f32 v68, v68, v32
    v_mul_f32 v69, v69, v33
    v_mul_f32 v70, v70, v34
    v_mul_f32 v71, v71, v35
    v_mul_f32 v72, v72, v36
    v_mul_f32 v73, v73, v37
    v_mul_f32 v74, v74, v38
    v_mul_f32 v75, v75, v39
    v_cvt_pk_bf16_f32 v88, v68, v69
    v_cvt_pk_bf16_f32 v89, v70, v71
    v_cvt_pk_bf16_f32 v90, v72, v73
    v_cvt_pk_bf16_f32 v91, v74, v75
    buffer_store_dwordx4 v[88:91], v64, s[16:19], s51 offen offset:0 sc1
    v_mul_f32 v68, s48, v40
    v_mul_f32 v69, s48, v41
    v_mul_f32 v70, s48, v42
    v_mul_f32 v71, s48, v43
    v_mul_f32 v72, s48, v44
    v_mul_f32 v73, s48, v45
    v_mul_f32 v74, s48, v46
    v_mul_f32 v75, s48, v47
    v_exp_f32 v68, v68
    v_exp_f32 v69, v69
    v_exp_f32 v70, v70
    v_exp_f32 v71, v71
    v_exp_f32 v72, v72
    v_exp_f32 v73, v73
    v_exp_f32 v74, v74
    v_exp_f32 v75, v75
    v_mul_f32 v40, v40, v56
    v_mul_f32 v41, v41, v57
    v_mul_f32 v42, v42, v58
    v_mul_f32 v43, v43, v59
    v_mul_f32 v44, v44, v60
    v_mul_f32 v45, v45, v61
    v_mul_f32 v46, v46, v62
    v_mul_f32 v47, v47, v63
    v_add_f32 v68, 1.0, v68
    v_add_f32 v69, 1.0, v69
    v_add_f32 v70, 1.0, v70
    v_add_f32 v71, 1.0, v71
    v_add_f32 v72, 1.0, v72
    v_add_f32 v73, 1.0, v73
    v_add_f32 v74, 1.0, v74
    v_add_f32 v75, 1.0, v75
    v_rcp_f32 v68, v68
    v_rcp_f32 v69, v69
    v_rcp_f32 v70, v70
    v_rcp_f32 v71, v71
    v_rcp_f32 v72, v72
    v_rcp_f32 v73, v73
    v_rcp_f32 v74, v74
    v_rcp_f32 v75, v75
    s_nop 0
    v_mul_f32 v68, v68, v40
    v_mul_f32 v69, v69, v41
    v_mul_f32 v70, v70, v42
    v_mul_f32 v71, v71, v43
    v_mul_f32 v72, v72, v44
    v_mul_f32 v73, v73, v45
    v_mul_f32 v74, v74, v46
    v_mul_f32 v75, v75, v47
    v_cvt_pk_bf16_f32 v92, v68, v69
    v_cvt_pk_bf16_f32 v93, v70, v71
    v_cvt_pk_bf16_f32 v94, v72, v73
    v_cvt_pk_bf16_f32 v95, v74, v75
    buffer_store_dwordx4 v[92:95], v64, s[16:19], s51 offen offset:512 sc1
    s_branch L_gu_end
L_gu_split:
    ds_read_b128 v[64:67], v96 offset:0
    ds_read_b128 v[68:71], v97 offset:0
    ds_read_b64_tr_b16 v[72:73], v98 offset:0
    ds_read_b64_tr_b16 v[74:75], v98 offset:768
    ds_read_b64_tr_b16 v[76:77], v98 offset:8192
    ds_read_b64_tr_b16 v[78:79], v98 offset:8960
    s_waitcnt lgkmcnt(0)
    v_mfma_f32_32x32x16_bf16 v[0:15], v[72:75], v[64:67], 0
    v_mfma_f32_32x32x16_bf16 v[16:31], v[76:79], v[64:67], 0
    s_waitcnt vmcnt(3)
    s_barrier
    ds_read_b128 v[80:83], v96 offset:24576
    ds_read_b128 v[84:87], v97 offset:24576
    ds_read_b64_tr_b16 v[88:89], v98 offset:24576
    ds_read_b64_tr_b16 v[90:91], v98 offset:25344
    ds_read_b64_tr_b16 v[92:93], v98 offset:32768
    ds_read_b64_tr_b16 v[94:95], v98 offset:33536
    v_mfma_f32_32x32x16_bf16 v[32:47], v[72:75], v[68:71], 0
    v_mfma_f32_32x32x16_bf16 v[48:63], v[76:79], v[68:71], 0
    s_add_u32 m0, s29, 0
    s_add_u32 s26, s26, 1
    buffer_load_dwordx4 v100, s[4:7], s24 offen sc1 lds
    s_add_u32 m0, s29, 8192
    s_add_u32 s24, s24, 2048
    buffer_load_dwordx4 v101, s[8:11], s25 offen lds
    s_add_u32 m0, s29, 16384
    s_cmp_eq_u32 s26, 20
    buffer_load_dwordx4 v101, s[12:15], s25 offen lds
    s_cselect_b32 s24, s27, s24
    s_cselect_b32 s30, 4293099520, s28
    s_add_u32 s25, s25, s30
    s_waitcnt lgkmcnt(0)
    v_mfma_f32_32x32x16_bf16 v[0:15], v[88:91], v[80:83], v[0:15]
    v_mfma_f32_32x32x16_bf16 v[16:31], v[92:95], v[80:83], v[16:31]
    s_waitcnt vmcnt(3)
    s_barrier
    ds_read_b128 v[64:67], v96 offset:49152
    ds_read_b128 v[68:71], v97 offset:49152
    ds_read_b64_tr_b16 v[72:73], v98 offset:49152
    ds_read_b64_tr_b16 v[74:75], v98 offset:49920
    ds_read_b64_tr_b16 v[76:77], v98 offset:57344
    ds_read_b64_tr_b16 v[78:79], v98 offset:58112
    v_mfma_f32_32x32x16_bf16 v[32:47], v[88:91], v[84:87], v[32:47]
    v_mfma_f32_32x32x16_bf16 v[48:63], v[92:95], v[84:87], v[48:63]
    s_add_u32 m0, s29, 24576
    s_add_u32 s26, s26, 1
    buffer_load_dwordx4 v100, s[4:7], s24 offen sc1 lds
    s_add_u32 m0, s29, 32768
    s_add_u32 s24, s24, 2048
    buffer_load_dwordx4 v101, s[8:11], s25 offen lds
    s_add_u32 m0, s29, 40960
    s_cmp_eq_u32 s26, 20
    buffer_load_dwordx4 v101, s[12:15], s25 offen lds
    s_cselect_b32 s24, s27, s24
    s_cselect_b32 s30, 4293099520, s28
    s_add_u32 s25, s25, s30
    s_waitcnt lgkmcnt(0)
    v_mfma_f32_32x32x16_bf16 v[0:15], v[72:75], v[64:67], v[0:15]
    v_mfma_f32_32x32x16_bf16 v[16:31], v[76:79], v[64:67], v[16:31]
    s_waitcnt vmcnt(3)
    s_barrier
    ds_read_b128 v[80:83], v96 offset:0
    ds_read_b128 v[84:87], v97 offset:0
    ds_read_b64_tr_b16 v[88:89], v98 offset:0
    ds_read_b64_tr_b16 v[90:91], v98 offset:768
    ds_read_b64_tr_b16 v[92:93], v98 offset:8192
    ds_read_b64_tr_b16 v[94:95], v98 offset:8960
    v_mfma_f32_32x32x16_bf16 v[32:47], v[72:75], v[68:71], v[32:47]
    v_mfma_f32_32x32x16_bf16 v[48:63], v[76:79], v[68:71], v[48:63]
    s_add_u32 m0, s29, 49152
    s_add_u32 s26, s26, 1
    buffer_load_dwordx4 v100, s[4:7], s24 offen sc1 lds
    s_add_u32 m0, s29, 57344
    s_add_u32 s24, s24, 2048
    buffer_load_dwordx4 v101, s[8:11], s25 offen lds
    s_add_u32 m0, s29, 65536
    s_cmp_eq_u32 s26, 20
    buffer_load_dwordx4 v101, s[12:15], s25 offen lds
    s_cselect_b32 s24, s27, s24
    s_cselect_b32 s30, 4293099520, s28
    s_add_u32 s25, s25, s30
    s_waitcnt lgkmcnt(0)
    v_mfma_f32_32x32x16_bf16 v[0:15], v[88:91], v[80:83], v[0:15]
    v_mfma_f32_32x32x16_bf16 v[16:31], v[92:95], v[80:83], v[16:31]
    s_waitcnt vmcnt(3)
    s_barrier
    ds_read_b128 v[64:67], v96 offset:24576
    ds_read_b128 v[68:71], v97 offset:24576
    ds_read_b64_tr_b16 v[72:73], v98 offset:24576
    ds_read_b64_tr_b16 v[74:75], v98 offset:25344
    ds_read_b64_tr_b16 v[76:77], v98 offset:32768
    ds_read_b64_tr_b16 v[78:79], v98 offset:33536
    v_mfma_f32_32x32x16_bf16 v[32:47], v[88:91], v[84:87], v[32:47]
    v_mfma_f32_32x32x16_bf16 v[48:63], v[92:95], v[84:87], v[48:63]
    s_add_u32 m0, s29, 0
    s_add_u32 s26, s26, 1
    buffer_load_dwordx4 v100, s[4:7], s24 offen sc1 lds
    s_add_u32 m0, s29, 8192
    s_add_u32 s24, s24, 2048
    buffer_load_dwordx4 v101, s[8:11], s25 offen lds
    s_add_u32 m0, s29, 16384
    s_cmp_eq_u32 s26, 20
    buffer_load_dwordx4 v101, s[12:15], s25 offen lds
    s_cselect_b32 s24, s27, s24
    s_cselect_b32 s30, 4293099520, s28
    s_add_u32 s25, s25, s30
    s_waitcnt lgkmcnt(0)
    v_mfma_f32_32x32x16_bf16 v[0:15], v[72:75], v[64:67], v[0:15]
    v_mfma_f32_32x32x16_bf16 v[16:31], v[76:79], v[64:67], v[16:31]
    s_waitcnt vmcnt(3)
    s_barrier
    ds_read_b128 v[80:83], v96 offset:49152
    ds_read_b128 v[84:87], v97 offset:49152
    ds_read_b64_tr_b16 v[88:89], v98 offset:49152
    ds_read_b64_tr_b16 v[90:91], v98 offset:49920
    ds_read_b64_tr_b16 v[92:93], v98 offset:57344
    ds_read_b64_tr_b16 v[94:95], v98 offset:58112
    v_mfma_f32_32x32x16_bf16 v[32:47], v[72:75], v[68:71], v[32:47]
    v_mfma_f32_32x32x16_bf16 v[48:63], v[76:79], v[68:71], v[48:63]
    s_add_u32 m0, s29, 24576
    s_add_u32 s26, s26, 1
    buffer_load_dwordx4 v100, s[4:7], s24 offen sc1 lds
    s_add_u32 m0, s29, 32768
    s_add_u32 s24, s24, 2048
    buffer_load_dwordx4 v101, s[8:11], s25 offen lds
    s_add_u32 m0, s29, 40960
    s_cmp_eq_u32 s26, 20
    buffer_load_dwordx4 v101, s[12:15], s25 offen lds
    s_cselect_b32 s24, s27, s24
    s_cselect_b32 s30, 4293099520, s28
    s_add_u32 s25, s25, s30
    s_waitcnt lgkmcnt(0)
    v_mfma_f32_32x32x16_bf16 v[0:15], v[88:91], v[80:83], v[0:15]
    v_mfma_f32_32x32x16_bf16 v[16:31], v[92:95], v[80:83], v[16:31]
    s_waitcnt vmcnt(3)
    s_barrier
    ds_read_b128 v[64:67], v96 offset:0
    ds_read_b128 v[68:71], v97 offset:0
    ds_read_b64_tr_b16 v[72:73], v98 offset:0
    ds_read_b64_tr_b16 v[74:75], v98 offset:768
    ds_read_b64_tr_b16 v[76:77], v98 offset:8192
    ds_read_b64_tr_b16 v[78:79], v98 offset:8960
    v_mfma_f32_32x32x16_bf16 v[32:47], v[88:91], v[84:87], v[32:47]
    v_mfma_f32_32x32x16_bf16 v[48:63], v[92:95], v[84:87], v[48:63]
    s_add_u32 m0, s29, 49152
    s_add_u32 s26, s26, 1
    buffer_load_dwordx4 v100, s[4:7], s24 offen sc1 lds
    s_add_u32 m0, s29, 57344
    s_add_u32 s24, s24, 2048
    buffer_load_dwordx4 v101, s[8:11], s25 offen lds
    s_add_u32 m0, s29, 65536
    s_cmp_eq_u32 s26, 20
    buffer_load_dwordx4 v101, s[12:15], s25 offen lds
    s_cselect_b32 s24, s27, s24
    s_cselect_b32 s30, 4293099520, s28
    s_add_u32 s25, s25, s30
    s_waitcnt lgkmcnt(0)
    v_mfma_f32_32x32x16_bf16 v[0:15], v[72:75], v[64:67], v[0:15]
    v_mfma_f32_32x32x16_bf16 v[16:31], v[76:79], v[64:67], v[16:31]
    s_waitcnt vmcnt(3)
    s_barrier
    ds_read_b128 v[80:83], v96 offset:24576
    ds_read_b128 v[84:87], v97 offset:24576
    ds_read_b64_tr_b16 v[88:89], v98 offset:24576
    ds_read_b64_tr_b16 v[90:91], v98 offset:25344
    ds_read_b64_tr_b16 v[92:93], v98 offset:32768
    ds_read_b64_tr_b16 v[94:95], v98 offset:33536
    v_mfma_f32_32x32x16_bf16 v[32:47], v[72:75], v[68:71], v[32:47]
    v_mfma_f32_32x32x16_bf16 v[48:63], v[76:79], v[68:71], v[48:63]
    s_add_u32 m0, s29, 0
    s_add_u32 s26, s26, 1
    buffer_load_dwordx4 v100, s[4:7], s24 offen sc1 lds
    s_add_u32 m0, s29, 8192
    s_add_u32 s24, s24, 2048
    buffer_load_dwordx4 v101, s[8:11], s25 offen lds
    s_add_u32 m0, s29, 16384
    s_cmp_eq_u32 s26, 20
    buffer_load_dwordx4 v101, s[12:15], s25 offen lds
    s_cselect_b32 s24, s27, s24
    s_cselect_b32 s30, 4293099520, s28
    s_add_u32 s25, s25, s30
    s_waitcnt lgkmcnt(0)
    v_mfma_f32_32x32x16_bf16 v[0:15], v[88:91], v[80:83], v[0:15]
    v_mfma_f32_32x32x16_bf16 v[16:31], v[92:95], v[80:83], v[16:31]
    s_waitcnt vmcnt(3)
    s_barrier
    ds_read_b128 v[64:67], v96 offset:49152
    ds_read_b128 v[68:71], v97 offset:49152
    ds_read_b64_tr_b16 v[72:73], v98 offset:49152
    ds_read_b64_tr_b16 v[74:75], v98 offset:49920
    ds_read_b64_tr_b16 v[76:77], v98 offset:57344
    ds_read_b64_tr_b16 v[78:79], v98 offset:58112
    v_mfma_f32_32x32x16_bf16 v[32:47], v[88:91], v[84:87], v[32:47]
    v_mfma_f32_32x32x16_bf16 v[48:63], v[92:95], v[84:87], v[48:63]
    s_add_u32 m0, s29, 24576
    s_add_u32 s26, s26, 1
    buffer_load_dwordx4 v100, s[4:7], s24 offen sc1 lds
    s_add_u32 m0, s29, 32768
    s_add_u32 s24, s24, 2048
    buffer_load_dwordx4 v101, s[8:11], s25 offen lds
    s_add_u32 m0, s29, 40960
    s_cmp_eq_u32 s26, 20
    buffer_load_dwordx4 v101, s[12:15], s25 offen lds
    s_cselect_b32 s24, s27, s24
    s_cselect_b32 s30, 4293099520, s28
    s_add_u32 s25, s25, s30
    s_waitcnt lgkmcnt(0)
    v_mfma_f32_32x32x16_bf16 v[0:15], v[72:75], v[64:67], v[0:15]
    v_mfma_f32_32x32x16_bf16 v[16:31], v[76:79], v[64:67], v[16:31]
    s_waitcnt vmcnt(3)
    s_barrier
    ds_read_b128 v[80:83], v96 offset:0
    ds_read_b128 v[84:87], v97 offset:0
    ds_read_b64_tr_b16 v[88:89], v98 offset:0
    ds_read_b64_tr_b16 v[90:91], v98 offset:768
    ds_read_b64_tr_b16 v[92:93], v98 offset:8192
    ds_read_b64_tr_b16 v[94:95], v98 offset:8960
    v_mfma_f32_32x32x16_bf16 v[32:47], v[72:75], v[68:71], v[32:47]
    v_mfma_f32_32x32x16_bf16 v[48:63], v[76:79], v[68:71], v[48:63]
    s_add_u32 m0, s29, 49152
    s_add_u32 s26, s26, 1
    buffer_load_dwordx4 v100, s[4:7], s24 offen sc1 lds
    s_add_u32 m0, s29, 57344
    s_add_u32 s24, s24, 2048
    buffer_load_dwordx4 v101, s[8:11], s25 offen lds
    s_add_u32 m0, s29, 65536
    s_cmp_eq_u32 s26, 20
    buffer_load_dwordx4 v101, s[12:15], s25 offen lds
    s_cselect_b32 s24, s27, s24
    s_cselect_b32 s30, 4293099520, s28
    s_add_u32 s25, s25, s30
    s_waitcnt lgkmcnt(0)
    v_mfma_f32_32x32x16_bf16 v[0:15], v[88:91], v[80:83], v[0:15]
    v_mfma_f32_32x32x16_bf16 v[16:31], v[92:95], v[80:83], v[16:31]
    s_waitcnt vmcnt(3)
    s_barrier
    ds_read_b128 v[64:67], v96 offset:24576
    ds_read_b128 v[68:71], v97 offset:24576
    ds_read_b64_tr_b16 v[72:73], v98 offset:24576
    ds_read_b64_tr_b16 v[74:75], v98 offset:25344
    ds_read_b64_tr_b16 v[76:77], v98 offset:32768
    ds_read_b64_tr_b16 v[78:79], v98 offset:33536
    v_mfma_f32_32x32x16_bf16 v[32:47], v[88:91], v[84:87], v[32:47]
    v_mfma_f32_32x32x16_bf16 v[48:63], v[92:95], v[84:87], v[48:63]
    s_add_u32 m0, s29, 0
    s_add_u32 s26, s26, 1
    buffer_load_dwordx4 v100, s[4:7], s24 offen sc1 lds
    s_add_u32 m0, s29, 8192
    s_add_u32 s24, s24, 2048
    buffer_load_dwordx4 v101, s[8:11], s25 offen lds
    s_add_u32 m0, s29, 16384
    s_cmp_eq_u32 s26, 20
    buffer_load_dwordx4 v101, s[12:15], s25 offen lds
    s_cselect_b32 s24, s27, s24
    s_cselect_b32 s30, 4293099520, s28
    s_add_u32 s25, s25, s30
    s_waitcnt lgkmcnt(0)
    v_mfma_f32_32x32x16_bf16 v[0:15], v[72:75], v[64:67], v[0:15]
    v_mfma_f32_32x32x16_bf16 v[16:31], v[76:79], v[64:67], v[16:31]
    s_waitcnt vmcnt(3)
    s_barrier
    ds_read_b128 v[80:83], v96 offset:49152
    ds_read_b128 v[84:87], v97 offset:49152
    ds_read_b64_tr_b16 v[88:89], v98 offset:49152
    ds_read_b64_tr_b16 v[90:91], v98 offset:49920
    ds_read_b64_tr_b16 v[92:93], v98 offset:57344
    ds_read_b64_tr_b16 v[94:95], v98 offset:58112
    v_mfma_f32_32x32x16_bf16 v[32:47], v[72:75], v[68:71], v[32:47]
    v_mfma_f32_32x32x16_bf16 v[48:63], v[76:79], v[68:71], v[48:63]
    s_add_u32 m0, s29, 24576
    s_add_u32 s26, s26, 1
    buffer_load_dwordx4 v100, s[4:7], s24 offen sc1 lds
    s_add_u32 m0, s29, 32768
    s_add_u32 s24, s24, 2048
    buffer_load_dwordx4 v101, s[8:11], s25 offen lds
    s_add_u32 m0, s29, 40960
    s_cmp_eq_u32 s26, 20
    buffer_load_dwordx4 v101, s[12:15], s25 offen lds
    s_cselect_b32 s24, s27, s24
    s_cselect_b32 s30, 4293099520, s28
    s_add_u32 s25, s25, s30
    s_waitcnt lgkmcnt(0)
    v_mfma_f32_32x32x16_bf16 v[0:15], v[88:91], v[80:83], v[0:15]
    v_mfma_f32_32x32x16_bf16 v[16:31], v[92:95], v[80:83], v[16:31]
    s_waitcnt vmcnt(3)
    s_barrier
    ds_read_b128 v[64:67], v96 offset:0
    ds_read_b128 v[68:71], v97 offset:0
    ds_read_b64_tr_b16 v[72:73], v98 offset:0
    ds_read_b64_tr_b16 v[74:75], v98 offset:768
    ds_read_b64_tr_b16 v[76:77], v98 offset:8192
    ds_read_b64_tr_b16 v[78:79], v98 offset:8960
    v_mfma_f32_32x32x16_bf16 v[32:47], v[88:91], v[84:87], v[32:47]
    v_mfma_f32_32x32x16_bf16 v[48:63], v[92:95], v[84:87], v[48:63]
    s_add_u32 m0, s29, 49152
    s_add_u32 s26, s26, 1
    buffer_load_dwordx4 v100, s[4:7], s24 offen sc1 lds
    s_add_u32 m0, s29, 57344
    s_add_u32 s24, s24, 2048
    buffer_load_dwordx4 v101, s[8:11], s25 offen lds
    s_add_u32 m0, s29, 65536
    s_cmp_eq_u32 s26, 20
    buffer_load_dwordx4 v101, s[12:15], s25 offen lds
    s_cselect_b32 s24, s27, s24
    s_cselect_b32 s30, 4293099520, s28
    s_add_u32 s25, s25, s30
    s_waitcnt lgkmcnt(0)
    v_mfma_f32_32x32x16_bf16 v[0:15], v[72:75], v[64:67], v[0:15]
    v_mfma_f32_32x32x16_bf16 v[16:31], v[76:79], v[64:67], v[16:31]
    s_waitcnt vmcnt(3)
    s_barrier
    ds_read_b128 v[80:83], v96 offset:24576
    ds_read_b128 v[84:87], v97 offset:24576
    ds_read_b64_tr_b16 v[88:89], v98 offset:24576
    ds_read_b64_tr_b16 v[90:91], v98 offset:25344
    ds_read_b64_tr_b16 v[92:93], v98 offset:32768
    ds_read_b64_tr_b16 v[94:95], v98 offset:33536
    v_mfma_f32_32x32x16_bf16 v[32:47], v[72:75], v[68:71], v[32:47]
    v_mfma_f32_32x32x16_bf16 v[48:63], v[76:79], v[68:71], v[48:63]
    s_add_u32 m0, s29, 0
    s_add_u32 s26, s26, 1
    buffer_load_dwordx4 v100, s[4:7], s24 offen sc1 lds
    s_add_u32 m0, s29, 8192
    s_add_u32 s24, s24, 2048
    buffer_load_dwordx4 v101, s[8:11], s25 offen lds
    s_add_u32 m0, s29, 16384
    s_cmp_eq_u32 s26, 20
    buffer_load_dwordx4 v101, s[12:15], s25 offen lds
    s_cselect_b32 s24, s27, s24
    s_cselect_b32 s30, 4293099520, s28
    s_add_u32 s25, s25, s30
    s_waitcnt lgkmcnt(0)
    v_mfma_f32_32x32x16_bf16 v[0:15], v[88:91], v[80:83], v[0:15]
    v_mfma_f32_32x32x16_bf16 v[16:31], v[92:95], v[80:83], v[16:31]
    s_waitcnt vmcnt(3)
    s_barrier
    ds_read_b128 v[64:67], v96 offset:49152
    ds_read_b128 v[68:71], v97 offset:49152
    ds_read_b64_tr_b16 v[72:73], v98 offset:49152
    ds_read_b64_tr_b16 v[74:75], v98 offset:49920
    ds_read_b64_tr_b16 v[76:77], v98 offset:57344
    ds_read_b64_tr_b16 v[78:79], v98 offset:58112
    v_mfma_f32_32x32x16_bf16 v[32:47], v[88:91], v[84:87], v[32:47]
    v_mfma_f32_32x32x16_bf16 v[48:63], v[92:95], v[84:87], v[48:63]
    s_add_u32 m0, s29, 24576
    s_add_u32 s26, s26, 1
    buffer_load_dwordx4 v100, s[4:7], s24 offen sc1 lds
    s_add_u32 m0, s29, 32768
    s_add_u32 s24, s24, 2048
    buffer_load_dwordx4 v101, s[8:11], s25 offen lds
    s_add_u32 m0, s29, 40960
    s_cmp_eq_u32 s26, 20
    buffer_load_dwordx4 v101, s[12:15], s25 offen lds
    s_cselect_b32 s24, s27, s24
    s_cselect_b32 s30, 4293099520, s28
    s_add_u32 s25, s25, s30
    s_waitcnt lgkmcnt(0)
    v_mfma_f32_32x32x16_bf16 v[0:15], v[72:75], v[64:67], v[0:15]
    v_mfma_f32_32x32x16_bf16 v[16:31], v[76:79], v[64:67], v[16:31]
    s_waitcnt vmcnt(3)
    s_barrier
    ds_read_b128 v[80:83], v96 offset:0
    ds_read_b128 v[84:87], v97 offset:0
    ds_read_b64_tr_b16 v[88:89], v98 offset:0
    ds_read_b64_tr_b16 v[90:91], v98 offset:768
    ds_read_b64_tr_b16 v[92:93], v98 offset:8192
    ds_read_b64_tr_b16 v[94:95], v98 offset:8960
    v_mfma_f32_32x32x16_bf16 v[32:47], v[72:75], v[68:71], v[32:47]
    v_mfma_f32_32x32x16_bf16 v[48:63], v[76:79], v[68:71], v[48:63]
    s_add_u32 m0, s29, 49152
    s_add_u32 s26, s26, 1
    buffer_load_dwordx4 v100, s[4:7], s24 offen sc1 lds
    s_add_u32 m0, s29, 57344
    s_add_u32 s24, s24, 2048
    buffer_load_dwordx4 v101, s[8:11], s25 offen lds
    s_add_u32 m0, s29, 65536
    s_cmp_eq_u32 s26, 20
    buffer_load_dwordx4 v101, s[12:15], s25 offen lds
    s_cselect_b32 s24, s27, s24
    s_cselect_b32 s30, 4293099520, s28
    s_add_u32 s25, s25, s30
    s_waitcnt lgkmcnt(0)
    v_mfma_f32_32x32x16_bf16 v[0:15], v[88:91], v[80:83], v[0:15]
    v_mfma_f32_32x32x16_bf16 v[16:31], v[92:95], v[80:83], v[16:31]
    s_waitcnt vmcnt(3)
    s_barrier
    ds_read_b128 v[64:67], v96 offset:24576
    ds_read_b128 v[68:71], v97 offset:24576
    ds_read_b64_tr_b16 v[72:73], v98 offset:24576
    ds_read_b64_tr_b16 v[74:75], v98 offset:25344
    ds_read_b64_tr_b16 v[76:77], v98 offset:32768
    ds_read_b64_tr_b16 v[78:79], v98 offset:33536
    v_mfma_f32_32x32x16_bf16 v[32:47], v[88:91], v[84:87], v[32:47]
    v_mfma_f32_32x32x16_bf16 v[48:63], v[92:95], v[84:87], v[48:63]
    s_add_u32 m0, s29, 0
    s_add_u32 s26, s26, 1
    buffer_load_dwordx4 v100, s[4:7], s24 offen sc1 lds
    s_add_u32 m0, s29, 8192
    s_add_u32 s24, s24, 2048
    buffer_load_dwordx4 v101, s[8:11], s25 offen lds
    s_add_u32 m0, s29, 16384
    s_cmp_eq_u32 s26, 20
    buffer_load_dwordx4 v101, s[12:15], s25 offen lds
    s_cselect_b32 s24, s27, s24
    s_cselect_b32 s30, 4293099520, s28
    s_add_u32 s25, s25, s30
    s_waitcnt lgkmcnt(0)
    v_mfma_f32_32x32x16_bf16 v[0:15], v[72:75], v[64:67], v[0:15]
    v_mfma_f32_32x32x16_bf16 v[16:31], v[76:79], v[64:67], v[16:31]
    s_waitcnt vmcnt(3)
    s_barrier
    ds_read_b128 v[80:83], v96 offset:49152
    ds_read_b128 v[84:87], v97 offset:49152
    ds_read_b64_tr_b16 v[88:89], v98 offset:49152
    ds_read_b64_tr_b16 v[90:91], v98 offset:49920
    ds_read_b64_tr_b16 v[92:93], v98 offset:57344
    ds_read_b64_tr_b16 v[94:95], v98 offset:58112
    v_mfma_f32_32x32x16_bf16 v[32:47], v[72:75], v[68:71], v[32:47]
    v_mfma_f32_32x32x16_bf16 v[48:63], v[76:79], v[68:71], v[48:63]
    s_add_u32 m0, s29, 24576
    s_add_u32 s26, s26, 1
    buffer_load_dwordx4 v100, s[4:7], s24 offen sc1 lds
    s_add_u32 m0, s29, 32768
    s_add_u32 s24, s24, 2048
    buffer_load_dwordx4 v101, s[8:11], s25 offen lds
    s_add_u32 m0, s29, 40960
    s_cmp_eq_u32 s26, 20
    buffer_load_dwordx4 v101, s[12:15], s25 offen lds
    s_cselect_b32 s24, s27, s24
    s_cselect_b32 s30, 4293099520, s28
    s_add_u32 s25, s25, s30
    s_waitcnt lgkmcnt(0)
    v_mfma_f32_32x32x16_bf16 v[0:15], v[88:91], v[80:83], v[0:15]
    v_mfma_f32_32x32x16_bf16 v[16:31], v[92:95], v[80:83], v[16:31]
    s_waitcnt vmcnt(3)
    s_barrier
    ds_read_b128 v[64:67], v96 offset:0
    ds_read_b128 v[68:71], v97 offset:0
    ds_read_b64_tr_b16 v[72:73], v98 offset:0
    ds_read_b64_tr_b16 v[74:75], v98 offset:768
    ds_read_b64_tr_b16 v[76:77], v98 offset:8192
    ds_read_b64_tr_b16 v[78:79], v98 offset:8960
    v_mfma_f32_32x32x16_bf16 v[32:47], v[88:91], v[84:87], v[32:47]
    v_mfma_f32_32x32x16_bf16 v[48:63], v[92:95], v[84:87], v[48:63]
    s_waitcnt lgkmcnt(0)
    v_mfma_f32_32x32x16_bf16 v[0:15], v[72:75], v[64:67], v[0:15]
    v_mfma_f32_32x32x16_bf16 v[16:31], v[76:79], v[64:67], v[16:31]
    s_waitcnt vmcnt(0)
    s_barrier
    ds_read_b128 v[80:83], v96 offset:24576
    ds_read_b128 v[84:87], v97 offset:24576
    ds_read_b64_tr_b16 v[88:89], v98 offset:24576
    ds_read_b64_tr_b16 v[90:91], v98 offset:25344
    ds_read_b64_tr_b16 v[92:93], v98 offset:32768
    ds_read_b64_tr_b16 v[94:95], v98 offset:33536
    v_mfma_f32_32x32x16_bf16 v[32:47], v[72:75], v[68:71], v[32:47]
    v_mfma_f32_32x32x16_bf16 v[48:63], v[76:79], v[68:71], v[48:63]
    s_waitcnt lgkmcnt(0)
    v_mfma_f32_32x32x16_bf16 v[0:15], v[88:91], v[80:83], v[0:15]
    v_mfma_f32_32x32x16_bf16 v[16:31], v[92:95], v[80:83], v[16:31]
    v_mfma_f32_32x32x16_bf16 v[32:47], v[88:91], v[84:87], v[32:47]
    v_mfma_f32_32x32x16_bf16 v[48:63], v[92:95], v[84:87], v[48:63]
    s_setprio 3
    v_mov_b32 v64, v104
    s_sub_u32 s30, s20, 4
    s_lshl_b32 s30, s30, 13
    v_add_u32 v65, s30, v100
    v_xor_b32 v66, 0x2000, v65
    s_nop 7
    ds_write_b128 v65, v[32:35] offset:49152
    ds_write_b128 v65, v[36:39] offset:50176
    ds_write_b128 v65, v[40:43] offset:51200
    ds_write_b128 v65, v[44:47] offset:52224
    ds_write_b128 v65, v[48:51] offset:53248
    ds_write_b128 v65, v[52:55] offset:54272
    ds_write_b128 v65, v[56:59] offset:55296
    ds_write_b128 v65, v[60:63] offset:56320
    s_waitcnt lgkmcnt(0)
    s_barrier
    ds_read_b128 v[32:35], v66 offset:49152
    ds_read_b128 v[36:39], v66 offset:50176
    ds_read_b128 v[40:43], v66 offset:51200
    ds_read_b128 v[44:47], v66 offset:52224
    ds_read_b128 v[48:51], v66 offset:53248
    ds_read_b128 v[52:55], v66 offset:54272
    ds_read_b128 v[56:59], v66 offset:55296
    ds_read_b128 v[60:63], v66 offset:56320
    s_waitcnt lgkmcnt(0)
    v_pk_add_f32 v[0:1], v[0:1], v[32:33]
    v_pk_add_f32 v[2:3], v[2:3], v[34:35]
    v_pk_add_f32 v[4:5], v[4:5], v[36:37]
    v_pk_add_f32 v[6:7], v[6:7], v[38:39]
    v_pk_add_f32 v[8:9], v[8:9], v[40:41]
    v_pk_add_f32 v[10:11], v[10:11], v[42:43]
    v_pk_add_f32 v[12:13], v[12:13], v[44:45]
    v_pk_add_f32 v[14:15], v[14:15], v[46:47]
    v_pk_add_f32 v[16:17], v[16:17], v[48:49]
    v_pk_add_f32 v[18:19], v[18:19], v[50:51]
    v_pk_add_f32 v[20:21], v[20:21], v[52:53]
    v_pk_add_f32 v[22:23], v[22:23], v[54:55]
    v_pk_add_f32 v[24:25], v[24:25], v[56:57]
    v_pk_add_f32 v[26:27], v[26:27], v[58:59]
    v_pk_add_f32 v[28:29], v[28:29], v[60:61]
    v_pk_add_f32 v[30:31], v[30:31], v[62:63]
    v_mul_f32 v68, s48, v0
    v_mul_f32 v69, s48, v1
    v_mul_f32 v70, s48, v2
    v_mul_f32 v71, s48, v3
    v_mul_f32 v72, s48, v4
    v_mul_f32 v73, s48, v5
    v_mul_f32 v74, s48, v6
    v_mul_f32 v75, s48, v7
    v_exp_f32 v68, v68
    v_exp_f32 v69, v69
    v_exp_f32 v70, v70
    v_exp_f32 v71, v71
    v_exp_f32 v72, v72
    v_exp_f32 v73, v73
    v_exp_f32 v74, v74
    v_exp_f32 v75, v75
    v_mul_f32 v0, v0, v16
    v_mul_f32 v1, v1, v17
    v_mul_f32 v2, v2, v18
    v_mul_f32 v3, v3, v19
    v_mul_f32 v4, v4, v20
    v_mul_f32 v5, v5, v21
    v_mul_f32 v6, v6, v22
    v_mul_f32 v7, v7, v23
    v_add_f32 v68, 1.0, v68
    v_add_f32 v69, 1.0, v69
    v_add_f32 v70, 1.0, v70
    v_add_f32 v71, 1.0, v71
    v_add_f32 v72, 1.0, v72
    v_add_f32 v73, 1.0, v73
    v_add_f32 v74, 1.0, v74
    v_add_f32 v75, 1.0, v75
    v_rcp_f32 v68, v68
    v_rcp_f32 v69, v69
    v_rcp_f32 v70, v70
    v_rcp_f32 v71, v71
    v_rcp_f32 v72, v72
    v_rcp_f32 v73, v73
    v_rcp_f32 v74, v74
    v_rcp_f32 v75, v75
    s_nop 0
    v_mul_f32 v68, v68, v0
    v_mul_f32 v69, v69, v1
    v_mul_f32 v70, v70, v2
    v_mul_f32 v71, v71, v3
    v_mul_f32 v72, v72, v4
    v_mul_f32 v73, v73, v5
    v_mul_f32 v74, v74, v6
    v_mul_f32 v75, v75, v7
    v_cvt_pk_bf16_f32 v80, v68, v69
    v_cvt_pk_bf16_f32 v81, v70, v71
    v_cvt_pk_bf16_f32 v82, v72, v73
    v_cvt_pk_bf16_f32 v83, v74, v75
    buffer_store_dwordx4 v[80:83], v64, s[16:19], s50 offen offset:0 sc1
    v_mul_f32 v68, s48, v8
    v_mul_f32 v69, s48, v9
    v_mul_f32 v70, s48, v10
    v_mul_f32 v71, s48, v11
    v_mul_f32 v72, s48, v12
    v_mul_f32 v73, s48, v13
    v_mul_f32 v74, s48, v14
    v_mul_f32 v75, s48, v15
    v_exp_f32 v68, v68
    v_exp_f32 v69, v69
    v_exp_f32 v70, v70
    v_exp_f32 v71, v71
    v_exp_f32 v72, v72
    v_exp_f32 v73, v73
    v_exp_f32 v74, v74
    v_exp_f32 v75, v75
    v_mul_f32 v8, v8, v24
    v_mul_f32 v9, v9, v25
    v_mul_f32 v10, v10, v26
    v_mul_f32 v11, v11, v27
    v_mul_f32 v12, v12, v28
    v_mul_f32 v13, v13, v29
    v_mul_f32 v14, v14, v30
    v_mul_f32 v15, v15, v31
    v_add_f32 v68, 1.0, v68
    v_add_f32 v69, 1.0, v69
    v_add_f32 v70, 1.0, v70
    v_add_f32 v71, 1.0, v71
    v_add_f32 v72, 1.0, v72
    v_add_f32 v73, 1.0, v73
    v_add_f32 v74, 1.0, v74
    v_add_f32 v75, 1.0, v75
    v_rcp_f32 v68, v68
    v_rcp_f32 v69, v69
    v_rcp_f32 v70, v70
    v_rcp_f32 v71, v71
    v_rcp_f32 v72, v72
    v_rcp_f32 v73, v73
    v_rcp_f32 v74, v74
    v_rcp_f32 v75, v75
    s_nop 0
    v_mul_f32 v68, v68, v8
    v_mul_f32 v69, v69, v9
    v_mul_f32 v70, v70, v10
    v_mul_f32 v71, v71, v11
    v_mul_f32 v72, v72, v12
    v_mul_f32 v73, v73, v13
    v_mul_f32 v74, v74, v14
    v_mul_f32 v75, v75, v15
    v_cvt_pk_bf16_f32 v84, v68, v69
    v_cvt_pk_bf16_f32 v85, v70, v71
    v_cvt_pk_bf16_f32 v86, v72, v73
    v_cvt_pk_bf16_f32 v87, v74, v75
    buffer_store_dwordx4 v[84:87], v64, s[16:19], s50 offen offset:512 sc1
L_gu_end:
    s_setprio 0
    s_waitcnt vmcnt(0)
    s_barrier
    s_cmp_lg_u32 s20, 0
    s_cbranch_scc1 L_arr_gu
    s_add_u32 s30, s31, 0
    s_lshl_b32 s30, s30, 7
    v_mov_b32 v2, s30
    v_mov_b32 v3, 1
    s_mov_b64 exec, 1
    buffer_atomic_add v3, v2, s[44:47], 0 offen sc0 sc1
    s_mul_i32 s30, s31, 1
    s_add_u32 s30, s30, 112
    s_waitcnt vmcnt(0)
    v_readfirstlane_b32 s55, v3
    s_mov_b64 exec, -1
    s_cmp_lg_u32 s55, 15
    s_cbranch_scc1 L_arr_gu
    v_mbcnt_lo_u32_b32 v2, -1, 0
    v_add_lshl_u32 v2, v2, s30, 7
    v_mov_b32 v3, 1
    s_mov_b64 exec, 1
    buffer_store_dword v3, v2, s[44:47], 0 offen sc1
    s_mov_b64 exec, -1
L_arr_gu:
L_out:
    s_load_dwordx2 s[32:33], s[0:1], 0
    s_load_dwordx2 s[34:35], s[0:1], 56
    s_and_b32 s21, s23, 3
    s_lshl_b32 s21, s21, 3
    s_bfe_u32 s22, s23, 0x30003
    s_add_u32 s21, s21, s22
    s_bfe_u32 s22, s23, 0x10002
    s_lshl_b32 s22, s22, 2
    s_lshr_b32 s30, s23, 6
    s_add_u32 s22, s22, s30
    s_add_u32 s4, s38, 10485760
    s_addc_u32 s5, s39, 0
    s_mov_b32 s6, 8912896
    s_mov_b32 s7, 0x00020000
    s_add_u32 s8, s38, 25165824
    s_addc_u32 s9, s39, 0
    s_mov_b32 s10, 2785280
    s_mov_b32 s11, 0x00020000
    s_and_b32 s27, s20, 3
    s_lshl_b32 s24, s21, 2
    s_add_u32 s24, s24, s27
    s_mul_i32 s24, s24, 68
    s_lshr_b32 s30, s20, 2
    s_add_u32 s24, s24, s30
    s_add_u32 s24, s24, 20
    s_lshl_b32 s24, s24, 10
    s_mul_i32 s25, s22, 68
    s_add_u32 s25, s25, 20
    s_mul_i32 s25, s25, 5120
    s_add_u32 s25, s25, s29
    s_cmp_ge_u32 s20, 6
    s_mov_b32 s26, 4096
    s_cmov_b32 s26, 0x40000000
    s_lshl_b32 s30, s27, 10
    v_add_u32 v96, s30, v100
    v_add_u32 v97, 40960, v96
    v_add_u32 v99, 40960, v100
    v_and_b32 v2, 15, v103
    v_mul_u32_u24 v2, 1280, v2
    v_lshrrev_b32 v3, 4, v103
    v_lshl_add_u32 v98, v3, 3, v2
    v_and_b32 v4, 1, v3
    v_lshl_add_u32 v95, v4, 5, v2
    v_lshrrev_b32 v4, 1, v3
    v_lshl_add_u32 v95, v4, 4, v95
    s_lshl_b32 s49, s21, 2
    s_add_u32 s49, s49, s27
    s_mul_i32 s49, s49, 20480
    s_mul_i32 s30, s22, 160
    s_add_u32 s49, s49, s30
    s_cmp_lg_u32 s20, 0
    s_cbranch_scc1 L_dn_nopoll
    s_lshr_b32 s41, s21, 1
    s_add_u32 s41, s41, 112
    s_lshl_b32 s30, s41, 7
    v_mov_b32 v2, s30
    s_mov_b32 s55, 262144
    s_mov_b64 exec, 1
L_poll_h:
    buffer_load_dword v3, v2, s[44:47], 0 offen sc1
    s_waitcnt vmcnt(0)
    v_cmp_ne_u32 vcc, 1, v3
    s_cbranch_vccz L_got_h
    s_sleep 24
    s_sub_u32 s55, s55, 1
    s_cbranch_scc0 L_poll_h
L_got_h:
    s_mov_b64 exec, -1
    v_add_lshl_u32 v2, v103, 48, 7
    s_mov_b32 s55, 262144
    s_mov_b64 exec, 255
L_poll_wf:
    buffer_load_dword v3, v2, s[44:47], 0 offen sc1
    s_waitcnt vmcnt(0)
    v_cmp_ne_u32 vcc, 32, v3
    s_cbranch_vccz L_got_wf
    s_sleep 24
    s_sub_u32 s55, s55, 1
    s_cbranch_scc0 L_poll_wf
L_got_wf:
    s_mov_b64 exec, -1
L_dn_nopoll:
    s_waitcnt lgkmcnt(0)
    s_mov_b32 s12, s32
    s_mov_b32 s13, s33
    s_mov_b32 s14, 2621440
    s_mov_b32 s15, 0x00020000
    s_mov_b32 s16, s34
    s_mov_b32 s17, s35
    s_mov_b32 s18, 2621440
    s_mov_b32 s19, 0x00020000
    s_barrier
    s_cmp_ge_u32 s20, 4
    s_cbranch_scc1 L_dn_g1
    s_mul_i32 s48, s22, 348160
    s_add_u32 s30, s48, 81920
    s_add_u32 s48, s48, s29
    s_add_u32 s41, s30, 0
    buffer_load_dwordx4 v[68:71], v100, s[8:11], s41 offen sc1
    s_add_u32 s41, s30, 1024
    buffer_load_dwordx4 v[72:75], v100, s[8:11], s41 offen sc1
    s_add_u32 s41, s30, 2048
    buffer_load_dwordx4 v[76:79], v100, s[8:11], s41 offen sc1
    s_add_u32 s41, s30, 3072
    buffer_load_dwordx4 v[80:83], v100, s[8:11], s41 offen sc1
    s_add_u32 s41, s30, 4096
    buffer_load_dwordx4 v[84:87], v100, s[8:11], s41 offen sc1
    s_add_u32 s41, s30, 5120
    buffer_load_dwordx4 v[104:107], v100, s[8:11], s41 offen sc1
    s_add_u32 s41, s30, 6144
    buffer_load_dwordx4 v[108:111], v100, s[8:11], s41 offen sc1
    s_add_u32 s41, s30, 7168
    buffer_load_dwordx4 v[112:115], v100, s[8:11], s41 offen sc1
    s_add_u32 s41, s30, 8192
    buffer_load_dwordx4 v[116:119], v100, s[8:11], s41 offen sc1
    s_add_u32 s41, s30, 9216
    buffer_load_dwordx4 v[120:123], v100, s[8:11], s41 offen sc1
    buffer_load_dwordx2 v[60:61], v98, s[12:15], s49 offen offset:0
    buffer_load_dwordx2 v[62:63], v98, s[12:15], s49 offen offset:32
    buffer_load_dwordx2 v[64:65], v98, s[12:15], s49 offen offset:64
    s_add_u32 m0, s29, 0
    s_nop 0
    buffer_load_dwordx4 v100, s[4:7], s24 offen sc1 lds
    s_add_u32 s24, s24, 2048
    s_add_u32 m0, s29, 8192
    s_nop 0
    buffer_load_dwordx4 v100, s[8:11], s25 offen sc1 lds
    s_add_u32 s25, s25, 10240
    s_add_u32 m0, s29, 20480
    s_nop 0
    buffer_load_dwordx4 v100, s[4:7], s24 offen sc1 lds
    s_add_u32 s24, s24, 2048
    s_add_u32 m0, s29, 28672
    s_nop 0
    buffer_load_dwordx4 v100, s[8:11], s25 offen sc1 lds
    s_add_u32 s25, s25, 10240
    s_add_u32 m0, s29, 40960
    s_nop 0
    buffer_load_dwordx4 v100, s[4:7], s24 offen sc1 lds
    s_add_u32 s24, s24, 2048
    s_add_u32 m0, s29, 49152
    s_nop 0
    buffer_load_dwordx4 v100, s[8:11], s25 offen sc1 lds
    s_add_u32 s25, s25, 10240
    s_add_u32 m0, s29, 61440
    s_nop 0
    buffer_load_dwordx4 v100, s[4:7], s24 offen sc1 lds
    s_add_u32 s24, s24, 2048
    s_add_u32 m0, s29, 69632
    s_nop 0
    buffer_load_dwordx4 v100, s[8:11], s25 offen sc1 lds
    s_add_u32 s25, s25, 10240
    s_waitcnt vmcnt(6)
    s_barrier
    ds_read_b128 v[16:19], v96 offset:0
    ds_read_b128 v[20:23], v100 offset:8192
    ds_read_b128 v[24:27], v100 offset:9216
    ds_read_b128 v[28:31], v100 offset:10240
    s_waitcnt lgkmcnt(0)
    ds_read_b128 v[32:35], v96 offset:4096
    ds_read_b128 v[36:39], v100 offset:13312
    ds_read_b128 v[40:43], v100 offset:14336
    ds_read_b128 v[44:47], v100 offset:15360
    v_mfma_f32_16x16x32_bf16 v[0:3], v[20:23], v[16:19], 0
    v_mfma_f32_16x16x32_bf16 v[4:7], v[24:27], v[16:19], 0
    v_mfma_f32_16x16x32_bf16 v[8:11], v[28:31], v[16:19], 0
    s_waitcnt lgkmcnt(0)
    s_waitcnt vmcnt(4)
    s_barrier
    ds_read_b128 v[16:19], v96 offset:20480
    ds_read_b128 v[20:23], v100 offset:28672
    ds_read_b128 v[24:27], v100 offset:29696
    ds_read_b128 v[28:31], v100 offset:30720
    v_mfma_f32_16x16x32_bf16 v[0:3], v[36:39], v[32:35], v[0:3]
    v_mfma_f32_16x16x32_bf16 v[4:7], v[40:43], v[32:35], v[4:7]
    v_mfma_f32_16x16x32_bf16 v[8:11], v[44:47], v[32:35], v[8:11]
    s_add_u32 m0, s29, 0
    s_nop 0
    buffer_load_dwordx4 v100, s[4:7], s24 offen sc1 lds
    s_add_u32 s24, s24, 2048
    s_add_u32 m0, s29, 8192
    s_nop 0
    buffer_load_dwordx4 v100, s[8:11], s25 offen sc1 lds
    s_add_u32 s25, s25, 10240
    s_waitcnt lgkmcnt(0)
    ds_read_b128 v[32:35], v96 offset:24576
    ds_read_b128 v[36:39], v100 offset:33792
    ds_read_b128 v[40:43], v100 offset:34816
    ds_read_b128 v[44:47], v100 offset:35840
    v_mfma_f32_16x16x32_bf16 v[0:3], v[20:23], v[16:19], v[0:3]
    v_mfma_f32_16x16x32_bf16 v[4:7], v[24:27], v[16:19], v[4:7]
    v_mfma_f32_16x16x32_bf16 v[8:11], v[28:31], v[16:19], v[8:11]
    s_waitcnt lgkmcnt(0)
    s_waitcnt vmcnt(4)
    s_barrier
    ds_read_b128 v[16:19], v97 offset:0
    ds_read_b128 v[20:23], v99 offset:8192
    ds_read_b128 v[24:27], v99 offset:9216
    ds_read_b128 v[28:31], v99 offset:10240
    v_mfma_f32_16x16x32_bf16 v[0:3], v[36:39], v[32:35], v[0:3]
    v_mfma_f32_16x16x32_bf16 v[4:7], v[40:43], v[32:35], v[4:7]
    v_mfma_f32_16x16x32_bf16 v[8:11], v[44:47], v[32:35], v[8:11]
    s_add_u32 m0, s29, 20480
    s_nop 0
    buffer_load_dwordx4 v100, s[4:7], s24 offen sc1 lds
    s_add_u32 s24, s24, 2048
    s_add_u32 m0, s29, 28672
    s_nop 0
    buffer_load_dwordx4 v100, s[8:11], s25 offen sc1 lds
    s_add_u32 s25, s25, 10240
    s_waitcnt lgkmcnt(0)
    ds_read_b128 v[32:35], v97 offset:4096
    ds_read_b128 v[36:39], v99 offset:13312
    ds_read_b128 v[40:43], v99 offset:14336
    ds_read_b128 v[44:47], v99 offset:15360
    v_mfma_f32_16x16x32_bf16 v[0:3], v[20:23], v[16:19], v[0:3]
    v_mfma_f32_16x16x32_bf16 v[4:7], v[24:27], v[16:19], v[4:7]
    v_mfma_f32_16x16x32_bf16 v[8:11], v[28:31], v[16:19], v[8:11]
    s_waitcnt lgkmcnt(0)
    s_waitcnt vmcnt(4)
    s_barrier
    ds_read_b128 v[16:19], v97 offset:20480
    ds_read_b128 v[20:23], v99 offset:28672
    ds_read_b128 v[24:27], v99 offset:29696
    ds_read_b128 v[28:31], v99 offset:30720
    v_mfma_f32_16x16x32_bf16 v[0:3], v[36:39], v[32:35], v[0:3]
    v_mfma_f32_16x16x32_bf16 v[4:7], v[40:43], v[32:35], v[4:7]
    v_mfma_f32_16x16x32_bf16 v[8:11], v[44:47], v[32:35], v[8:11]
    s_add_u32 m0, s29, 40960
    s_nop 0
    buffer_load_dwordx4 v100, s[4:7], s24 offen sc1 lds
    s_add_u32 s24, s24, 2048
    s_add_u32 m0, s29, 49152
    s_nop 0
    buffer_load_dwordx4 v100, s[8:11], s25 offen sc1 lds
    s_add_u32 s25, s25, 10240
    s_waitcnt lgkmcnt(0)
    ds_read_b128 v[32:35], v97 offset:24576
    ds_read_b128 v[36:39], v99 offset:33792
    ds_read_b128 v[40:43], v99 offset:34816
    ds_read_b128 v[44:47], v99 offset:35840
    v_mfma_f32_16x16x32_bf16 v[0:3], v[20:23], v[16:19], v[0:3]
    v_mfma_f32_16x16x32_bf16 v[4:7], v[24:27], v[16:19], v[4:7]
    v_mfma_f32_16x16x32_bf16 v[8:11], v[28:31], v[16:19], v[8:11]
    s_waitcnt lgkmcnt(0)
    s_waitcnt vmcnt(4)
    s_barrier
    ds_read_b128 v[16:19], v96 offset:0
    ds_read_b128 v[20:23], v100 offset:8192
    ds_read_b128 v[24:27], v100 offset:9216
    ds_read_b128 v[28:31], v100 offset:10240
    v_mfma_f32_16x16x32_bf16 v[0:3], v[36:39], v[32:35], v[0:3]
    v_mfma_f32_16x16x32_bf16 v[4:7], v[40:43], v[32:35], v[4:7]
    v_mfma_f32_16x16x32_bf16 v[8:11], v[44:47], v[32:35], v[8:11]
    s_add_u32 m0, s29, 61440
    s_nop 0
    buffer_load_dwordx4 v100, s[4:7], s24 offen sc1 lds
    s_add_u32 s24, s24, 2048
    s_add_u32 m0, s29, 69632
    s_nop 0
    buffer_load_dwordx4 v100, s[8:11], s25 offen sc1 lds
    s_add_u32 s25, s25, 10240
    s_waitcnt lgkmcnt(0)
    ds_read_b128 v[32:35], v96 offset:4096
    ds_read_b128 v[36:39], v100 offset:13312
    ds_read_b128 v[40:43], v100 offset:14336
    ds_read_b128 v[44:47], v100 offset:15360
    v_mfma_f32_16x16x32_bf16 v[0:3], v[20:23], v[16:19], v[0:3]
    v_mfma_f32_16x16x32_bf16 v[4:7], v[24:27], v[16:19], v[4:7]
    v_mfma_f32_16x16x32_bf16 v[8:11], v[28:31], v[16:19], v[8:11]
    s_waitcnt lgkmcnt(0)
    s_waitcnt vmcnt(4)
    s_barrier
    ds_read_b128 v[16:19], v96 offset:20480
    ds_read_b128 v[20:23], v100 offset:28672
    ds_read_b128 v[24:27], v100 offset:29696
    ds_read_b128 v[28:31], v100 offset:30720
    v_mfma_f32_16x16x32_bf16 v[0:3], v[36:39], v[32:35], v[0:3]
    v_mfma_f32_16x16x32_bf16 v[4:7], v[40:43], v[32:35], v[4:7]
    v_mfma_f32_16x16x32_bf16 v[8:11], v[44:47], v[32:35], v[8:11]
    s_add_u32 m0, s29, 0
    s_nop 0
    buffer_load_dwordx4 v100, s[4:7], s24 offen sc1 lds
    s_add_u32 s24, s24, 2048
    s_add_u32 m0, s29, 8192
    s_nop 0
    buffer_load_dwordx4 v100, s[8:11], s25 offen sc1 lds
    s_add_u32 s25, s25, 10240
    s_waitcnt lgkmcnt(0)
    ds_read_b128 v[32:35], v96 offset:24576
    ds_read_b128 v[36:39], v100 offset:33792
    ds_read_b128 v[40:43], v100 offset:34816
    ds_read_b128 v[44:47], v100 offset:35840
    v_mfma_f32_16x16x32_bf16 v[0:3], v[20:23], v[16:19], v[0:3]
    v_mfma_f32_16x16x32_bf16 v[4:7], v[24:27], v[16:19], v[4:7]
    v_mfma_f32_16x16x32_bf16 v[8:11], v[28:31], v[16:19], v[8:11]
    s_waitcnt lgkmcnt(0)
    s_waitcnt vmcnt(4)
    s_barrier
    ds_read_b128 v[16:19], v97 offset:0
    ds_read_b128 v[20:23], v99 offset:8192
    ds_read_b128 v[24:27], v99 offset:9216
    ds_read_b128 v[28:31], v99 offset:10240
    v_mfma_f32_16x16x32_bf16 v[0:3], v[36:39], v[32:35], v[0:3]
    v_mfma_f32_16x16x32_bf16 v[4:7], v[40:43], v[32:35], v[4:7]
    v_mfma_f32_16x16x32_bf16 v[8:11], v[44:47], v[32:35], v[8:11]
    s_add_u32 m0, s29, 20480
    s_nop 0
    buffer_load_dwordx4 v100, s[4:7], s24 offen sc1 lds
    s_add_u32 s24, s24, 2048
    s_add_u32 m0, s29, 28672
    s_nop 0
    buffer_load_dwordx4 v100, s[8:11], s25 offen sc1 lds
    s_add_u32 s25, s25, 10240
    s_waitcnt lgkmcnt(0)
    ds_read_b128 v[32:35], v97 offset:4096
    ds_read_b128 v[36:39], v99 offset:13312
    ds_read_b128 v[40:43], v99 offset:14336
    ds_read_b128 v[44:47], v99 offset:15360
    v_mfma_f32_16x16x32_bf16 v[0:3], v[20:23], v[16:19], v[0:3]
    v_mfma_f32_16x16x32_bf16 v[4:7], v[24:27], v[16:19], v[4:7]
    v_mfma_f32_16x16x32_bf16 v[8:11], v[28:31], v[16:19], v[8:11]
    s_waitcnt lgkmcnt(0)
    s_waitcnt vmcnt(4)
    s_barrier
    ds_read_b128 v[16:19], v97 offset:20480
    ds_read_b128 v[20:23], v99 offset:28672
    ds_read_b128 v[24:27], v99 offset:29696
    ds_read_b128 v[28:31], v99 offset:30720
    v_mfma_f32_16x16x32_bf16 v[0:3], v[36:39], v[32:35], v[0:3]
    v_mfma_f32_16x16x32_bf16 v[4:7], v[40:43], v[32:35], v[4:7]
    v_mfma_f32_16x16x32_bf16 v[8:11], v[44:47], v[32:35], v[8:11]
    s_add_u32 m0, s29, 40960
    s_nop 0
    buffer_load_dwordx4 v100, s[4:7], s24 offen sc1 lds
    s_add_u32 s24, s24, 2048
    s_add_u32 m0, s29, 49152
    s_nop 0
    buffer_load_dwordx4 v100, s[8:11], s25 offen sc1 lds
    s_add_u32 s25, s25, 10240
    s_waitcnt lgkmcnt(0)
    ds_read_b128 v[32:35], v97 offset:24576
    ds_read_b128 v[36:39], v99 offset:33792
    ds_read_b128 v[40:43], v99 offset:34816
    ds_read_b128 v[44:47], v99 offset:35840
    v_mfma_f32_16x16x32_bf16 v[0:3], v[20:23], v[16:19], v[0:3]
    v_mfma_f32_16x16x32_bf16 v[4:7], v[24:27], v[16:19], v[4:7]
    v_mfma_f32_16x16x32_bf16 v[8:11], v[28:31], v[16:19], v[8:11]
    s_waitcnt lgkmcnt(0)
    s_cmp_lg_u32 s20, 0
    s_cbranch_scc1 L_nohold
    s_and_b32 s41, s23, 7
    s_add_u32 s41, s41, 152
    s_lshl_b32 s30, s41, 7
    v_mov_b32 v66, s30
    s_mov_b32 s55, 262144
    s_mov_b64 exec, 1
L_poll_late:
    buffer_load_dword v67, v66, s[44:47], 0 offen sc1
    s_waitcnt vmcnt(0)
    v_cmp_ne_u32 vcc, 1, v67
    s_cbranch_vccz L_got_late
    s_sleep 12
    s_sub_u32 s55, s55, 1
    s_cbranch_scc0 L_poll_late
L_got_late:
    s_mov_b64 exec, -1
L_nohold:
    s_waitcnt vmcnt(4)
    s_barrier
    ds_read_b128 v[16:19], v96 offset:0
    ds_read_b128 v[20:23], v100 offset:8192
    ds_read_b128 v[24:27], v100 offset:9216
    ds_read_b128 v[28:31], v100 offset:10240
    v_mfma_f32_16x16x32_bf16 v[0:3], v[36:39], v[32:35], v[0:3]
    v_mfma_f32_16x16x32_bf16 v[4:7], v[40:43], v[32:35], v[4:7]
    v_mfma_f32_16x16x32_bf16 v[8:11], v[44:47], v[32:35], v[8:11]
    s_add_u32 m0, s29, 61440
    s_nop 0
    buffer_load_dwordx4 v100, s[4:7], s24 offen sc1 lds
    s_add_u32 s24, s24, 2048
    s_add_u32 m0, s29, 69632
    s_nop 0
    buffer_load_dwordx4 v100, s[8:11], s25 offen sc1 lds
    s_add_u32 s25, s25, 10240
    s_waitcnt lgkmcnt(0)
    ds_read_b128 v[32:35], v96 offset:4096
    ds_read_b128 v[36:39], v100 offset:13312
    ds_read_b128 v[40:43], v100 offset:14336
    ds_read_b128 v[44:47], v100 offset:15360
    v_mfma_f32_16x16x32_bf16 v[0:3], v[20:23], v[16:19], v[0:3]
    v_mfma_f32_16x16x32_bf16 v[4:7], v[24:27], v[16:19], v[4:7]
    v_mfma_f32_16x16x32_bf16 v[8:11], v[28:31], v[16:19], v[8:11]
    s_waitcnt lgkmcnt(0)
    s_waitcnt vmcnt(4)
    s_barrier
    ds_read_b128 v[16:19], v96 offset:20480
    ds_read_b128 v[20:23], v100 offset:28672
    ds_read_b128 v[24:27], v100 offset:29696
    ds_read_b128 v[28:31], v100 offset:30720
    v_mfma_f32_16x16x32_bf16 v[0:3], v[36:39], v[32:35], v[0:3]
    v_mfma_f32_16x16x32_bf16 v[4:7], v[40:43], v[32:35], v[4:7]
    v_mfma_f32_16x16x32_bf16 v[8:11], v[44:47], v[32:35], v[8:11]
    s_add_u32 m0, s29, 0
    s_nop 0
    buffer_load_dwordx4 v100, s[4:7], s24 offen sc1 lds
    s_add_u32 s24, s24, 2048
    s_add_u32 m0, s29, 8192
    s_nop 0
    buffer_load_dwordx4 v100, s[8:11], s25 offen sc1 lds
    s_add_u32 s25, s25, 10240
    s_waitcnt lgkmcnt(0)
    ds_read_b128 v[32:35], v96 offset:24576
    ds_read_b128 v[36:39], v100 offset:33792
    ds_read_b128 v[40:43], v100 offset:34816
    ds_read_b128 v[44:47], v100 offset:35840
    v_mfma_f32_16x16x32_bf16 v[0:3], v[20:23], v[16:19], v[0:3]
    v_mfma_f32_16x16x32_bf16 v[4:7], v[24:27], v[16:19], v[4:7]
    v_mfma_f32_16x16x32_bf16 v[8:11], v[28:31], v[16:19], v[8:11]
    s_waitcnt lgkmcnt(0)
    s_waitcnt vmcnt(4)
    s_barrier
    ds_read_b128 v[16:19], v97 offset:0
    ds_read_b128 v[20:23], v99 offset:8192
    ds_read_b128 v[24:27], v99 offset:9216
    ds_read_b128 v[28:31], v99 offset:10240
    v_mfma_f32_16x16x32_bf16 v[0:3], v[36:39], v[32:35], v[0:3]
    v_mfma_f32_16x16x32_bf16 v[4:7], v[40:43], v[32:35], v[4:7]
    v_mfma_f32_16x16x32_bf16 v[8:11], v[44:47], v[32:35], v[8:11]
    s_add_u32 m0, s29, 20480
    s_nop 0
    buffer_load_dwordx4 v100, s[4:7], s24 offen sc1 lds
    s_add_u32 s24, s24, 2048
    s_add_u32 m0, s29, 28672
    s_nop 0
    buffer_load_dwordx4 v100, s[8:11], s25 offen sc1 lds
    s_add_u32 s25, s25, 10240
    s_waitcnt lgkmcnt(0)
    ds_read_b128 v[32:35], v97 offset:4096
    ds_read_b128 v[36:39], v99 offset:13312
    ds_read_b128 v[40:43], v99 offset:14336
    ds_read_b128 v[44:47], v99 offset:15360
    v_mfma_f32_16x16x32_bf16 v[0:3], v[20:23], v[16:19], v[0:3]
    v_mfma_f32_16x16x32_bf16 v[4:7], v[24:27], v[16:19], v[4:7]
    v_mfma_f32_16x16x32_bf16 v[8:11], v[28:31], v[16:19], v[8:11]
    s_waitcnt lgkmcnt(0)
    s_waitcnt vmcnt(4)
    s_barrier
    ds_read_b128 v[16:19], v97 offset:20480
    ds_read_b128 v[20:23], v99 offset:28672
    ds_read_b128 v[24:27], v99 offset:29696
    ds_read_b128 v[28:31], v99 offset:30720
    v_mfma_f32_16x16x32_bf16 v[0:3], v[36:39], v[32:35], v[0:3]
    v_mfma_f32_16x16x32_bf16 v[4:7], v[40:43], v[32:35], v[4:7]
    v_mfma_f32_16x16x32_bf16 v[8:11], v[44:47], v[32:35], v[8:11]
    s_add_u32 m0, s29, 40960
    s_nop 0
    buffer_load_dwordx4 v100, s[4:7], s24 offen sc1 lds
    s_add_u32 s24, s24, 2048
    s_add_u32 m0, s29, 49152
    s_nop 0
    buffer_load_dwordx4 v100, s[8:11], s25 offen sc1 lds
    s_add_u32 s25, s25, 10240
    s_waitcnt lgkmcnt(0)
    ds_read_b128 v[32:35], v97 offset:24576
    ds_read_b128 v[36:39], v99 offset:33792
    ds_read_b128 v[40:43], v99 offset:34816
    ds_read_b128 v[44:47], v99 offset:35840
    v_mfma_f32_16x16x32_bf16 v[0:3], v[20:23], v[16:19], v[0:3]
    v_mfma_f32_16x16x32_bf16 v[4:7], v[24:27], v[16:19], v[4:7]
    v_mfma_f32_16x16x32_bf16 v[8:11], v[28:31], v[16:19], v[8:11]
    s_waitcnt lgkmcnt(0)
    s_waitcnt vmcnt(4)
    s_barrier
    ds_read_b128 v[16:19], v96 offset:0
    ds_read_b128 v[20:23], v100 offset:8192
    ds_read_b128 v[24:27], v100 offset:9216
    ds_read_b128 v[28:31], v100 offset:10240
    v_mfma_f32_16x16x32_bf16 v[0:3], v[36:39], v[32:35], v[0:3]
    v_mfma_f32_16x16x32_bf16 v[4:7], v[40:43], v[32:35], v[4:7]
    v_mfma_f32_16x16x32_bf16 v[8:11], v[44:47], v[32:35], v[8:11]
    s_add_u32 m0, s29, 61440
    s_nop 0
    buffer_load_dwordx4 v100, s[4:7], s24 offen sc1 lds
    s_add_u32 s24, s24, 2048
    s_add_u32 m0, s29, 69632
    s_nop 0
    buffer_load_dwordx4 v100, s[8:11], s25 offen sc1 lds
    s_add_u32 s25, s25, 10240
    s_waitcnt lgkmcnt(0)
    ds_read_b128 v[32:35], v96 offset:4096
    ds_read_b128 v[36:39], v100 offset:13312
    ds_read_b128 v[40:43], v100 offset:14336
    ds_read_b128 v[44:47], v100 offset:15360
    v_mfma_f32_16x16x32_bf16 v[0:3], v[20:23], v[16:19], v[0:3]
    v_mfma_f32_16x16x32_bf16 v[4:7], v[24:27], v[16:19], v[4:7]
    v_mfma_f32_16x16x32_bf16 v[8:11], v[28:31], v[16:19], v[8:11]
    s_waitcnt lgkmcnt(0)
    s_waitcnt vmcnt(4)
    s_barrier
    ds_read_b128 v[16:19], v96 offset:20480
    ds_read_b128 v[20:23], v100 offset:28672
    ds_read_b128 v[24:27], v100 offset:29696
    ds_read_b128 v[28:31], v100 offset:30720
    v_mfma_f32_16x16x32_bf16 v[0:3], v[36:39], v[32:35], v[0:3]
    v_mfma_f32_16x16x32_bf16 v[4:7], v[40:43], v[32:35], v[4:7]
    v_mfma_f32_16x16x32_bf16 v[8:11], v[44:47], v[32:35], v[8:11]
    s_add_u32 m0, s29, 0
    s_nop 0
    buffer_load_dwordx4 v100, s[4:7], s24 offen sc1 lds
    s_add_u32 s24, s24, 2048
    s_add_u32 m0, s29, 8192
    s_nop 0
    buffer_load_dwordx4 v100, s[8:11], s25 offen sc1 lds
    s_add_u32 s25, s25, 10240
    s_waitcnt lgkmcnt(0)
    ds_read_b128 v[32:35], v96 offset:24576
    ds_read_b128 v[36:39], v100 offset:33792
    ds_read_b128 v[40:43], v100 offset:34816
    ds_read_b128 v[44:47], v100 offset:35840
    v_mfma_f32_16x16x32_bf16 v[0:3], v[20:23], v[16:19], v[0:3]
    v_mfma_f32_16x16x32_bf16 v[4:7], v[24:27], v[16:19], v[4:7]
    v_mfma_f32_16x16x32_bf16 v[8:11], v[28:31], v[16:19], v[8:11]
    s_waitcnt lgkmcnt(0)
    s_waitcnt vmcnt(4)
    s_barrier
    ds_read_b128 v[16:19], v97 offset:0
    ds_read_b128 v[20:23], v99 offset:8192
    ds_read_b128 v[24:27], v99 offset:9216
    ds_read_b128 v[28:31], v99 offset:10240
    v_mfma_f32_16x16x32_bf16 v[0:3], v[36:39], v[32:35], v[0:3]
    v_mfma_f32_16x16x32_bf16 v[4:7], v[40:43], v[32:35], v[4:7]
    v_mfma_f32_16x16x32_bf16 v[8:11], v[44:47], v[32:35], v[8:11]
    s_add_u32 m0, s29, 20480
    s_nop 0
    buffer_load_dwordx4 v100, s[4:7], s24 offen sc1 lds
    s_add_u32 s24, s24, 2048
    s_add_u32 m0, s29, 28672
    s_nop 0
    buffer_load_dwordx4 v100, s[8:11], s25 offen sc1 lds
    s_add_u32 s25, s25, 10240
    s_waitcnt lgkmcnt(0)
    ds_read_b128 v[32:35], v97 offset:4096
    ds_read_b128 v[36:39], v99 offset:13312
    ds_read_b128 v[40:43], v99 offset:14336
    ds_read_b128 v[44:47], v99 offset:15360
    v_mfma_f32_16x16x32_bf16 v[0:3], v[20:23], v[16:19], v[0:3]
    v_mfma_f32_16x16x32_bf16 v[4:7], v[24:27], v[16:19], v[4:7]
    v_mfma_f32_16x16x32_bf16 v[8:11], v[28:31], v[16:19], v[8:11]
    s_waitcnt lgkmcnt(0)
    s_waitcnt vmcnt(4)
    s_barrier
    ds_read_b128 v[16:19], v97 offset:20480
    ds_read_b128 v[20:23], v99 offset:28672
    ds_read_b128 v[24:27], v99 offset:29696
    ds_read_b128 v[28:31], v99 offset:30720
    v_mfma_f32_16x16x32_bf16 v[0:3], v[36:39], v[32:35], v[0:3]
    v_mfma_f32_16x16x32_bf16 v[4:7], v[40:43], v[32:35], v[4:7]
    v_mfma_f32_16x16x32_bf16 v[8:11], v[44:47], v[32:35], v[8:11]
    s_add_u32 m0, s29, 40960
    s_nop 0
    buffer_load_dwordx4 v100, s[4:7], s24 offen sc1 lds
    s_add_u32 s24, s24, 2048
    s_add_u32 m0, s29, 49152
    s_nop 0
    buffer_load_dwordx4 v100, s[8:11], s25 offen sc1 lds
    s_add_u32 s25, s25, 10240
    s_waitcnt lgkmcnt(0)
    ds_read_b128 v[32:35], v97 offset:24576
    ds_read_b128 v[36:39], v99 offset:33792
    ds_read_b128 v[40:43], v99 offset:34816
    ds_read_b128 v[44:47], v99 offset:35840
    v_mfma_f32_16x16x32_bf16 v[0:3], v[20:23], v[16:19], v[0:3]
    v_mfma_f32_16x16x32_bf16 v[4:7], v[24:27], v[16:19], v[4:7]
    v_mfma_f32_16x16x32_bf16 v[8:11], v[28:31], v[16:19], v[8:11]
    s_waitcnt lgkmcnt(0)
    s_waitcnt vmcnt(4)
    s_barrier
    ds_read_b128 v[16:19], v96 offset:0
    ds_read_b128 v[20:23], v100 offset:8192
    ds_read_b128 v[24:27], v100 offset:9216
    ds_read_b128 v[28:31], v100 offset:10240
    v_mfma_f32_16x16x32_bf16 v[0:3], v[36:39], v[32:35], v[0:3]
    v_mfma_f32_16x16x32_bf16 v[4:7], v[40:43], v[32:35], v[4:7]
    v_mfma_f32_16x16x32_bf16 v[8:11], v[44:47], v[32:35], v[8:11]
    s_add_u32 m0, s29, 61440
    s_nop 0
    buffer_load_dwordx4 v100, s[4:7], s24 offen sc1 lds
    s_add_u32 s24, s24, 2048
    s_add_u32 m0, s29, 69632
    s_nop 0
    buffer_load_dwordx4 v100, s[8:11], s25 offen sc1 lds
    s_add_u32 s25, s25, 10240
    s_waitcnt lgkmcnt(0)
    ds_read_b128 v[32:35], v96 offset:4096
    ds_read_b128 v[36:39], v100 offset:13312
    ds_read_b128 v[40:43], v100 offset:14336
    ds_read_b128 v[44:47], v100 offset:15360
    v_mfma_f32_16x16x32_bf16 v[0:3], v[20:23], v[16:19], v[0:3]
    v_mfma_f32_16x16x32_bf16 v[4:7], v[24:27], v[16:19], v[4:7]
    v_mfma_f32_16x16x32_bf16 v[8:11], v[28:31], v[16:19], v[8:11]
    s_waitcnt lgkmcnt(0)
    s_waitcnt vmcnt(4)
    s_barrier
    ds_read_b128 v[16:19], v96 offset:20480
    ds_read_b128 v[20:23], v100 offset:28672
    ds_read_b128 v[24:27], v100 offset:29696
    ds_read_b128 v[28:31], v100 offset:30720
    v_mfma_f32_16x16x32_bf16 v[0:3], v[36:39], v[32:35], v[0:3]
    v_mfma_f32_16x16x32_bf16 v[4:7], v[40:43], v[32:35], v[4:7]
    v_mfma_f32_16x16x32_bf16 v[8:11], v[44:47], v[32:35], v[8:11]
    s_add_u32 m0, s29, 0
    s_nop 0
    buffer_load_dwordx4 v100, s[4:7], s24 offen sc1 lds
    s_add_u32 s24, s24, 2048
    s_add_u32 m0, s29, 8192
    s_nop 0
    buffer_load_dwordx4 v100, s[8:11], s25 offen sc1 lds
    s_add_u32 s25, s25, 10240
    s_waitcnt lgkmcnt(0)
    ds_read_b128 v[32:35], v96 offset:24576
    ds_read_b128 v[36:39], v100 offset:33792
    ds_read_b128 v[40:43], v100 offset:34816
    ds_read_b128 v[44:47], v100 offset:35840
    v_mfma_f32_16x16x32_bf16 v[0:3], v[20:23], v[16:19], v[0:3]
    v_mfma_f32_16x16x32_bf16 v[4:7], v[24:27], v[16:19], v[4:7]
    v_mfma_f32_16x16x32_bf16 v[8:11], v[28:31], v[16:19], v[8:11]
    s_waitcnt lgkmcnt(0)
    s_waitcnt vmcnt(4)
    s_barrier
    ds_read_b128 v[16:19], v97 offset:0
    ds_read_b128 v[20:23], v99 offset:8192
    ds_read_b128 v[24:27], v99 offset:9216
    ds_read_b128 v[28:31], v99 offset:10240
    v_mfma_f32_16x16x32_bf16 v[0:3], v[36:39], v[32:35], v[0:3]
    v_mfma_f32_16x16x32_bf16 v[4:7], v[40:43], v[32:35], v[4:7]
    v_mfma_f32_16x16x32_bf16 v[8:11], v[44:47], v[32:35], v[8:11]
    s_add_u32 m0, s29, 20480
    s_nop 0
    buffer_load_dwordx4 v100, s[4:7], s24 offen sc1 lds
    s_add_u32 s24, s24, 2048
    s_add_u32 m0, s29, 28672
    s_nop 0
    buffer_load_dwordx4 v100, s[8:11], s25 offen sc1 lds
    s_add_u32 s25, s25, 10240
    s_waitcnt lgkmcnt(0)
    ds_read_b128 v[32:35], v97 offset:4096
    ds_read_b128 v[36:39], v99 offset:13312
    ds_read_b128 v[40:43], v99 offset:14336
    ds_read_b128 v[44:47], v99 offset:15360
    v_mfma_f32_16x16x32_bf16 v[0:3], v[20:23], v[16:19], v[0:3]
    v_mfma_f32_16x16x32_bf16 v[4:7], v[24:27], v[16:19], v[4:7]
    v_mfma_f32_16x16x32_bf16 v[8:11], v[28:31], v[16:19], v[8:11]
    s_waitcnt lgkmcnt(0)
    s_waitcnt vmcnt(4)
    s_barrier
    ds_read_b128 v[16:19], v97 offset:20480
    ds_read_b128 v[20:23], v99 offset:28672
    ds_read_b128 v[24:27], v99 offset:29696
    ds_read_b128 v[28:31], v99 offset:30720
    v_mfma_f32_16x16x32_bf16 v[0:3], v[36:39], v[32:35], v[0:3]
    v_mfma_f32_16x16x32_bf16 v[4:7], v[40:43], v[32:35], v[4:7]
    v_mfma_f32_16x16x32_bf16 v[8:11], v[44:47], v[32:35], v[8:11]
    s_add_u32 m0, s29, 40960
    s_nop 0
    buffer_load_dwordx4 v100, s[4:7], s24 offen sc1 lds
    s_add_u32 s24, s24, 2048
    s_add_u32 m0, s29, 49152
    s_nop 0
    buffer_load_dwordx4 v100, s[8:11], s25 offen sc1 lds
    s_add_u32 s25, s25, 10240
    s_waitcnt lgkmcnt(0)
    ds_read_b128 v[32:35], v97 offset:24576
    ds_read_b128 v[36:39], v99 offset:33792
    ds_read_b128 v[40:43], v99 offset:34816
    ds_read_b128 v[44:47], v99 offset:35840
    v_mfma_f32_16x16x32_bf16 v[0:3], v[20:23], v[16:19], v[0:3]
    v_mfma_f32_16x16x32_bf16 v[4:7], v[24:27], v[16:19], v[4:7]
    v_mfma_f32_16x16x32_bf16 v[8:11], v[28:31], v[16:19], v[8:11]
    s_waitcnt lgkmcnt(0)
    s_waitcnt vmcnt(4)
    s_barrier
    ds_read_b128 v[16:19], v96 offset:0
    ds_read_b128 v[20:23], v100 offset:8192
    ds_read_b128 v[24:27], v100 offset:9216
    ds_read_b128 v[28:31], v100 offset:10240
    v_mfma_f32_16x16x32_bf16 v[0:3], v[36:39], v[32:35], v[0:3]
    v_mfma_f32_16x16x32_bf16 v[4:7], v[40:43], v[32:35], v[4:7]
    v_mfma_f32_16x16x32_bf16 v[8:11], v[44:47], v[32:35], v[8:11]
    s_add_u32 m0, s29, 61440
    s_nop 0
    buffer_load_dwordx4 v100, s[4:7], s24 offen sc1 lds
    s_add_u32 s24, s24, 2048
    s_add_u32 m0, s29, 69632
    s_nop 0
    buffer_load_dwordx4 v100, s[8:11], s25 offen sc1 lds
    s_add_u32 s25, s25, 10240
    s_waitcnt lgkmcnt(0)
    ds_read_b128 v[32:35], v96 offset:4096
    ds_read_b128 v[36:39], v100 offset:13312
    ds_read_b128 v[40:43], v100 offset:14336
    ds_read_b128 v[44:47], v100 offset:15360
    v_mfma_f32_16x16x32_bf16 v[0:3], v[20:23], v[16:19], v[0:3]
    v_mfma_f32_16x16x32_bf16 v[4:7], v[24:27], v[16:19], v[4:7]
    v_mfma_f32_16x16x32_bf16 v[8:11], v[28:31], v[16:19], v[8:11]
    s_waitcnt lgkmcnt(0)
    s_waitcnt vmcnt(4)
    s_barrier
    ds_read_b128 v[16:19], v96 offset:20480
    ds_read_b128 v[20:23], v100 offset:28672
    ds_read_b128 v[24:27], v100 offset:29696
    ds_read_b128 v[28:31], v100 offset:30720
    v_mfma_f32_16x16x32_bf16 v[0:3], v[36:39], v[32:35], v[0:3]
    v_mfma_f32_16x16x32_bf16 v[4:7], v[40:43], v[32:35], v[4:7]
    v_mfma_f32_16x16x32_bf16 v[8:11], v[44:47], v[32:35], v[8:11]
    s_add_u32 m0, s29, 0
    s_add_u32 s30, s48, 0
    buffer_load_dwordx4 v100, s[8:11], s30 offen sc1 lds
    s_add_u32 m0, s29, 8192
    s_add_u32 s30, s48, 8192
    buffer_load_dwordx4 v100, s[8:11], s30 offen sc1 lds
    s_add_u32 m0, s29, 16384
    s_add_u32 s30, s48, 16384
    buffer_load_dwordx4 v100, s[8:11], s30 offen sc1 lds
    s_waitcnt lgkmcnt(0)
    ds_read_b128 v[32:35], v96 offset:24576
    ds_read_b128 v[36:39], v100 offset:33792
    ds_read_b128 v[40:43], v100 offset:34816
    ds_read_b128 v[44:47], v100 offset:35840
    v_mfma_f32_16x16x32_bf16 v[0:3], v[20:23], v[16:19], v[0:3]
    v_mfma_f32_16x16x32_bf16 v[4:7], v[24:27], v[16:19], v[4:7]
    v_mfma_f32_16x16x32_bf16 v[8:11], v[28:31], v[16:19], v[8:11]
    s_waitcnt lgkmcnt(0)
    s_waitcnt vmcnt(5)
    s_barrier
    ds_read_b128 v[16:19], v97 offset:0
    ds_read_b128 v[20:23], v99 offset:8192
    ds_read_b128 v[24:27], v99 offset:9216
    ds_read_b128 v[28:31], v99 offset:10240
    v_mfma_f32_16x16x32_bf16 v[0:3], v[36:39], v[32:35], v[0:3]
    v_mfma_f32_16x16x32_bf16 v[4:7], v[40:43], v[32:35], v[4:7]
    v_mfma_f32_16x16x32_bf16 v[8:11], v[44:47], v[32:35], v[8:11]
    s_add_u32 m0, s29, 20480
    s_add_u32 s30, s48, 20480
    buffer_load_dwordx4 v100, s[8:11], s30 offen sc1 lds
    s_add_u32 m0, s29, 28672
    s_add_u32 s30, s48, 28672
    buffer_load_dwordx4 v100, s[8:11], s30 offen sc1 lds
    s_add_u32 m0, s29, 36864
    s_add_u32 s30, s48, 36864
    buffer_load_dwordx4 v100, s[8:11], s30 offen sc1 lds
    s_waitcnt lgkmcnt(0)
    ds_read_b128 v[32:35], v97 offset:4096
    ds_read_b128 v[36:39], v99 offset:13312
    ds_read_b128 v[40:43], v99 offset:14336
    ds_read_b128 v[44:47], v99 offset:15360
    v_mfma_f32_16x16x32_bf16 v[0:3], v[20:23], v[16:19], v[0:3]
    v_mfma_f32_16x16x32_bf16 v[4:7], v[24:27], v[16:19], v[4:7]
    v_mfma_f32_16x16x32_bf16 v[8:11], v[28:31], v[16:19], v[8:11]
    s_waitcnt lgkmcnt(0)
    s_waitcnt vmcnt(6)
    s_barrier
    ds_read_b128 v[16:19], v97 offset:20480
    ds_read_b128 v[20:23], v99 offset:28672
    ds_read_b128 v[24:27], v99 offset:29696
    ds_read_b128 v[28:31], v99 offset:30720
    v_mfma_f32_16x16x32_bf16 v[0:3], v[36:39], v[32:35], v[0:3]
    v_mfma_f32_16x16x32_bf16 v[4:7], v[40:43], v[32:35], v[4:7]
    v_mfma_f32_16x16x32_bf16 v[8:11], v[44:47], v[32:35], v[8:11]
    s_add_u32 m0, s29, 40960
    s_add_u32 s30, s48, 40960
    buffer_load_dwordx4 v100, s[8:11], s30 offen sc1 lds
    s_add_u32 m0, s29, 49152
    s_add_u32 s30, s48, 49152
    buffer_load_dwordx4 v100, s[8:11], s30 offen sc1 lds
    s_add_u32 m0, s29, 57344
    s_add_u32 s30, s48, 57344
    buffer_load_dwordx4 v100, s[8:11], s30 offen sc1 lds
    s_waitcnt lgkmcnt(0)
    ds_read_b128 v[32:35], v97 offset:24576
    ds_read_b128 v[36:39], v99 offset:33792
    ds_read_b128 v[40:43], v99 offset:34816
    ds_read_b128 v[44:47], v99 offset:35840
    v_mfma_f32_16x16x32_bf16 v[0:3], v[20:23], v[16:19], v[0:3]
    v_mfma_f32_16x16x32_bf16 v[4:7], v[24:27], v[16:19], v[4:7]
    v_mfma_f32_16x16x32_bf16 v[8:11], v[28:31], v[16:19], v[8:11]
    s_waitcnt lgkmcnt(0)
    v_mfma_f32_16x16x32_bf16 v[0:3], v[36:39], v[32:35], v[0:3]
    v_mfma_f32_16x16x32_bf16 v[4:7], v[40:43], v[32:35], v[4:7]
    v_mfma_f32_16x16x32_bf16 v[8:11], v[44:47], v[32:35], v[8:11]
    s_barrier
    s_add_u32 m0, s29, 61440
    s_add_u32 s30, s48, 61440
    buffer_load_dwordx4 v100, s[8:11], s30 offen sc1 lds
    s_add_u32 m0, s29, 69632
    s_add_u32 s30, s48, 69632
    buffer_load_dwordx4 v100, s[8:11], s30 offen sc1 lds
    s_add_u32 m0, s29, 77824
    s_add_u32 s30, s48, 77824
    buffer_load_dwordx4 v100, s[8:11], s30 offen sc1 lds
    s_lshl_b32 s24, s21, 2
    s_add_u32 s24, s24, s27
    s_mul_i32 s24, s24, 69632
    s_add_u32 s50, s24, 16384
    s_add_u32 s51, s24, 0
    s_add_u32 s52, s51, 4096
    v_add_u32 v96, 0, v100
    s_mul_i32 s30, s20, 3072
    v_add_u32 v97, s30, v100
    s_xor_b32 s30, s20, 4
    s_mul_i32 s30, s30, 3072
    v_add_u32 v99, s30, v100
    s_cmp_lg_u32 s20, 0
    s_cbranch_scc1 L_o_nopoll
    s_lshr_b32 s41, s21, 2
    s_lshl_b32 s41, s41, 1
    s_and_b32 s30, s22, 1
    s_add_u32 s41, s41, s30
    s_add_u32 s41, s41, 80
    s_lshl_b32 s30, s41, 7
    v_mov_b32 v66, s30
    s_mov_b32 s55, 262144
    s_mov_b64 exec, 1
L_poll_o:
    buffer_load_dword v67, v66, s[44:47], 0 offen sc1
    s_waitcnt vmcnt(0)
    v_cmp_ne_u32 vcc, 1, v67
    s_cbranch_vccz L_got_o
    s_sleep 8
    s_sub_u32 s55, s55, 1
    s_cbranch_scc0 L_poll_o
L_got_o:
    s_mov_b64 exec, -1
L_o_nopoll:
    s_waitcnt vmcnt(0)
    s_barrier
    buffer_load_dwordx4 v[20:23], v100, s[4:7], s50 offen offset:0 sc1
    buffer_load_dwordx4 v[24:27], v100, s[4:7], s50 offen offset:1024 sc1
    buffer_load_dwordx4 v[28:31], v100, s[4:7], s51 offen offset:0 sc1
    buffer_load_dwordx4 v[32:35], v100, s[4:7], s51 offen offset:1024 sc1
    buffer_load_dwordx4 v[36:39], v100, s[4:7], s51 offen offset:2048 sc1
    buffer_load_dwordx4 v[40:43], v100, s[4:7], s51 offen offset:3072 sc1
    buffer_load_dwordx4 v[44:47], v100, s[4:7], s52 offen offset:0 sc1
    buffer_load_dwordx4 v[48:51], v100, s[4:7], s52 offen offset:1024 sc1
    buffer_load_dwordx4 v[52:55], v100, s[4:7], s52 offen offset:2048 sc1
    buffer_load_dwordx4 v[56:59], v100, s[4:7], s52 offen offset:3072 sc1
    s_waitcnt vmcnt(9)
    v_mfma_f32_16x16x32_bf16 v[0:3], v[68:71], v[20:23], v[0:3]
    v_mfma_f32_16x16x32_bf16 v[4:7], v[72:75], v[20:23], v[4:7]
    v_mfma_f32_16x16x32_bf16 v[8:11], v[76:79], v[20:23], v[8:11]
    v_mfma_f32_16x16x32_bf16 v[12:15], v[80:83], v[20:23], 0
    v_mfma_f32_16x16x32_bf16 v[16:19], v[84:87], v[20:23], 0
    ds_read_b128 v[68:71], v96 offset:0
    ds_read_b128 v[72:75], v96 offset:1024
    ds_read_b128 v[76:79], v96 offset:2048
    ds_read_b128 v[80:83], v96 offset:3072
    ds_read_b128 v[84:87], v96 offset:4096
    s_waitcnt vmcnt(8)
    v_mfma_f32_16x16x32_bf16 v[0:3], v[104:107], v[24:27], v[0:3]
    v_mfma_f32_16x16x32_bf16 v[4:7], v[108:111], v[24:27], v[4:7]
    v_mfma_f32_16x16x32_bf16 v[8:11], v[112:115], v[24:27], v[8:11]
    v_mfma_f32_16x16x32_bf16 v[12:15], v[116:119], v[24:27], v[12:15]
    v_mfma_f32_16x16x32_bf16 v[16:19], v[120:123], v[24:27], v[16:19]
    ds_read_b128 v[104:107], v96 offset:5120
    ds_read_b128 v[108:111], v96 offset:6144
    ds_read_b128 v[112:115], v96 offset:7168
    ds_read_b128 v[116:119], v96 offset:8192
    ds_read_b128 v[120:123], v96 offset:9216
    s_waitcnt vmcnt(7) lgkmcnt(5)
    v_mfma_f32_16x16x32_bf16 v[0:3], v[68:71], v[28:31], v[0:3]
    v_mfma_f32_16x16x32_bf16 v[4:7], v[72:75], v[28:31], v[4:7]
    v_mfma_f32_16x16x32_bf16 v[8:11], v[76:79], v[28:31], v[8:11]
    v_mfma_f32_16x16x32_bf16 v[12:15], v[80:83], v[28:31], v[12:15]
    v_mfma_f32_16x16x32_bf16 v[16:19], v[84:87], v[28:31], v[16:19]
    ds_read_b128 v[68:71], v96 offset:10240
    ds_read_b128 v[72:75], v96 offset:11264
    ds_read_b128 v[76:79], v96 offset:12288
    ds_read_b128 v[80:83], v96 offset:13312
    ds_read_b128 v[84:87], v96 offset:14336
    s_waitcnt vmcnt(6) lgkmcnt(5)
    v_mfma_f32_16x16x32_bf16 v[0:3], v[104:107], v[32:35], v[0:3]
    v_mfma_f32_16x16x32_bf16 v[4:7], v[108:111], v[32:35], v[4:7]
    v_mfma_f32_16x16x32_bf16 v[8:11], v[112:115], v[32:35], v[8:11]
    v_mfma_f32_16x16x32_bf16 v[12:15], v[116:119], v[32:35], v[12:15]
    v_mfma_f32_16x16x32_bf16 v[16:19], v[120:123], v[32:35], v[16:19]
    ds_read_b128 v[104:107], v96 offset:15360
    ds_read_b128 v[108:111], v96 offset:16384
    ds_read_b128 v[112:115], v96 offset:17408
    ds_read_b128 v[116:119], v96 offset:18432
    ds_read_b128 v[120:123], v96 offset:19456
    s_waitcnt vmcnt(5) lgkmcnt(5)
    v_mfma_f32_16x16x32_bf16 v[0:3], v[68:71], v[36:39], v[0:3]
    v_mfma_f32_16x16x32_bf16 v[4:7], v[72:75], v[36:39], v[4:7]
    v_mfma_f32_16x16x32_bf16 v[8:11], v[76:79], v[36:39], v[8:11]
    v_mfma_f32_16x16x32_bf16 v[12:15], v[80:83], v[36:39], v[12:15]
    v_mfma_f32_16x16x32_bf16 v[16:19], v[84:87], v[36:39], v[16:19]
    ds_read_b128 v[68:71], v96 offset:20480
    ds_read_b128 v[72:75], v96 offset:21504
    ds_read_b128 v[76:79], v96 offset:22528
    ds_read_b128 v[80:83], v96 offset:23552
    ds_read_b128 v[84:87], v96 offset:24576
    s_waitcnt vmcnt(4) lgkmcnt(5)
    v_mfma_f32_16x16x32_bf16 v[0:3], v[104:107], v[40:43], v[0:3]
    v_mfma_f32_16x16x32_bf16 v[4:7], v[108:111], v[40:43], v[4:7]
    v_mfma_f32_16x16x32_bf16 v[8:11], v[112:115], v[40:43], v[8:11]
    v_mfma_f32_16x16x32_bf16 v[12:15], v[116:119], v[40:43], v[12:15]
    v_mfma_f32_16x16x32_bf16 v[16:19], v[120:123], v[40:43], v[16:19]
    ds_read_b128 v[104:107], v96 offset:25600
    ds_read_b128 v[108:111], v96 offset:26624
    ds_read_b128 v[112:115], v96 offset:27648
    ds_read_b128 v[116:119], v96 offset:28672
    ds_read_b128 v[120:123], v96 offset:29696
    s_waitcnt vmcnt(3) lgkmcnt(5)
    v_mfma_f32_16x16x32_bf16 v[0:3], v[68:71], v[44:47], v[0:3]
    v_mfma_f32_16x16x32_bf16 v[4:7], v[72:75], v[44:47], v[4:7]
    v_mfma_f32_16x16x32_bf16 v[8:11], v[76:79], v[44:47], v[8:11]
    v_mfma_f32_16x16x32_bf16 v[12:15], v[80:83], v[44:47], v[12:15]
    v_mfma_f32_16x16x32_bf16 v[16:19], v[84:87], v[44:47], v[16:19]
    ds_read_b128 v[68:71], v96 offset:30720
    ds_read_b128 v[72:75], v96 offset:31744
    ds_read_b128 v[76:79], v96 offset:32768
    ds_read_b128 v[80:83], v96 offset:33792
    ds_read_b128 v[84:87], v96 offset:34816
    s_waitcnt vmcnt(2) lgkmcnt(5)
    v_mfma_f32_16x16x32_bf16 v[0:3], v[104:107], v[48:51], v[0:3]
    v_mfma_f32_16x16x32_bf16 v[4:7], v[108:111], v[48:51], v[4:7]
    v_mfma_f32_16x16x32_bf16 v[8:11], v[112:115], v[48:51], v[8:11]
    v_mfma_f32_16x16x32_bf16 v[12:15], v[116:119], v[48:51], v[12:15]
    v_mfma_f32_16x16x32_bf16 v[16:19], v[120:123], v[48:51], v[16:19]
    ds_read_b128 v[104:107], v96 offset:35840
    ds_read_b128 v[108:111], v96 offset:36864
    ds_read_b128 v[112:115], v96 offset:37888
    ds_read_b128 v[116:119], v96 offset:38912
    ds_read_b128 v[120:123], v96 offset:39936
    s_waitcnt vmcnt(1) lgkmcnt(5)
    v_mfma_f32_16x16x32_bf16 v[0:3], v[68:71], v[52:55], v[0:3]
    v_mfma_f32_16x16x32_bf16 v[4:7], v[72:75], v[52:55], v[4:7]
    v_mfma_f32_16x16x32_bf16 v[8:11], v[76:79], v[52:55], v[8:11]
    v_mfma_f32_16x16x32_bf16 v[12:15], v[80:83], v[52:55], v[12:15]
    v_mfma_f32_16x16x32_bf16 v[16:19], v[84:87], v[52:55], v[16:19]
    s_waitcnt vmcnt(0) lgkmcnt(0)
    v_mfma_f32_16x16x32_bf16 v[0:3], v[104:107], v[56:59], v[0:3]
    v_mfma_f32_16x16x32_bf16 v[4:7], v[108:111], v[56:59], v[4:7]
    v_mfma_f32_16x16x32_bf16 v[8:11], v[112:115], v[56:59], v[8:11]
    v_mfma_f32_16x16x32_bf16 v[12:15], v[116:119], v[56:59], v[12:15]
    v_mfma_f32_16x16x32_bf16 v[16:19], v[120:123], v[56:59], v[16:19]
    s_barrier
    s_nop 6
    ds_write_b128 v97, v[12:15] offset:0
    ds_write_b128 v97, v[16:19] offset:1024
    s_waitcnt lgkmcnt(0)
    s_barrier
    ds_read_b128 v[20:23], v99 offset:0
    ds_read_b128 v[24:27], v99 offset:1024
    ds_read_b128 v[28:31], v99 offset:2048
    v_mov_b64 v[48:49], v[60:61]
    v_mov_b64 v[50:51], v[62:63]
    v_mov_b64 v[52:53], v[64:65]
    s_waitcnt lgkmcnt(0)
    v_pk_add_f32 v[0:1], v[0:1], v[20:21]
    v_pk_add_f32 v[2:3], v[2:3], v[22:23]
    v_pk_add_f32 v[4:5], v[4:5], v[24:25]
    v_pk_add_f32 v[6:7], v[6:7], v[26:27]
    v_pk_add_f32 v[8:9], v[8:9], v[28:29]
    v_pk_add_f32 v[10:11], v[10:11], v[30:31]
    v_lshlrev_b32 v56, 16, v48
    v_and_b32 v57, 0xffff0000, v48
    v_lshlrev_b32 v58, 16, v49
    v_and_b32 v59, 0xffff0000, v49
    s_nop 3
    v_add_f32 v56, v0, v56
    v_add_f32 v57, v1, v57
    v_add_f32 v58, v2, v58
    v_add_f32 v59, v3, v59
    v_cvt_pk_bf16_f32 v60, v56, v57
    v_cvt_pk_bf16_f32 v61, v58, v59
    v_lshlrev_b32 v56, 16, v50
    v_and_b32 v57, 0xffff0000, v50
    v_lshlrev_b32 v58, 16, v51
    v_and_b32 v59, 0xffff0000, v51
    v_add_f32 v56, v4, v56
    v_add_f32 v57, v5, v57
    v_add_f32 v58, v6, v58
    v_add_f32 v59, v7, v59
    v_cvt_pk_bf16_f32 v62, v56, v57
    v_cvt_pk_bf16_f32 v63, v58, v59
    s_nop 1
    v_permlane16_swap_b32 v60, v62
    v_permlane16_swap_b32 v61, v63
    buffer_store_dwordx4 v[60:63], v95, s[16:19], s49 offen offset:0
    v_lshlrev_b32 v56, 16, v52
    v_and_b32 v57, 0xffff0000, v52
    v_lshlrev_b32 v58, 16, v53
    v_and_b32 v59, 0xffff0000, v53
    v_add_f32 v56, v8, v56
    v_add_f32 v57, v9, v57
    v_add_f32 v58, v10, v58
    v_add_f32 v59, v11, v59
    v_cvt_pk_bf16_f32 v64, v56, v57
    v_cvt_pk_bf16_f32 v65, v58, v59
    buffer_store_dwordx2 v[64:65], v98, s[16:19], s49 offen offset:64
    s_endpgm
L_dn_g1:
    s_mul_i32 s48, s22, 348160
    s_add_u32 s30, s48, 92160
    s_add_u32 s48, s48, s29
    s_add_u32 s41, s30, 3072
    buffer_load_dwordx4 v[68:71], v100, s[8:11], s41 offen sc1
    s_add_u32 s41, s30, 4096
    buffer_load_dwordx4 v[72:75], v100, s[8:11], s41 offen sc1
    s_add_u32 s41, s30, 0
    buffer_load_dwordx4 v[76:79], v100, s[8:11], s41 offen sc1
    s_add_u32 s41, s30, 1024
    buffer_load_dwordx4 v[80:83], v100, s[8:11], s41 offen sc1
    s_add_u32 s41, s30, 2048
    buffer_load_dwordx4 v[84:87], v100, s[8:11], s41 offen sc1
    s_add_u32 s41, s30, 8192
    buffer_load_dwordx4 v[104:107], v100, s[8:11], s41 offen sc1
    s_add_u32 s41, s30, 9216
    buffer_load_dwordx4 v[108:111], v100, s[8:11], s41 offen sc1
    s_add_u32 s41, s30, 5120
    buffer_load_dwordx4 v[112:115], v100, s[8:11], s41 offen sc1
    s_add_u32 s41, s30, 6144
    buffer_load_dwordx4 v[116:119], v100, s[8:11], s41 offen sc1
    s_add_u32 s41, s30, 7168
    buffer_load_dwordx4 v[120:123], v100, s[8:11], s41 offen sc1
    buffer_load_dwordx2 v[60:61], v98, s[12:15], s49 offen offset:96
    buffer_load_dwordx2 v[62:63], v98, s[12:15], s49 offen offset:128
    s_add_u32 m0, s29, 0
    s_nop 0
    buffer_load_dwordx4 v100, s[4:7], s24 offen sc1 lds
    s_add_u32 s24, s24, 2048
    s_add_u32 m0, s29, 8192
    s_nop 0
    buffer_load_dwordx4 v100, s[8:11], s25 offen sc1 lds
    s_add_u32 m0, s29, 12288
    s_add_u32 s30, s25, s26
    buffer_load_dwordx4 v100, s[8:11], s30 offen sc1 lds
    s_add_u32 s25, s25, 10240
    s_add_u32 m0, s29, 20480
    s_nop 0
    buffer_load_dwordx4 v100, s[4:7], s24 offen sc1 lds
    s_add_u32 s24, s24, 2048
    s_add_u32 m0, s29, 28672
    s_nop 0
    buffer_load_dwordx4 v100, s[8:11], s25 offen sc1 lds
    s_add_u32 m0, s29, 32768
    s_add_u32 s30, s25, s26
    buffer_load_dwordx4 v100, s[8:11], s30 offen sc1 lds
    s_add_u32 s25, s25, 10240
    s_add_u32 m0, s29, 40960
    s_nop 0
    buffer_load_dwordx4 v100, s[4:7], s24 offen sc1 lds
    s_add_u32 s24, s24, 2048
    s_add_u32 m0, s29, 49152
    s_nop 0
    buffer_load_dwordx4 v100, s[8:11], s25 offen sc1 lds
    s_add_u32 m0, s29, 53248
    s_add_u32 s30, s25, s26
    buffer_load_dwordx4 v100, s[8:11], s30 offen sc1 lds
    s_add_u32 s25, s25, 10240
    s_add_u32 m0, s29, 61440
    s_nop 0
    buffer_load_dwordx4 v100, s[4:7], s24 offen sc1 lds
    s_add_u32 s24, s24, 2048
    s_add_u32 m0, s29, 69632
    s_nop 0
    buffer_load_dwordx4 v100, s[8:11], s25 offen sc1 lds
    s_add_u32 m0, s29, 73728
    s_add_u32 s30, s25, s26
    buffer_load_dwordx4 v100, s[8:11], s30 offen sc1 lds
    s_add_u32 s25, s25, 10240
    s_waitcnt vmcnt(9)
    s_barrier
    ds_read_b128 v[16:19], v96 offset:0
    ds_read_b128 v[20:23], v100 offset:11264
    ds_read_b128 v[24:27], v100 offset:12288
    s_waitcnt lgkmcnt(0)
    ds_read_b128 v[32:35], v96 offset:4096
    ds_read_b128 v[36:39], v100 offset:16384
    ds_read_b128 v[40:43], v100 offset:17408
    v_mfma_f32_16x16x32_bf16 v[0:3], v[20:23], v[16:19], 0
    v_mfma_f32_16x16x32_bf16 v[4:7], v[24:27], v[16:19], 0
    s_waitcnt lgkmcnt(0)
    s_waitcnt vmcnt(6)
    s_barrier
    ds_read_b128 v[16:19], v96 offset:20480
    ds_read_b128 v[20:23], v100 offset:31744
    ds_read_b128 v[24:27], v100 offset:32768
    v_mfma_f32_16x16x32_bf16 v[0:3], v[36:39], v[32:35], v[0:3]
    v_mfma_f32_16x16x32_bf16 v[4:7], v[40:43], v[32:35], v[4:7]
    s_add_u32 m0, s29, 0
    s_nop 0
    buffer_load_dwordx4 v100, s[4:7], s24 offen sc1 lds
    s_add_u32 s24, s24, 2048
    s_add_u32 m0, s29, 8192
    s_nop 0
    buffer_load_dwordx4 v100, s[8:11], s25 offen sc1 lds
    s_add_u32 m0, s29, 12288
    s_add_u32 s30, s25, s26
    buffer_load_dwordx4 v100, s[8:11], s30 offen sc1 lds
    s_add_u32 s25, s25, 10240
    s_waitcnt lgkmcnt(0)
    ds_read_b128 v[32:35], v96 offset:24576
    ds_read_b128 v[36:39], v100 offset:36864
    ds_read_b128 v[40:43], v100 offset:37888
    v_mfma_f32_16x16x32_bf16 v[0:3], v[20:23], v[16:19], v[0:3]
    v_mfma_f32_16x16x32_bf16 v[4:7], v[24:27], v[16:19], v[4:7]
    s_waitcnt lgkmcnt(0)
    s_waitcnt vmcnt(6)
    s_barrier
    ds_read_b128 v[16:19], v97 offset:0
    ds_read_b128 v[20:23], v99 offset:11264
    ds_read_b128 v[24:27], v99 offset:12288
    v_mfma_f32_16x16x32_bf16 v[0:3], v[36:39], v[32:35], v[0:3]
    v_mfma_f32_16x16x32_bf16 v[4:7], v[40:43], v[32:35], v[4:7]
    s_add_u32 m0, s29, 20480
    s_nop 0
    buffer_load_dwordx4 v100, s[4:7], s24 offen sc1 lds
    s_add_u32 s24, s24, 2048
    s_add_u32 m0, s29, 28672
    s_nop 0
    buffer_load_dwordx4 v100, s[8:11], s25 offen sc1 lds
    s_add_u32 m0, s29, 32768
    s_add_u32 s30, s25, s26
    buffer_load_dwordx4 v100, s[8:11], s30 offen sc1 lds
    s_add_u32 s25, s25, 10240
    s_waitcnt lgkmcnt(0)
    ds_read_b128 v[32:35], v97 offset:4096
    ds_read_b128 v[36:39], v99 offset:16384
    ds_read_b128 v[40:43], v99 offset:17408
    v_mfma_f32_16x16x32_bf16 v[0:3], v[20:23], v[16:19], v[0:3]
    v_mfma_f32_16x16x32_bf16 v[4:7], v[24:27], v[16:19], v[4:7]
    s_waitcnt lgkmcnt(0)
    s_waitcnt vmcnt(6)
    s_barrier
    ds_read_b128 v[16:19], v97 offset:20480
    ds_read_b128 v[20:23], v99 offset:31744
    ds_read_b128 v[24:27], v99 offset:32768
    v_mfma_f32_16x16x32_bf16 v[0:3], v[36:39], v[32:35], v[0:3]
    v_mfma_f32_16x16x32_bf16 v[4:7], v[40:43], v[32:35], v[4:7]
    s_add_u32 m0, s29, 40960
    s_nop 0
    buffer_load_dwordx4 v100, s[4:7], s24 offen sc1 lds
    s_add_u32 s24, s24, 2048
    s_add_u32 m0, s29, 49152
    s_nop 0
    buffer_load_dwordx4 v100, s[8:11], s25 offen sc1 lds
    s_add_u32 m0, s29, 53248
    s_add_u32 s30, s25, s26
    buffer_load_dwordx4 v100, s[8:11], s30 offen sc1 lds
    s_add_u32 s25, s25, 10240
    s_waitcnt lgkmcnt(0)
    ds_read_b128 v[32:35], v97 offset:24576
    ds_read_b128 v[36:39], v99 offset:36864
    ds_read_b128 v[40:43], v99 offset:37888
    v_mfma_f32_16x16x32_bf16 v[0:3], v[20:23], v[16:19], v[0:3]
    v_mfma_f32_16x16x32_bf16 v[4:7], v[24:27], v[16:19], v[4:7]
    s_waitcnt lgkmcnt(0)
    s_waitcnt vmcnt(6)
    s_barrier
    ds_read_b128 v[16:19], v96 offset:0
    ds_read_b128 v[20:23], v100 offset:11264
    ds_read_b128 v[24:27], v100 offset:12288
    v_mfma_f32_16x16x32_bf16 v[0:3], v[36:39], v[32:35], v[0:3]
    v_mfma_f32_16x16x32_bf16 v[4:7], v[40:43], v[32:35], v[4:7]
    s_add_u32 m0, s29, 61440
    s_nop 0
    buffer_load_dwordx4 v100, s[4:7], s24 offen sc1 lds
    s_add_u32 s24, s24, 2048
    s_add_u32 m0, s29, 69632
    s_nop 0
    buffer_load_dwordx4 v100, s[8:11], s25 offen sc1 lds
    s_add_u32 m0, s29, 73728
    s_add_u32 s30, s25, s26
    buffer_load_dwordx4 v100, s[8:11], s30 offen sc1 lds
    s_add_u32 s25, s25, 10240
    s_waitcnt lgkmcnt(0)
    ds_read_b128 v[32:35], v96 offset:4096
    ds_read_b128 v[36:39], v100 offset:16384
    ds_read_b128 v[40:43], v100 offset:17408
    v_mfma_f32_16x16x32_bf16 v[0:3], v[20:23], v[16:19], v[0:3]
    v_mfma_f32_16x16x32_bf16 v[4:7], v[24:27], v[16:19], v[4:7]
    s_waitcnt lgkmcnt(0)
    s_waitcnt vmcnt(6)
    s_barrier
    ds_read_b128 v[16:19], v96 offset:20480
    ds_read_b128 v[20:23], v100 offset:31744
    ds_read_b128 v[24:27], v100 offset:32768
    v_mfma_f32_16x16x32_bf16 v[0:3], v[36:39], v[32:35], v[0:3]
    v_mfma_f32_16x16x32_bf16 v[4:7], v[40:43], v[32:35], v[4:7]
    s_add_u32 m0, s29, 0
    s_nop 0
    buffer_load_dwordx4 v100, s[4:7], s24 offen sc1 lds
    s_add_u32 s24, s24, 2048
    s_add_u32 m0, s29, 8192
    s_nop 0
    buffer_load_dwordx4 v100, s[8:11], s25 offen sc1 lds
    s_add_u32 m0, s29, 12288
    s_add_u32 s30, s25, s26
    buffer_load_dwordx4 v100, s[8:11], s30 offen sc1 lds
    s_add_u32 s25, s25, 10240
    s_waitcnt lgkmcnt(0)
    ds_read_b128 v[32:35], v96 offset:24576
    ds_read_b128 v[36:39], v100 offset:36864
    ds_read_b128 v[40:43], v100 offset:37888
    v_mfma_f32_16x16x32_bf16 v[0:3], v[20:23], v[16:19], v[0:3]
    v_mfma_f32_16x16x32_bf16 v[4:7], v[24:27], v[16:19], v[4:7]
    s_waitcnt lgkmcnt(0)
    s_waitcnt vmcnt(6)
    s_barrier
    ds_read_b128 v[16:19], v97 offset:0
    ds_read_b128 v[20:23], v99 offset:11264
    ds_read_b128 v[24:27], v99 offset:12288
    v_mfma_f32_16x16x32_bf16 v[0:3], v[36:39], v[32:35], v[0:3]
    v_mfma_f32_16x16x32_bf16 v[4:7], v[40:43], v[32:35], v[4:7]
    s_add_u32 m0, s29, 20480
    s_nop 0
    buffer_load_dwordx4 v100, s[4:7], s24 offen sc1 lds
    s_add_u32 s24, s24, 2048
    s_add_u32 m0, s29, 28672
    s_nop 0
    buffer_load_dwordx4 v100, s[8:11], s25 offen sc1 lds
    s_add_u32 m0, s29, 32768
    s_add_u32 s30, s25, s26
    buffer_load_dwordx4 v100, s[8:11], s30 offen sc1 lds
    s_add_u32 s25, s25, 10240
    s_waitcnt lgkmcnt(0)
    ds_read_b128 v[32:35], v97 offset:4096
    ds_read_b128 v[36:39], v99 offset:16384
    ds_read_b128 v[40:43], v99 offset:17408
    v_mfma_f32_16x16x32_bf16 v[0:3], v[20:23], v[16:19], v[0:3]
    v_mfma_f32_16x16x32_bf16 v[4:7], v[24:27], v[16:19], v[4:7]
    s_waitcnt lgkmcnt(0)
    s_waitcnt vmcnt(6)
    s_barrier
    ds_read_b128 v[16:19], v97 offset:20480
    ds_read_b128 v[20:23], v99 offset:31744
    ds_read_b128 v[24:27], v99 offset:32768
    v_mfma_f32_16x16x32_bf16 v[0:3], v[36:39], v[32:35], v[0:3]
    v_mfma_f32_16x16x32_bf16 v[4:7], v[40:43], v[32:35], v[4:7]
    s_add_u32 m0, s29, 40960
    s_nop 0
    buffer_load_dwordx4 v100, s[4:7], s24 offen sc1 lds
    s_add_u32 s24, s24, 2048
    s_add_u32 m0, s29, 49152
    s_nop 0
    buffer_load_dwordx4 v100, s[8:11], s25 offen sc1 lds
    s_add_u32 m0, s29, 53248
    s_add_u32 s30, s25, s26
    buffer_load_dwordx4 v100, s[8:11], s30 offen sc1 lds
    s_add_u32 s25, s25, 10240
    s_waitcnt lgkmcnt(0)
    ds_read_b128 v[32:35], v97 offset:24576
    ds_read_b128 v[36:39], v99 offset:36864
    ds_read_b128 v[40:43], v99 offset:37888
    v_mfma_f32_16x16x32_bf16 v[0:3], v[20:23], v[16:19], v[0:3]
    v_mfma_f32_16x16x32_bf16 v[4:7], v[24:27], v[16:19], v[4:7]
    s_waitcnt lgkmcnt(0)
    s_waitcnt vmcnt(6)
    s_barrier
    ds_read_b128 v[16:19], v96 offset:0
    ds_read_b128 v[20:23], v100 offset:11264
    ds_read_b128 v[24:27], v100 offset:12288
    v_mfma_f32_16x16x32_bf16 v[0:3], v[36:39], v[32:35], v[0:3]
    v_mfma_f32_16x16x32_bf16 v[4:7], v[40:43], v[32:35], v[4:7]
    s_add_u32 m0, s29, 61440
    s_nop 0
    buffer_load_dwordx4 v100, s[4:7], s24 offen sc1 lds
    s_add_u32 s24, s24, 2048
    s_add_u32 m0, s29, 69632
    s_nop 0
    buffer_load_dwordx4 v100, s[8:11], s25 offen sc1 lds
    s_add_u32 m0, s29, 73728
    s_add_u32 s30, s25, s26
    buffer_load_dwordx4 v100, s[8:11], s30 offen sc1 lds
    s_add_u32 s25, s25, 10240
    s_waitcnt lgkmcnt(0)
    ds_read_b128 v[32:35], v96 offset:4096
    ds_read_b128 v[36:39], v100 offset:16384
    ds_read_b128 v[40:43], v100 offset:17408
    v_mfma_f32_16x16x32_bf16 v[0:3], v[20:23], v[16:19], v[0:3]
    v_mfma_f32_16x16x32_bf16 v[4:7], v[24:27], v[16:19], v[4:7]
    s_waitcnt lgkmcnt(0)
    s_waitcnt vmcnt(6)
    s_barrier
    ds_read_b128 v[16:19], v96 offset:20480
    ds_read_b128 v[20:23], v100 offset:31744
    ds_read_b128 v[24:27], v100 offset:32768
    v_mfma_f32_16x16x32_bf16 v[0:3], v[36:39], v[32:35], v[0:3]
    v_mfma_f32_16x16x32_bf16 v[4:7], v[40:43], v[32:35], v[4:7]
    s_add_u32 m0, s29, 0
    s_nop 0
    buffer_load_dwordx4 v100, s[4:7], s24 offen sc1 lds
    s_add_u32 s24, s24, 2048
    s_add_u32 m0, s29, 8192
    s_nop 0
    buffer_load_dwordx4 v100, s[8:11], s25 offen sc1 lds
    s_add_u32 m0, s29, 12288
    s_add_u32 s30, s25, s26
    buffer_load_dwordx4 v100, s[8:11], s30 offen sc1 lds
    s_add_u32 s25, s25, 10240
    s_waitcnt lgkmcnt(0)
    ds_read_b128 v[32:35], v96 offset:24576
    ds_read_b128 v[36:39], v100 offset:36864
    ds_read_b128 v[40:43], v100 offset:37888
    v_mfma_f32_16x16x32_bf16 v[0:3], v[20:23], v[16:19], v[0:3]
    v_mfma_f32_16x16x32_bf16 v[4:7], v[24:27], v[16:19], v[4:7]
    s_waitcnt lgkmcnt(0)
    s_waitcnt vmcnt(6)
    s_barrier
    ds_read_b128 v[16:19], v97 offset:0
    ds_read_b128 v[20:23], v99 offset:11264
    ds_read_b128 v[24:27], v99 offset:12288
    v_mfma_f32_16x16x32_bf16 v[0:3], v[36:39], v[32:35], v[0:3]
    v_mfma_f32_16x16x32_bf16 v[4:7], v[40:43], v[32:35], v[4:7]
    s_add_u32 m0, s29, 20480
    s_nop 0
    buffer_load_dwordx4 v100, s[4:7], s24 offen sc1 lds
    s_add_u32 s24, s24, 2048
    s_add_u32 m0, s29, 28672
    s_nop 0
    buffer_load_dwordx4 v100, s[8:11], s25 offen sc1 lds
    s_add_u32 m0, s29, 32768
    s_add_u32 s30, s25, s26
    buffer_load_dwordx4 v100, s[8:11], s30 offen sc1 lds
    s_add_u32 s25, s25, 10240
    s_waitcnt lgkmcnt(0)
    ds_read_b128 v[32:35], v97 offset:4096
    ds_read_b128 v[36:39], v99 offset:16384
    ds_read_b128 v[40:43], v99 offset:17408
    v_mfma_f32_16x16x32_bf16 v[0:3], v[20:23], v[16:19], v[0:3]
    v_mfma_f32_16x16x32_bf16 v[4:7], v[24:27], v[16:19], v[4:7]
    s_waitcnt lgkmcnt(0)
    s_waitcnt vmcnt(6)
    s_barrier
    ds_read_b128 v[16:19], v97 offset:20480
    ds_read_b128 v[20:23], v99 offset:31744
    ds_read_b128 v[24:27], v99 offset:32768
    v_mfma_f32_16x16x32_bf16 v[0:3], v[36:39], v[32:35], v[0:3]
    v_mfma_f32_16x16x32_bf16 v[4:7], v[40:43], v[32:35], v[4:7]
    s_add_u32 m0, s29, 40960
    s_nop 0
    buffer_load_dwordx4 v100, s[4:7], s24 offen sc1 lds
    s_add_u32 s24, s24, 2048
    s_add_u32 m0, s29, 49152
    s_nop 0
    buffer_load_dwordx4 v100, s[8:11], s25 offen sc1 lds
    s_add_u32 m0, s29, 53248
    s_add_u32 s30, s25, s26
    buffer_load_dwordx4 v100, s[8:11], s30 offen sc1 lds
    s_add_u32 s25, s25, 10240
    s_waitcnt lgkmcnt(0)
    ds_read_b128 v[32:35], v97 offset:24576
    ds_read_b128 v[36:39], v99 offset:36864
    ds_read_b128 v[40:43], v99 offset:37888
    v_mfma_f32_16x16x32_bf16 v[0:3], v[20:23], v[16:19], v[0:3]
    v_mfma_f32_16x16x32_bf16 v[4:7], v[24:27], v[16:19], v[4:7]
    s_waitcnt lgkmcnt(0)
    s_waitcnt vmcnt(6)
    s_barrier
    ds_read_b128 v[16:19], v96 offset:0
    ds_read_b128 v[20:23], v100 offset:11264
    ds_read_b128 v[24:27], v100 offset:12288
    v_mfma_f32_16x16x32_bf16 v[0:3], v[36:39], v[32:35], v[0:3]
    v_mfma_f32_16x16x32_bf16 v[4:7], v[40:43], v[32:35], v[4:7]
    s_add_u32 m0, s29, 61440
    s_nop 0
    buffer_load_dwordx4 v100, s[4:7], s24 offen sc1 lds
    s_add_u32 s24, s24, 2048
    s_add_u32 m0, s29, 69632
    s_nop 0
    buffer_load_dwordx4 v100, s[8:11], s25 offen sc1 lds
    s_add_u32 m0, s29, 73728
    s_add_u32 s30, s25, s26
    buffer_load_dwordx4 v100, s[8:11], s30 offen sc1 lds
    s_add_u32 s25, s25, 10240
    s_waitcnt lgkmcnt(0)
    ds_read_b128 v[32:35], v96 offset:4096
    ds_read_b128 v[36:39], v100 offset:16384
    ds_read_b128 v[40:43], v100 offset:17408
    v_mfma_f32_16x16x32_bf16 v[0:3], v[20:23], v[16:19], v[0:3]
    v_mfma_f32_16x16x32_bf16 v[4:7], v[24:27], v[16:19], v[4:7]
    s_waitcnt lgkmcnt(0)
    s_waitcnt vmcnt(6)
    s_barrier
    ds_read_b128 v[16:19], v96 offset:20480
    ds_read_b128 v[20:23], v100 offset:31744
    ds_read_b128 v[24:27], v100 offset:32768
    v_mfma_f32_16x16x32_bf16 v[0:3], v[36:39], v[32:35], v[0:3]
    v_mfma_f32_16x16x32_bf16 v[4:7], v[40:43], v[32:35], v[4:7]
    s_add_u32 m0, s29, 0
    s_nop 0
    buffer_load_dwordx4 v100, s[4:7], s24 offen sc1 lds
    s_add_u32 s24, s24, 2048
    s_add_u32 m0, s29, 8192
    s_nop 0
    buffer_load_dwordx4 v100, s[8:11], s25 offen sc1 lds
    s_add_u32 m0, s29, 12288
    s_add_u32 s30, s25, s26
    buffer_load_dwordx4 v100, s[8:11], s30 offen sc1 lds
    s_add_u32 s25, s25, 10240
    s_waitcnt lgkmcnt(0)
    ds_read_b128 v[32:35], v96 offset:24576
    ds_read_b128 v[36:39], v100 offset:36864
    ds_read_b128 v[40:43], v100 offset:37888
    v_mfma_f32_16x16x32_bf16 v[0:3], v[20:23], v[16:19], v[0:3]
    v_mfma_f32_16x16x32_bf16 v[4:7], v[24:27], v[16:19], v[4:7]
    s_waitcnt lgkmcnt(0)
    s_waitcnt vmcnt(6)
    s_barrier
    ds_read_b128 v[16:19], v97 offset:0
    ds_read_b128 v[20:23], v99 offset:11264
    ds_read_b128 v[24:27], v99 offset:12288
    v_mfma_f32_16x16x32_bf16 v[0:3], v[36:39], v[32:35], v[0:3]
    v_mfma_f32_16x16x32_bf16 v[4:7], v[40:43], v[32:35], v[4:7]
    s_add_u32 m0, s29, 20480
    s_nop 0
    buffer_load_dwordx4 v100, s[4:7], s24 offen sc1 lds
    s_add_u32 s24, s24, 2048
    s_add_u32 m0, s29, 28672
    s_nop 0
    buffer_load_dwordx4 v100, s[8:11], s25 offen sc1 lds
    s_add_u32 m0, s29, 32768
    s_add_u32 s30, s25, s26
    buffer_load_dwordx4 v100, s[8:11], s30 offen sc1 lds
    s_add_u32 s25, s25, 10240
    s_waitcnt lgkmcnt(0)
    ds_read_b128 v[32:35], v97 offset:4096
    ds_read_b128 v[36:39], v99 offset:16384
    ds_read_b128 v[40:43], v99 offset:17408
    v_mfma_f32_16x16x32_bf16 v[0:3], v[20:23], v[16:19], v[0:3]
    v_mfma_f32_16x16x32_bf16 v[4:7], v[24:27], v[16:19], v[4:7]
    s_waitcnt lgkmcnt(0)
    s_waitcnt vmcnt(6)
    s_barrier
    ds_read_b128 v[16:19], v97 offset:20480
    ds_read_b128 v[20:23], v99 offset:31744
    ds_read_b128 v[24:27], v99 offset:32768
    v_mfma_f32_16x16x32_bf16 v[0:3], v[36:39], v[32:35], v[0:3]
    v_mfma_f32_16x16x32_bf16 v[4:7], v[40:43], v[32:35], v[4:7]
    s_add_u32 m0, s29, 40960
    s_nop 0
    buffer_load_dwordx4 v100, s[4:7], s24 offen sc1 lds
    s_add_u32 s24, s24, 2048
    s_add_u32 m0, s29, 49152
    s_nop 0
    buffer_load_dwordx4 v100, s[8:11], s25 offen sc1 lds
    s_add_u32 m0, s29, 53248
    s_add_u32 s30, s25, s26
    buffer_load_dwordx4 v100, s[8:11], s30 offen sc1 lds
    s_add_u32 s25, s25, 10240
    s_waitcnt lgkmcnt(0)
    ds_read_b128 v[32:35], v97 offset:24576
    ds_read_b128 v[36:39], v99 offset:36864
    ds_read_b128 v[40:43], v99 offset:37888
    v_mfma_f32_16x16x32_bf16 v[0:3], v[20:23], v[16:19], v[0:3]
    v_mfma_f32_16x16x32_bf16 v[4:7], v[24:27], v[16:19], v[4:7]
    s_waitcnt lgkmcnt(0)
    s_waitcnt vmcnt(6)
    s_barrier
    ds_read_b128 v[16:19], v96 offset:0
    ds_read_b128 v[20:23], v100 offset:11264
    ds_read_b128 v[24:27], v100 offset:12288
    v_mfma_f32_16x16x32_bf16 v[0:3], v[36:39], v[32:35], v[0:3]
    v_mfma_f32_16x16x32_bf16 v[4:7], v[40:43], v[32:35], v[4:7]
    s_add_u32 m0, s29, 61440
    s_nop 0
    buffer_load_dwordx4 v100, s[4:7], s24 offen sc1 lds
    s_add_u32 s24, s24, 2048
    s_add_u32 m0, s29, 69632
    s_nop 0
    buffer_load_dwordx4 v100, s[8:11], s25 offen sc1 lds
    s_add_u32 m0, s29, 73728
    s_add_u32 s30, s25, s26
    buffer_load_dwordx4 v100, s[8:11], s30 offen sc1 lds
    s_add_u32 s25, s25, 10240
    s_waitcnt lgkmcnt(0)
    ds_read_b128 v[32:35], v96 offset:4096
    ds_read_b128 v[36:39], v100 offset:16384
    ds_read_b128 v[40:43], v100 offset:17408
    v_mfma_f32_16x16x32_bf16 v[0:3], v[20:23], v[16:19], v[0:3]
    v_mfma_f32_16x16x32_bf16 v[4:7], v[24:27], v[16:19], v[4:7]
    s_waitcnt lgkmcnt(0)
    s_waitcnt vmcnt(6)
    s_barrier
    ds_read_b128 v[16:19], v96 offset:20480
    ds_read_b128 v[20:23], v100 offset:31744
    ds_read_b128 v[24:27], v100 offset:32768
    v_mfma_f32_16x16x32_bf16 v[0:3], v[36:39], v[32:35], v[0:3]
    v_mfma_f32_16x16x32_bf16 v[4:7], v[40:43], v[32:35], v[4:7]
    s_add_u32 m0, s29, 0
    s_nop 0
    buffer_load_dwordx4 v100, s[4:7], s24 offen sc1 lds
    s_add_u32 s24, s24, 2048
    s_add_u32 m0, s29, 8192
    s_nop 0
    buffer_load_dwordx4 v100, s[8:11], s25 offen sc1 lds
    s_add_u32 m0, s29, 12288
    s_add_u32 s30, s25, s26
    buffer_load_dwordx4 v100, s[8:11], s30 offen sc1 lds
    s_add_u32 s25, s25, 10240
    s_waitcnt lgkmcnt(0)
    ds_read_b128 v[32:35], v96 offset:24576
    ds_read_b128 v[36:39], v100 offset:36864
    ds_read_b128 v[40:43], v100 offset:37888
    v_mfma_f32_16x16x32_bf16 v[0:3], v[20:23], v[16:19], v[0:3]
    v_mfma_f32_16x16x32_bf16 v[4:7], v[24:27], v[16:19], v[4:7]
    s_waitcnt lgkmcnt(0)
    s_waitcnt vmcnt(6)
    s_barrier
    ds_read_b128 v[16:19], v97 offset:0
    ds_read_b128 v[20:23], v99 offset:11264
    ds_read_b128 v[24:27], v99 offset:12288
    v_mfma_f32_16x16x32_bf16 v[0:3], v[36:39], v[32:35], v[0:3]
    v_mfma_f32_16x16x32_bf16 v[4:7], v[40:43], v[32:35], v[4:7]
    s_add_u32 m0, s29, 20480
    s_nop 0
    buffer_load_dwordx4 v100, s[4:7], s24 offen sc1 lds
    s_add_u32 s24, s24, 2048
    s_add_u32 m0, s29, 28672
    s_nop 0
    buffer_load_dwordx4 v100, s[8:11], s25 offen sc1 lds
    s_add_u32 m0, s29, 32768
    s_add_u32 s30, s25, s26
    buffer_load_dwordx4 v100, s[8:11], s30 offen sc1 lds
    s_add_u32 s25, s25, 10240
    s_waitcnt lgkmcnt(0)
    ds_read_b128 v[32:35], v97 offset:4096
    ds_read_b128 v[36:39], v99 offset:16384
    ds_read_b128 v[40:43], v99 offset:17408
    v_mfma_f32_16x16x32_bf16 v[0:3], v[20:23], v[16:19], v[0:3]
    v_mfma_f32_16x16x32_bf16 v[4:7], v[24:27], v[16:19], v[4:7]
    s_waitcnt lgkmcnt(0)
    s_waitcnt vmcnt(6)
    s_barrier
    ds_read_b128 v[16:19], v97 offset:20480
    ds_read_b128 v[20:23], v99 offset:31744
    ds_read_b128 v[24:27], v99 offset:32768
    v_mfma_f32_16x16x32_bf16 v[0:3], v[36:39], v[32:35], v[0:3]
    v_mfma_f32_16x16x32_bf16 v[4:7], v[40:43], v[32:35], v[4:7]
    s_add_u32 m0, s29, 40960
    s_nop 0
    buffer_load_dwordx4 v100, s[4:7], s24 offen sc1 lds
    s_add_u32 s24, s24, 2048
    s_add_u32 m0, s29, 49152
    s_nop 0
    buffer_load_dwordx4 v100, s[8:11], s25 offen sc1 lds
    s_add_u32 m0, s29, 53248
    s_add_u32 s30, s25, s26
    buffer_load_dwordx4 v100, s[8:11], s30 offen sc1 lds
    s_add_u32 s25, s25, 10240
    s_waitcnt lgkmcnt(0)
    ds_read_b128 v[32:35], v97 offset:24576
    ds_read_b128 v[36:39], v99 offset:36864
    ds_read_b128 v[40:43], v99 offset:37888
    v_mfma_f32_16x16x32_bf16 v[0:3], v[20:23], v[16:19], v[0:3]
    v_mfma_f32_16x16x32_bf16 v[4:7], v[24:27], v[16:19], v[4:7]
    s_waitcnt lgkmcnt(0)
    s_waitcnt vmcnt(6)
    s_barrier
    ds_read_b128 v[16:19], v96 offset:0
    ds_read_b128 v[20:23], v100 offset:11264
    ds_read_b128 v[24:27], v100 offset:12288
    v_mfma_f32_16x16x32_bf16 v[0:3], v[36:39], v[32:35], v[0:3]
    v_mfma_f32_16x16x32_bf16 v[4:7], v[40:43], v[32:35], v[4:7]
    s_add_u32 m0, s29, 61440
    s_nop 0
    buffer_load_dwordx4 v100, s[4:7], s24 offen sc1 lds
    s_add_u32 s24, s24, 2048
    s_add_u32 m0, s29, 69632
    s_nop 0
    buffer_load_dwordx4 v100, s[8:11], s25 offen sc1 lds
    s_add_u32 m0, s29, 73728
    s_add_u32 s30, s25, s26
    buffer_load_dwordx4 v100, s[8:11], s30 offen sc1 lds
    s_add_u32 s25, s25, 10240
    s_waitcnt lgkmcnt(0)
    ds_read_b128 v[32:35], v96 offset:4096
    ds_read_b128 v[36:39], v100 offset:16384
    ds_read_b128 v[40:43], v100 offset:17408
    v_mfma_f32_16x16x32_bf16 v[0:3], v[20:23], v[16:19], v[0:3]
    v_mfma_f32_16x16x32_bf16 v[4:7], v[24:27], v[16:19], v[4:7]
    s_waitcnt lgkmcnt(0)
    s_waitcnt vmcnt(6)
    s_barrier
    ds_read_b128 v[16:19], v96 offset:20480
    ds_read_b128 v[20:23], v100 offset:31744
    ds_read_b128 v[24:27], v100 offset:32768
    v_mfma_f32_16x16x32_bf16 v[0:3], v[36:39], v[32:35], v[0:3]
    v_mfma_f32_16x16x32_bf16 v[4:7], v[40:43], v[32:35], v[4:7]
    s_add_u32 m0, s29, 0
    s_add_u32 s30, s48, 0
    buffer_load_dwordx4 v100, s[8:11], s30 offen sc1 lds
    s_add_u32 m0, s29, 8192
    s_add_u32 s30, s48, 8192
    buffer_load_dwordx4 v100, s[8:11], s30 offen sc1 lds
    s_waitcnt lgkmcnt(0)
    ds_read_b128 v[32:35], v96 offset:24576
    ds_read_b128 v[36:39], v100 offset:36864
    ds_read_b128 v[40:43], v100 offset:37888
    v_mfma_f32_16x16x32_bf16 v[0:3], v[20:23], v[16:19], v[0:3]
    v_mfma_f32_16x16x32_bf16 v[4:7], v[24:27], v[16:19], v[4:7]
    s_waitcnt lgkmcnt(0)
    s_waitcnt vmcnt(5)
    s_barrier
    ds_read_b128 v[16:19], v97 offset:0
    ds_read_b128 v[20:23], v99 offset:11264
    ds_read_b128 v[24:27], v99 offset:12288
    v_mfma_f32_16x16x32_bf16 v[0:3], v[36:39], v[32:35], v[0:3]
    v_mfma_f32_16x16x32_bf16 v[4:7], v[40:43], v[32:35], v[4:7]
    s_add_u32 m0, s29, 20480
    s_add_u32 s30, s48, 20480
    buffer_load_dwordx4 v100, s[8:11], s30 offen sc1 lds
    s_add_u32 m0, s29, 28672
    s_add_u32 s30, s48, 28672
    buffer_load_dwordx4 v100, s[8:11], s30 offen sc1 lds
    s_waitcnt lgkmcnt(0)
    ds_read_b128 v[32:35], v97 offset:4096
    ds_read_b128 v[36:39], v99 offset:16384
    ds_read_b128 v[40:43], v99 offset:17408
    v_mfma_f32_16x16x32_bf16 v[0:3], v[20:23], v[16:19], v[0:3]
    v_mfma_f32_16x16x32_bf16 v[4:7], v[24:27], v[16:19], v[4:7]
    s_waitcnt lgkmcnt(0)
    s_waitcnt vmcnt(4)
    s_barrier
    ds_read_b128 v[16:19], v97 offset:20480
    ds_read_b128 v[20:23], v99 offset:31744
    ds_read_b128 v[24:27], v99 offset:32768
    v_mfma_f32_16x16x32_bf16 v[0:3], v[36:39], v[32:35], v[0:3]
    v_mfma_f32_16x16x32_bf16 v[4:7], v[40:43], v[32:35], v[4:7]
    s_add_u32 m0, s29, 40960
    s_add_u32 s30, s48, 40960
    buffer_load_dwordx4 v100, s[8:11], s30 offen sc1 lds
    s_add_u32 m0, s29, 49152
    s_add_u32 s30, s48, 49152
    buffer_load_dwordx4 v100, s[8:11], s30 offen sc1 lds
    s_waitcnt lgkmcnt(0)
    ds_read_b128 v[32:35], v97 offset:24576
    ds_read_b128 v[36:39], v99 offset:36864
    ds_read_b128 v[40:43], v99 offset:37888
    v_mfma_f32_16x16x32_bf16 v[0:3], v[20:23], v[16:19], v[0:3]
    v_mfma_f32_16x16x32_bf16 v[4:7], v[24:27], v[16:19], v[4:7]
    s_waitcnt lgkmcnt(0)
    v_mfma_f32_16x16x32_bf16 v[0:3], v[36:39], v[32:35], v[0:3]
    v_mfma_f32_16x16x32_bf16 v[4:7], v[40:43], v[32:35], v[4:7]
    s_barrier
    s_add_u32 m0, s29, 61440
    s_add_u32 s30, s48, 61440
    buffer_load_dwordx4 v100, s[8:11], s30 offen sc1 lds
    s_add_u32 m0, s29, 69632
    s_add_u32 s30, s48, 69632
    buffer_load_dwordx4 v100, s[8:11], s30 offen sc1 lds
    s_lshl_b32 s24, s21, 2
    s_add_u32 s24, s24, s27
    s_mul_i32 s24, s24, 69632
    s_add_u32 s50, s24, 18432
    s_add_u32 s51, s24, 8192
    s_add_u32 s52, s51, 4096
    v_add_u32 v96, 40960, v100
    s_mul_i32 s30, s20, 3072
    v_add_u32 v97, s30, v100
    s_xor_b32 s30, s20, 4
    s_mul_i32 s30, s30, 3072
    v_add_u32 v99, s30, v100
    s_waitcnt vmcnt(0)
    s_barrier
    buffer_load_dwordx4 v[20:23], v100, s[4:7], s50 offen offset:0 sc1
    buffer_load_dwordx4 v[24:27], v100, s[4:7], s50 offen offset:1024 sc1
    buffer_load_dwordx4 v[28:31], v100, s[4:7], s51 offen offset:0 sc1
    buffer_load_dwordx4 v[32:35], v100, s[4:7], s51 offen offset:1024 sc1
    buffer_load_dwordx4 v[36:39], v100, s[4:7], s51 offen offset:2048 sc1
    buffer_load_dwordx4 v[40:43], v100, s[4:7], s51 offen offset:3072 sc1
    buffer_load_dwordx4 v[44:47], v100, s[4:7], s52 offen offset:0 sc1
    buffer_load_dwordx4 v[48:51], v100, s[4:7], s52 offen offset:1024 sc1
    buffer_load_dwordx4 v[52:55], v100, s[4:7], s52 offen offset:2048 sc1
    buffer_load_dwordx4 v[56:59], v100, s[4:7], s52 offen offset:3072 sc1
    s_waitcnt vmcnt(9)
    v_mfma_f32_16x16x32_bf16 v[0:3], v[68:71], v[20:23], v[0:3]
    v_mfma_f32_16x16x32_bf16 v[4:7], v[72:75], v[20:23], v[4:7]
    v_mfma_f32_16x16x32_bf16 v[8:11], v[76:79], v[20:23], 0
    v_mfma_f32_16x16x32_bf16 v[12:15], v[80:83], v[20:23], 0
    v_mfma_f32_16x16x32_bf16 v[16:19], v[84:87], v[20:23], 0
    ds_read_b128 v[68:71], v96 offset:3072
    ds_read_b128 v[72:75], v96 offset:4096
    ds_read_b128 v[76:79], v96 offset:0
    ds_read_b128 v[80:83], v96 offset:1024
    ds_read_b128 v[84:87], v96 offset:2048
    s_waitcnt vmcnt(8)
    v_mfma_f32_16x16x32_bf16 v[0:3], v[104:107], v[24:27], v[0:3]
    v_mfma_f32_16x16x32_bf16 v[4:7], v[108:111], v[24:27], v[4:7]
    v_mfma_f32_16x16x32_bf16 v[8:11], v[112:115], v[24:27], v[8:11]
    v_mfma_f32_16x16x32_bf16 v[12:15], v[116:119], v[24:27], v[12:15]
    v_mfma_f32_16x16x32_bf16 v[16:19], v[120:123], v[24:27], v[16:19]
    ds_read_b128 v[104:107], v96 offset:8192
    ds_read_b128 v[108:111], v96 offset:9216
    ds_read_b128 v[112:115], v96 offset:5120
    ds_read_b128 v[116:119], v96 offset:6144
    ds_read_b128 v[120:123], v96 offset:7168
    s_waitcnt vmcnt(7) lgkmcnt(5)
    v_mfma_f32_16x16x32_bf16 v[0:3], v[68:71], v[28:31], v[0:3]
    v_mfma_f32_16x16x32_bf16 v[4:7], v[72:75], v[28:31], v[4:7]
    v_mfma_f32_16x16x32_bf16 v[8:11], v[76:79], v[28:31], v[8:11]
    v_mfma_f32_16x16x32_bf16 v[12:15], v[80:83], v[28:31], v[12:15]
    v_mfma_f32_16x16x32_bf16 v[16:19], v[84:87], v[28:31], v[16:19]
    ds_read_b128 v[68:71], v96 offset:13312
    ds_read_b128 v[72:75], v96 offset:14336
    ds_read_b128 v[76:79], v96 offset:10240
    ds_read_b128 v[80:83], v96 offset:11264
    ds_read_b128 v[84:87], v96 offset:12288
    s_waitcnt vmcnt(6) lgkmcnt(5)
    v_mfma_f32_16x16x32_bf16 v[0:3], v[104:107], v[32:35], v[0:3]
    v_mfma_f32_16x16x32_bf16 v[4:7], v[108:111], v[32:35], v[4:7]
    v_mfma_f32_16x16x32_bf16 v[8:11], v[112:115], v[32:35], v[8:11]
    v_mfma_f32_16x16x32_bf16 v[12:15], v[116:119], v[32:35], v[12:15]
    v_mfma_f32_16x16x32_bf16 v[16:19], v[120:123], v[32:35], v[16:19]
    ds_read_b128 v[104:107], v96 offset:18432
    ds_read_b128 v[108:111], v96 offset:19456
    ds_read_b128 v[112:115], v96 offset:15360
    ds_read_b128 v[116:119], v96 offset:16384
    ds_read_b128 v[120:123], v96 offset:17408
    s_waitcnt vmcnt(5) lgkmcnt(5)
    v_mfma_f32_16x16x32_bf16 v[0:3], v[68:71], v[36:39], v[0:3]
    v_mfma_f32_16x16x32_bf16 v[4:7], v[72:75], v[36:39], v[4:7]
    v_mfma_f32_16x16x32_bf16 v[8:11], v[76:79], v[36:39], v[8:11]
    v_mfma_f32_16x16x32_bf16 v[12:15], v[80:83], v[36:39], v[12:15]
    v_mfma_f32_16x16x32_bf16 v[16:19], v[84:87], v[36:39], v[16:19]
    ds_read_b128 v[68:71], v96 offset:23552
    ds_read_b128 v[72:75], v96 offset:24576
    ds_read_b128 v[76:79], v96 offset:20480
    ds_read_b128 v[80:83], v96 offset:21504
    ds_read_b128 v[84:87], v96 offset:22528
    s_waitcnt vmcnt(4) lgkmcnt(5)
    v_mfma_f32_16x16x32_bf16 v[0:3], v[104:107], v[40:43], v[0:3]
    v_mfma_f32_16x16x32_bf16 v[4:7], v[108:111], v[40:43], v[4:7]
    v_mfma_f32_16x16x32_bf16 v[8:11], v[112:115], v[40:43], v[8:11]
    v_mfma_f32_16x16x32_bf16 v[12:15], v[116:119], v[40:43], v[12:15]
    v_mfma_f32_16x16x32_bf16 v[16:19], v[120:123], v[40:43], v[16:19]
    ds_read_b128 v[104:107], v96 offset:28672
    ds_read_b128 v[108:111], v96 offset:29696
    ds_read_b128 v[112:115], v96 offset:25600
    ds_read_b128 v[116:119], v96 offset:26624
    ds_read_b128 v[120:123], v96 offset:27648
    s_waitcnt vmcnt(3) lgkmcnt(5)
    v_mfma_f32_16x16x32_bf16 v[0:3], v[68:71], v[44:47], v[0:3]
    v_mfma_f32_16x16x32_bf16 v[4:7], v[72:75], v[44:47], v[4:7]
    v_mfma_f32_16x16x32_bf16 v[8:11], v[76:79], v[44:47], v[8:11]
    v_mfma_f32_16x16x32_bf16 v[12:15], v[80:83], v[44:47], v[12:15]
    v_mfma_f32_16x16x32_bf16 v[16:19], v[84:87], v[44:47], v[16:19]
    ds_read_b128 v[68:71], v96 offset:33792
    ds_read_b128 v[72:75], v96 offset:34816
    ds_read_b128 v[76:79], v96 offset:30720
    ds_read_b128 v[80:83], v96 offset:31744
    ds_read_b128 v[84:87], v96 offset:32768
    s_waitcnt vmcnt(2) lgkmcnt(5)
    v_mfma_f32_16x16x32_bf16 v[0:3], v[104:107], v[48:51], v[0:3]
    v_mfma_f32_16x16x32_bf16 v[4:7], v[108:111], v[48:51], v[4:7]
    v_mfma_f32_16x16x32_bf16 v[8:11], v[112:115], v[48:51], v[8:11]
    v_mfma_f32_16x16x32_bf16 v[12:15], v[116:119], v[48:51], v[12:15]
    v_mfma_f32_16x16x32_bf16 v[16:19], v[120:123], v[48:51], v[16:19]
    ds_read_b128 v[104:107], v96 offset:38912
    ds_read_b128 v[108:111], v96 offset:39936
    ds_read_b128 v[112:115], v96 offset:35840
    ds_read_b128 v[116:119], v96 offset:36864
    ds_read_b128 v[120:123], v96 offset:37888
    s_waitcnt vmcnt(1) lgkmcnt(5)
    v_mfma_f32_16x16x32_bf16 v[0:3], v[68:71], v[52:55], v[0:3]
    v_mfma_f32_16x16x32_bf16 v[4:7], v[72:75], v[52:55], v[4:7]
    v_mfma_f32_16x16x32_bf16 v[8:11], v[76:79], v[52:55], v[8:11]
    v_mfma_f32_16x16x32_bf16 v[12:15], v[80:83], v[52:55], v[12:15]
    v_mfma_f32_16x16x32_bf16 v[16:19], v[84:87], v[52:55], v[16:19]
    s_waitcnt vmcnt(0) lgkmcnt(0)
    v_mfma_f32_16x16x32_bf16 v[0:3], v[104:107], v[56:59], v[0:3]
    v_mfma_f32_16x16x32_bf16 v[4:7], v[108:111], v[56:59], v[4:7]
    v_mfma_f32_16x16x32_bf16 v[8:11], v[112:115], v[56:59], v[8:11]
    v_mfma_f32_16x16x32_bf16 v[12:15], v[116:119], v[56:59], v[12:15]
    v_mfma_f32_16x16x32_bf16 v[16:19], v[120:123], v[56:59], v[16:19]
    s_barrier
    s_nop 6
    ds_write_b128 v97, v[8:11] offset:0
    ds_write_b128 v97, v[12:15] offset:1024
    ds_write_b128 v97, v[16:19] offset:2048
    s_waitcnt lgkmcnt(0)
    s_barrier
    ds_read_b128 v[20:23], v99 offset:0
    ds_read_b128 v[24:27], v99 offset:1024
    v_mov_b64 v[48:49], v[60:61]
    v_mov_b64 v[50:51], v[62:63]
    s_waitcnt lgkmcnt(0)
    v_pk_add_f32 v[0:1], v[0:1], v[20:21]
    v_pk_add_f32 v[2:3], v[2:3], v[22:23]
    v_pk_add_f32 v[4:5], v[4:5], v[24:25]
    v_pk_add_f32 v[6:7], v[6:7], v[26:27]
    v_lshlrev_b32 v56, 16, v48
    v_and_b32 v57, 0xffff0000, v48
    v_lshlrev_b32 v58, 16, v49
    v_and_b32 v59, 0xffff0000, v49
    s_nop 3
    v_add_f32 v56, v0, v56
    v_add_f32 v57, v1, v57
    v_add_f32 v58, v2, v58
    v_add_f32 v59, v3, v59
    v_cvt_pk_bf16_f32 v60, v56, v57
    v_cvt_pk_bf16_f32 v61, v58, v59
    v_lshlrev_b32 v56, 16, v50
    v_and_b32 v57, 0xffff0000, v50
    v_lshlrev_b32 v58, 16, v51
    v_and_b32 v59, 0xffff0000, v51
    v_add_f32 v56, v4, v56
    v_add_f32 v57, v5, v57
    v_add_f32 v58, v6, v58
    v_add_f32 v59, v7, v59
    v_cvt_pk_bf16_f32 v62, v56, v57
    v_cvt_pk_bf16_f32 v63, v58, v59
    s_nop 1
    v_permlane16_swap_b32 v60, v62
    v_permlane16_swap_b32 v61, v63
    buffer_store_dwordx4 v[60:63], v95, s[16:19], s49 offen offset:96
    s_endpgm
L_end:
    s_endpgm
L_code_end:
.section .rodata,"a"
.p2align 6
.amdhsa_kernel parallel_sum__softmax_full_mha__swiglu_ffn__prompt_kernel
  .amdhsa_next_free_vgpr 128
  .amdhsa_next_free_sgpr 96
  .amdhsa_accum_offset 128
  .amdhsa_group_segment_fixed_size 0
  .amdhsa_kernarg_size 80
  .amdhsa_user_sgpr_count 2
  .amdhsa_user_sgpr_kernarg_segment_ptr 1
  .amdhsa_system_sgpr_workgroup_id_x 1
.end_amdhsa_kernel
```
